```python
import torch

def _softmax(x, axis=-1):
    return torch.softmax(x, dim=axis)
def _gelu(x):
    return torch.nn.functional.gelu(x, approximate="tanh")
def _silu(x):
    return torch.nn.functional.silu(x)
def _sigmoid(x):
    return torch.sigmoid(x)
def _layernorm(x, axis=-1, eps=1e-5):
    m = x.mean(dim=axis, keepdim=True)
    v = x.var(dim=axis, keepdim=True, unbiased=False)
    return (x - m) / torch.sqrt(v + eps)
def _scatter_add(tgt, idx, src, axis=0):
    return tgt.clone().index_add_(axis, idx, src)
def _segment_sum(src, seg, n):
    out = torch.zeros((n,) + src.shape[1:], dtype=src.dtype)
    return out.index_add_(0, seg, src)
def _pad(x, pw):
    flat = tuple(v for pair in reversed(pw) for v in pair)
    return torch.nn.functional.pad(x, flat)

kernel_name = 'standalone__mha_block_cached__sampling'

def setup_inputs():

    _w = (lambda a: (lambda t: t.to(torch.bfloat16) if t.is_floating_point() else t)(torch.as_tensor(a)))
    B, Sq, D = 16, 8, 1024
    H, Sk, Dh = 32, 2048, 128
    return {
        "x": _w((lambda *s: torch.randn(*s, dtype=torch.bfloat16) * 0.8)(B, Sq, D)),
        "k_cache": _w((lambda *s: torch.randn(*s, dtype=torch.bfloat16) * 0.8)(B, H, Sk, Dh)),
        "v_cache": _w((lambda *s: torch.randn(*s, dtype=torch.bfloat16) * 0.05)(B, H, Sk, Dh)),
        "wq": _w((lambda *s: torch.randn(*s, dtype=torch.bfloat16) * 0.8)(D, H * Dh) * (D ** -0.5)),
        "wo": _w((lambda *s: torch.randn(*s, dtype=torch.bfloat16) * 0.05)(H * Dh, D) * ((H * Dh) ** -0.5)),
    }

def reference(x, k_cache, v_cache, wq, wo):
    B, Sq, D = x.shape
    H, Dh = 32, 128
    q = (lambda x, *d: x.permute(*d))((x @ wq).reshape(B, Sq, H, Dh), 0, 2, 1, 3)
    scores = torch.einsum("bhqd,bhkd->bhqk", q, k_cache) * (Dh ** -0.5)
    p = _softmax(scores, axis=-1)
    o = torch.einsum("bhqk,bhkd->bhqd", p, v_cache)
    return (lambda x, *d: x.permute(*d))(o, 0, 2, 1, 3).reshape(B, Sq, H * Dh) @ wo
```

```asm
; @launch grid=(256,1,1) block=(256,1,1) lds=147520
.amdgcn_target "amdgcn-amd-amdhsa--gfx950"
.text
.globl standalone__mha_block_cached__sampling_kernel
.p2align 8
.type standalone__mha_block_cached__sampling_kernel,@function
standalone__mha_block_cached__sampling_kernel:
  s_cmp_ge_u32 s2, 256
  s_cbranch_scc1 L_end
  s_load_dwordx16 s[4:19], s[0:1], 0
  s_memrealtime s[90:91]
  v_lshrrev_b32 v7, 6, v0
  v_and_b32 v5, 63, v0
  v_readfirstlane_b32 s40, v7
  s_getpc_b64 s[86:87]
L_cwpc:
  s_sub_u32 s86, s86, L_cwpc-standalone__mha_block_cached__sampling_kernel
  s_subb_u32 s87, s87, 0
  s_lshr_b32 s48, s2, 3
  s_lshl_b32 s48, s48, 2
  s_add_u32 s48, s48, s40
  s_lshl_b32 s48, s48, 9
  v_lshl_add_u32 v244, v5, 7, s48
  v_min_u32 v244, L_cend-standalone__mha_block_cached__sampling_kernel-4, v244
  v_mov_b32 v245, s87
  v_add_co_u32 v244, vcc, s86, v244
  v_addc_co_u32 v245, vcc, 0, v245, vcc
  s_mov_b64 exec, 15
  global_load_dword v252, v[244:245], off
  s_mov_b64 exec, -1
  v_and_b32 v6, 15, v5
  v_lshrrev_b32 v7, 4, v5
  s_and_b32 s41, s2, 7
  s_lshl_b32 s41, s41, 2
  s_lshr_b32 s48, s2, 3
  s_and_b32 s48, s48, 3
  s_add_u32 s41, s41, s48
  s_lshr_b32 s42, s2, 5
  v_and_b32 v240, 3, v6
  v_lshlrev_b32 v240, 2, v240
  v_lshrrev_b32 v242, 3, v6
  v_and_b32 v243, 7, v6
  v_lshlrev_b32 v87, 16, v7
  v_lshl_add_u32 v87, v6, 4, v87
  v_lshlrev_b32 v86, 17, v242
  v_lshl_add_u32 v86, v243, 11, v86
  v_lshl_add_u32 v86, v7, 4, v86
  v_bfe_u32 v241, v6, 2, 1
  v_lshlrev_b32 v1, 13, v241
  v_lshl_add_u32 v1, v242, 16, v1
  v_lshl_add_u32 v1, v7, 6, v1
  v_lshl_add_u32 v1, v240, 2, v1
  v_and_b32 v241, 1, v7
  v_lshlrev_b32 v3, 13, v241
  v_lshrrev_b32 v241, 1, v7
  v_lshl_add_u32 v3, v241, 16, v3
  v_lshl_add_u32 v3, v6, 4, v3
  v_lshlrev_b32 v2, 4, v5
  v_add_u32 v4, 0x1000, v2
  s_lshl_b32 s84, s42, 14
  s_lshl_b32 s48, s40, 9
  s_add_u32 s84, s84, s48
  s_lshl_b32 s85, s40, 21
  s_lshl_b32 s48, s41, 8
  s_add_u32 s85, s85, s48
  s_lshl_b32 s44, s42, 5
  s_add_u32 s44, s44, s41
  s_lshl_b32 s44, s44, 19
  s_and_b32 s48, s40, 1
  s_lshl_b32 s78, s48, 8
  s_lshr_b32 s48, s40, 1
  s_lshl_b32 s48, s48, 9
  s_add_u32 s78, s78, s48
  s_add_u32 s44, s44, s78
  s_mov_b32 s78, s44
  s_xor_b32 s43, s44, 0x8000000
  s_mov_b32 s22, 0x40000
  s_mov_b32 s23, 0x00020000
  s_mov_b32 s34, 0x800000
  s_mov_b32 s35, 0x00020000
  s_mov_b32 s26, 0x10000000
  s_mov_b32 s27, 0x00020000
  s_mov_b32 s30, 0x10000000
  s_mov_b32 s31, 0x00020000
  s_mov_b32 s50, 0x05040100
  s_mov_b32 s51, 0x07060302
  s_waitcnt lgkmcnt(0)
  s_mov_b32 s20, s4
  s_mov_b32 s21, s5
  s_mov_b32 s32, s10
  s_mov_b32 s33, s11
  s_mov_b32 s24, s6
  s_mov_b32 s25, s7
  s_mov_b32 s28, s8
  s_mov_b32 s29, s9
  s_mov_b32 s80, s16
  s_mov_b32 s81, s17
  s_mov_b64 s[0:1], s[6:7]
  s_mov_b64 s[16:17], s[8:9]
  s_mov_b32 s82, 256
  s_mov_b32 s83, 0x00020000
  v_mov_b32 v247, 0
  s_or_b32 s48, s2, s40
  s_cmp_lg_u32 s48, 0
  s_cbranch_scc1 L_nopub
  s_or_b32 s55, s90, 1
  v_mov_b32 v246, s55
  s_mov_b64 exec, 1
  buffer_store_dword v246, v247, s[80:83], 0 offen sc1
  s_mov_b64 exec, -1
L_nopub:
  s_add_u32 s48, s42, 0
  s_and_b32 s48, s48, 7
  s_lshl_b32 s48, s48, 6
  s_add_u32 s48, s48, s84
  buffer_load_dwordx4 v[8:11], v86, s[20:23], s48 offen
  s_add_u32 s48, s42, 0
  s_and_b32 s48, s48, 7
  s_lshl_b32 s47, s48, 18
  s_add_u32 s47, s47, s85
  buffer_load_dwordx4 v[88:91], v87, s[32:35], s47 offen
  s_add_u32 s47, s47, 0x2000
  buffer_load_dwordx4 v[92:95], v87, s[32:35], s47 offen
  s_add_u32 s47, s47, 0x2000
  buffer_load_dwordx4 v[96:99], v87, s[32:35], s47 offen
  s_add_u32 s47, s47, 0x2000
  buffer_load_dwordx4 v[100:103], v87, s[32:35], s47 offen
  s_add_u32 s47, s47, 0x2000
  buffer_load_dwordx4 v[104:107], v87, s[32:35], s47 offen
  s_add_u32 s47, s47, 0x2000
  buffer_load_dwordx4 v[108:111], v87, s[32:35], s47 offen
  s_add_u32 s47, s47, 0x2000
  buffer_load_dwordx4 v[112:115], v87, s[32:35], s47 offen
  s_add_u32 s47, s47, 0x2000
  buffer_load_dwordx4 v[116:119], v87, s[32:35], s47 offen
  s_bitcmp1_b32 0x18, s42
  s_cbranch_scc1 L_pc28
  s_bitcmp1_b32 0xe0, s42
  s_cbranch_scc1 L_pc56
L_pc0:
  s_add_u32 s48, s42, 1
  s_and_b32 s48, s48, 7
  s_lshl_b32 s48, s48, 6
  s_add_u32 s48, s48, s84
  buffer_load_dwordx4 v[12:15], v86, s[20:23], s48 offen
  s_add_u32 s48, s42, 2
  s_and_b32 s48, s48, 7
  s_lshl_b32 s48, s48, 6
  s_add_u32 s48, s48, s84
  buffer_load_dwordx4 v[16:19], v86, s[20:23], s48 offen
  s_add_u32 s48, s42, 3
  s_and_b32 s48, s48, 7
  s_lshl_b32 s48, s48, 6
  s_add_u32 s48, s48, s84
  buffer_load_dwordx4 v[20:23], v86, s[20:23], s48 offen
  s_add_u32 s48, s42, 4
  s_and_b32 s48, s48, 7
  s_lshl_b32 s48, s48, 6
  s_add_u32 s48, s48, s84
  buffer_load_dwordx4 v[24:27], v86, s[20:23], s48 offen
  s_add_u32 s48, s42, 5
  s_and_b32 s48, s48, 7
  s_lshl_b32 s48, s48, 6
  s_add_u32 s48, s48, s84
  buffer_load_dwordx4 v[28:31], v86, s[20:23], s48 offen
  s_add_u32 s48, s42, 6
  s_and_b32 s48, s48, 7
  s_lshl_b32 s48, s48, 6
  s_add_u32 s48, s48, s84
  buffer_load_dwordx4 v[32:35], v86, s[20:23], s48 offen
  s_add_u32 s48, s42, 7
  s_and_b32 s48, s48, 7
  s_lshl_b32 s48, s48, 6
  s_add_u32 s48, s48, s84
  buffer_load_dwordx4 v[36:39], v86, s[20:23], s48 offen
  s_add_u32 s48, s42, 1
  s_and_b32 s48, s48, 7
  s_lshl_b32 s47, s48, 18
  s_add_u32 s47, s47, s85
  buffer_load_dwordx4 v[120:123], v87, s[32:35], s47 offen
  s_add_u32 s47, s47, 0x2000
  buffer_load_dwordx4 v[124:127], v87, s[32:35], s47 offen
  s_add_u32 s47, s47, 0x2000
  buffer_load_dwordx4 v[128:131], v87, s[32:35], s47 offen
  s_add_u32 s47, s47, 0x2000
  buffer_load_dwordx4 v[132:135], v87, s[32:35], s47 offen
  s_add_u32 s47, s47, 0x2000
  buffer_load_dwordx4 v[136:139], v87, s[32:35], s47 offen
  s_add_u32 s47, s47, 0x2000
  buffer_load_dwordx4 v[140:143], v87, s[32:35], s47 offen
  s_add_u32 s47, s47, 0x2000
  buffer_load_dwordx4 v[144:147], v87, s[32:35], s47 offen
  s_waitcnt vmcnt(14)
  v_perm_b32 v72, v92, v88, s50
  v_perm_b32 v73, v100, v96, s50
  v_perm_b32 v74, v108, v104, s50
  v_perm_b32 v75, v116, v112, s50
  v_perm_b32 v76, v92, v88, s51
  v_perm_b32 v77, v100, v96, s51
  v_perm_b32 v78, v108, v104, s51
  v_perm_b32 v79, v116, v112, s51
  s_nop 1
  v_mfma_f32_16x16x32_bf16 v[40:43], v[72:75], v[8:11], 0
  v_mfma_f32_16x16x32_bf16 v[44:47], v[76:79], v[8:11], 0
  s_add_u32 s47, s47, 0x2000
  buffer_load_dwordx4 v[148:151], v87, s[32:35], s47 offen
  v_perm_b32 v72, v93, v89, s50
  v_perm_b32 v73, v101, v97, s50
  v_perm_b32 v74, v109, v105, s50
  v_perm_b32 v75, v117, v113, s50
  v_perm_b32 v76, v93, v89, s51
  v_perm_b32 v77, v101, v97, s51
  v_perm_b32 v78, v109, v105, s51
  v_perm_b32 v79, v117, v113, s51
  s_nop 1
  v_mfma_f32_16x16x32_bf16 v[48:51], v[72:75], v[8:11], 0
  v_mfma_f32_16x16x32_bf16 v[52:55], v[76:79], v[8:11], 0
  v_lshl_add_u32 v241, v7, 6, v243
  v_lshlrev_b32 v241, 4, v241
  v_lshl_add_u32 v241, v242, 8, v241
  v_add_u32 v82, 0x19000, v241
  v_mov_b32 v248, 0x1a000
  v_mov_b32 v83, 0
  ds_write_b32 v248, v83
  ds_write_b32 v248, v83 offset:4
  ds_write_b32 v248, v83 offset:8
  ds_write_b32 v248, v83 offset:12
  ds_write_b32 v248, v83 offset:16
  ds_write_b32 v248, v83 offset:24
  ds_write_b32 v248, v83 offset:28
  v_lshl_add_u32 v241, v243, 2, v248
  ds_write_b32 v241, v83 offset:32
  v_lshl_add_u32 v241, v7, 3, v243
  v_lshlrev_b32 v241, 4, v241
  s_lshl_b32 s48, s40, 12
  s_add_u32 s48, s48, 0x8000
  v_add_u32 v80, s48, v241
  s_lshl_b32 s48, s40, 8
  s_add_u32 s48, s48, 0x18000
  v_lshlrev_b32 v241, 2, v5
  v_add_u32 v81, s48, v241
  v_lshrrev_b32 v241, 3, v5
  v_lshlrev_b32 v85, 11, v241
  v_lshl_add_u32 v85, v243, 4, v85
  v_and_b32 v241, 1, v7
  v_lshlrev_b32 v84, 5, v241
  v_xor_b32 v85, v85, v84
  v_bfe_u32 v241, v6, 2, 1
  v_lshl_add_u32 v84, v241, 6, v84
  v_lshrrev_b32 v241, 2, v6
  v_lshl_add_u32 v84, v241, 10, v84
  v_lshl_add_u32 v84, v7, 8, v84
  v_lshl_add_u32 v84, v242, 7, v84
  v_lshl_add_u32 v84, v240, 1, v84
  s_lshl_b32 s59, s40, 14
  s_lshr_b32 s48, s40, 1
  s_lshl_b32 s48, s48, 15
  s_add_u32 s59, s59, s48
  s_lshl_b32 s49, s48, 1
  v_add_u32 v84, s49, v84
  v_mov_b32 v83, 1
  s_mov_b32 s52, 0x3e0293ee
  s_mov_b32 s56, 0x00ff00ff
  s_mov_b32 s57, 0x00ff00ff
  s_mov_b32 s36, s18
  s_mov_b32 s37, s19
  s_mov_b32 s38, 0x1c00000
  s_mov_b32 s39, 0x00020000
  s_mov_b32 s60, s12
  s_mov_b32 s61, s13
  s_mov_b32 s62, 0x800000
  s_mov_b32 s63, 0x00020000
  s_mov_b32 s64, s14
  s_mov_b32 s65, s15
  s_mov_b32 s66, 0x40000
  s_mov_b32 s67, 0x00020000
  s_mov_b32 s96, s18
  s_mov_b32 s97, s19
  s_mov_b32 s98, 0x0
  s_mov_b32 s99, 0x00020000
  s_and_b32 s48, s2, 7
  s_lshl_b32 s93, s48, 15
  s_lshl_b32 s58, s48, 20
  s_lshl_b32 s48, s40, 18
  s_add_u32 s58, s58, s48
  s_lshr_b32 s48, s2, 4
  s_lshl_b32 s48, s48, 7
  s_add_u32 s58, s58, s48
  s_and_b32 s48, s2, 8
  s_lshl_b32 s48, s48, 19
  s_add_u32 s93, s93, s48
  s_and_b32 s48, s40, 1
  s_lshl_b32 s48, s48, 21
  s_add_u32 s93, s93, s48
  s_and_b32 s48, s40, 2
  s_lshl_b32 s48, s48, 18
  s_add_u32 s93, s93, s48
  s_add_u32 s93, s93, 0xc00000
  s_lshl_b32 s94, s2, 15
  s_add_u32 s48, s42, 3
  s_and_b32 s48, s48, 3
  s_lshl_b32 s48, s48, 13
  s_add_u32 s94, s94, s48
  s_add_u32 s94, s94, 0xc00000
  s_and_b32 s48, s40, 1
  s_lshl_b32 s48, s48, 10
  s_add_u32 s94, s94, s48
  s_add_u32 s48, s42, 2
  s_and_b32 s48, s48, 7
  s_lshl_b32 s47, s48, 18
  s_add_u32 s47, s47, s85
  buffer_load_dwordx4 v[152:155], v87, s[32:35], s47 offen
  v_perm_b32 v72, v94, v90, s50
  v_perm_b32 v73, v102, v98, s50
  v_perm_b32 v74, v110, v106, s50
  v_perm_b32 v75, v118, v114, s50
  v_perm_b32 v76, v94, v90, s51
  v_perm_b32 v77, v102, v98, s51
  v_perm_b32 v78, v110, v106, s51
  v_perm_b32 v79, v118, v114, s51
  s_nop 1
  v_mfma_f32_16x16x32_bf16 v[56:59], v[72:75], v[8:11], 0
  v_mfma_f32_16x16x32_bf16 v[60:63], v[76:79], v[8:11], 0
  s_add_u32 s47, s47, 0x2000
  buffer_load_dwordx4 v[156:159], v87, s[32:35], s47 offen
  v_perm_b32 v72, v95, v91, s50
  v_perm_b32 v73, v103, v99, s50
  v_perm_b32 v74, v111, v107, s50
  v_perm_b32 v75, v119, v115, s50
  v_perm_b32 v76, v95, v91, s51
  v_perm_b32 v77, v103, v99, s51
  v_perm_b32 v78, v111, v107, s51
  v_perm_b32 v79, v119, v115, s51
  s_nop 1
  v_mfma_f32_16x16x32_bf16 v[64:67], v[72:75], v[8:11], 0
  v_mfma_f32_16x16x32_bf16 v[68:71], v[76:79], v[8:11], 0
  s_add_u32 s47, s47, 0x2000
  buffer_load_dwordx4 v[160:163], v87, s[32:35], s47 offen
  s_add_u32 s47, s47, 0x2000
  buffer_load_dwordx4 v[164:167], v87, s[32:35], s47 offen
  s_add_u32 s47, s47, 0x2000
  buffer_load_dwordx4 v[168:171], v87, s[32:35], s47 offen
  s_add_u32 s47, s47, 0x2000
  buffer_load_dwordx4 v[172:175], v87, s[32:35], s47 offen
  s_add_u32 s47, s47, 0x2000
  buffer_load_dwordx4 v[176:179], v87, s[32:35], s47 offen
  s_add_u32 s47, s47, 0x2000
  buffer_load_dwordx4 v[180:183], v87, s[32:35], s47 offen
  s_add_u32 s48, s42, 3
  s_and_b32 s48, s48, 7
  s_lshl_b32 s47, s48, 18
  s_add_u32 s47, s47, s85
  buffer_load_dwordx4 v[184:187], v87, s[32:35], s47 offen
  s_add_u32 s47, s47, 0x2000
  buffer_load_dwordx4 v[188:191], v87, s[32:35], s47 offen
  s_add_u32 s47, s47, 0x2000
  buffer_load_dwordx4 v[192:195], v87, s[32:35], s47 offen
  s_add_u32 s47, s47, 0x2000
  buffer_load_dwordx4 v[196:199], v87, s[32:35], s47 offen
  s_add_u32 s47, s47, 0x2000
  buffer_load_dwordx4 v[200:203], v87, s[32:35], s47 offen
  s_add_u32 s47, s47, 0x2000
  buffer_load_dwordx4 v[204:207], v87, s[32:35], s47 offen
  s_waitcnt vmcnt(14)
  v_perm_b32 v72, v124, v120, s50
  v_perm_b32 v73, v132, v128, s50
  v_perm_b32 v74, v140, v136, s50
  v_perm_b32 v75, v148, v144, s50
  v_perm_b32 v76, v124, v120, s51
  v_perm_b32 v77, v132, v128, s51
  v_perm_b32 v78, v140, v136, s51
  v_perm_b32 v79, v148, v144, s51
  s_nop 1
  v_mfma_f32_16x16x32_bf16 v[40:43], v[72:75], v[12:15], v[40:43]
  v_mfma_f32_16x16x32_bf16 v[44:47], v[76:79], v[12:15], v[44:47]
  s_add_u32 s47, s47, 0x2000
  buffer_load_dwordx4 v[208:211], v87, s[32:35], s47 offen
  v_perm_b32 v72, v125, v121, s50
  v_perm_b32 v73, v133, v129, s50
  v_perm_b32 v74, v141, v137, s50
  v_perm_b32 v75, v149, v145, s50
  v_perm_b32 v76, v125, v121, s51
  v_perm_b32 v77, v133, v129, s51
  v_perm_b32 v78, v141, v137, s51
  v_perm_b32 v79, v149, v145, s51
  s_nop 1
  v_mfma_f32_16x16x32_bf16 v[48:51], v[72:75], v[12:15], v[48:51]
  v_mfma_f32_16x16x32_bf16 v[52:55], v[76:79], v[12:15], v[52:55]
  s_add_u32 s47, s47, 0x2000
  buffer_load_dwordx4 v[212:215], v87, s[32:35], s47 offen
  v_perm_b32 v72, v126, v122, s50
  v_perm_b32 v73, v134, v130, s50
  v_perm_b32 v74, v142, v138, s50
  v_perm_b32 v75, v150, v146, s50
  v_perm_b32 v76, v126, v122, s51
  v_perm_b32 v77, v134, v130, s51
  v_perm_b32 v78, v142, v138, s51
  v_perm_b32 v79, v150, v146, s51
  s_nop 1
  v_mfma_f32_16x16x32_bf16 v[56:59], v[72:75], v[12:15], v[56:59]
  v_mfma_f32_16x16x32_bf16 v[60:63], v[76:79], v[12:15], v[60:63]
  s_add_u32 s48, s42, 4
  s_and_b32 s48, s48, 7
  s_lshl_b32 s47, s48, 18
  s_add_u32 s47, s47, s85
  buffer_load_dwordx4 v[88:91], v87, s[32:35], s47 offen
  v_perm_b32 v72, v127, v123, s50
  v_perm_b32 v73, v135, v131, s50
  v_perm_b32 v74, v143, v139, s50
  v_perm_b32 v75, v151, v147, s50
  v_perm_b32 v76, v127, v123, s51
  v_perm_b32 v77, v135, v131, s51
  v_perm_b32 v78, v143, v139, s51
  v_perm_b32 v79, v151, v147, s51
  s_nop 1
  v_mfma_f32_16x16x32_bf16 v[64:67], v[72:75], v[12:15], v[64:67]
  v_mfma_f32_16x16x32_bf16 v[68:71], v[76:79], v[12:15], v[68:71]
  s_add_u32 s47, s47, 0x2000
  buffer_load_dwordx4 v[92:95], v87, s[32:35], s47 offen
  s_add_u32 s47, s47, 0x2000
  buffer_load_dwordx4 v[96:99], v87, s[32:35], s47 offen
  s_add_u32 s47, s47, 0x2000
  buffer_load_dwordx4 v[100:103], v87, s[32:35], s47 offen
  s_add_u32 s47, s47, 0x2000
  buffer_load_dwordx4 v[104:107], v87, s[32:35], s47 offen
  s_add_u32 s47, s47, 0x2000
  buffer_load_dwordx4 v[108:111], v87, s[32:35], s47 offen
  s_waitcnt vmcnt(14)
  v_perm_b32 v72, v156, v152, s50
  v_perm_b32 v73, v164, v160, s50
  v_perm_b32 v74, v172, v168, s50
  v_perm_b32 v75, v180, v176, s50
  v_perm_b32 v76, v156, v152, s51
  v_perm_b32 v77, v164, v160, s51
  v_perm_b32 v78, v172, v168, s51
  v_perm_b32 v79, v180, v176, s51
  s_nop 1
  v_mfma_f32_16x16x32_bf16 v[40:43], v[72:75], v[16:19], v[40:43]
  v_mfma_f32_16x16x32_bf16 v[44:47], v[76:79], v[16:19], v[44:47]
  s_add_u32 s47, s47, 0x2000
  buffer_load_dwordx4 v[112:115], v87, s[32:35], s47 offen
  v_perm_b32 v72, v157, v153, s50
  v_perm_b32 v73, v165, v161, s50
  v_perm_b32 v74, v173, v169, s50
  v_perm_b32 v75, v181, v177, s50
  v_perm_b32 v76, v157, v153, s51
  v_perm_b32 v77, v165, v161, s51
  v_perm_b32 v78, v173, v169, s51
  v_perm_b32 v79, v181, v177, s51
  s_nop 1
  v_mfma_f32_16x16x32_bf16 v[48:51], v[72:75], v[16:19], v[48:51]
  v_mfma_f32_16x16x32_bf16 v[52:55], v[76:79], v[16:19], v[52:55]
  s_add_u32 s47, s47, 0x2000
  buffer_load_dwordx4 v[116:119], v87, s[32:35], s47 offen
  v_perm_b32 v72, v158, v154, s50
  v_perm_b32 v73, v166, v162, s50
  v_perm_b32 v74, v174, v170, s50
  v_perm_b32 v75, v182, v178, s50
  v_perm_b32 v76, v158, v154, s51
  v_perm_b32 v77, v166, v162, s51
  v_perm_b32 v78, v174, v170, s51
  v_perm_b32 v79, v182, v178, s51
  s_nop 1
  v_mfma_f32_16x16x32_bf16 v[56:59], v[72:75], v[16:19], v[56:59]
  v_mfma_f32_16x16x32_bf16 v[60:63], v[76:79], v[16:19], v[60:63]
  s_add_u32 s48, s42, 5
  s_and_b32 s48, s48, 7
  s_lshl_b32 s47, s48, 18
  s_add_u32 s47, s47, s85
  buffer_load_dwordx4 v[120:123], v87, s[32:35], s47 offen
  v_perm_b32 v72, v159, v155, s50
  v_perm_b32 v73, v167, v163, s50
  v_perm_b32 v74, v175, v171, s50
  v_perm_b32 v75, v183, v179, s50
  v_perm_b32 v76, v159, v155, s51
  v_perm_b32 v77, v167, v163, s51
  v_perm_b32 v78, v175, v171, s51
  v_perm_b32 v79, v183, v179, s51
  s_nop 1
  v_mfma_f32_16x16x32_bf16 v[64:67], v[72:75], v[16:19], v[64:67]
  v_mfma_f32_16x16x32_bf16 v[68:71], v[76:79], v[16:19], v[68:71]
  s_add_u32 s47, s47, 0x2000
  buffer_load_dwordx4 v[124:127], v87, s[32:35], s47 offen
  s_add_u32 s47, s47, 0x2000
  buffer_load_dwordx4 v[128:131], v87, s[32:35], s47 offen
  s_add_u32 s47, s47, 0x2000
  buffer_load_dwordx4 v[132:135], v87, s[32:35], s47 offen
  s_add_u32 s47, s47, 0x2000
  buffer_load_dwordx4 v[136:139], v87, s[32:35], s47 offen
  s_add_u32 s47, s47, 0x2000
  buffer_load_dwordx4 v[140:143], v87, s[32:35], s47 offen
  s_waitcnt vmcnt(14)
  v_perm_b32 v72, v188, v184, s50
  v_perm_b32 v73, v196, v192, s50
  v_perm_b32 v74, v204, v200, s50
  v_perm_b32 v75, v212, v208, s50
  v_perm_b32 v76, v188, v184, s51
  v_perm_b32 v77, v196, v192, s51
  v_perm_b32 v78, v204, v200, s51
  v_perm_b32 v79, v212, v208, s51
  s_nop 1
  v_mfma_f32_16x16x32_bf16 v[40:43], v[72:75], v[20:23], v[40:43]
  v_mfma_f32_16x16x32_bf16 v[44:47], v[76:79], v[20:23], v[44:47]
  s_add_u32 s47, s47, 0x2000
  buffer_load_dwordx4 v[144:147], v87, s[32:35], s47 offen
  v_perm_b32 v72, v189, v185, s50
  v_perm_b32 v73, v197, v193, s50
  v_perm_b32 v74, v205, v201, s50
  v_perm_b32 v75, v213, v209, s50
  v_perm_b32 v76, v189, v185, s51
  v_perm_b32 v77, v197, v193, s51
  v_perm_b32 v78, v205, v201, s51
  v_perm_b32 v79, v213, v209, s51
  s_nop 1
  v_mfma_f32_16x16x32_bf16 v[48:51], v[72:75], v[20:23], v[48:51]
  v_mfma_f32_16x16x32_bf16 v[52:55], v[76:79], v[20:23], v[52:55]
  s_add_u32 s47, s47, 0x2000
  buffer_load_dwordx4 v[148:151], v87, s[32:35], s47 offen
  v_perm_b32 v72, v190, v186, s50
  v_perm_b32 v73, v198, v194, s50
  v_perm_b32 v74, v206, v202, s50
  v_perm_b32 v75, v214, v210, s50
  v_perm_b32 v76, v190, v186, s51
  v_perm_b32 v77, v198, v194, s51
  v_perm_b32 v78, v206, v202, s51
  v_perm_b32 v79, v214, v210, s51
  s_nop 1
  v_mfma_f32_16x16x32_bf16 v[56:59], v[72:75], v[20:23], v[56:59]
  v_mfma_f32_16x16x32_bf16 v[60:63], v[76:79], v[20:23], v[60:63]
  s_add_u32 s48, s42, 6
  s_and_b32 s48, s48, 7
  s_lshl_b32 s47, s48, 18
  s_add_u32 s47, s47, s85
  buffer_load_dwordx4 v[152:155], v87, s[32:35], s47 offen
  v_perm_b32 v72, v191, v187, s50
  v_perm_b32 v73, v199, v195, s50
  v_perm_b32 v74, v207, v203, s50
  v_perm_b32 v75, v215, v211, s50
  v_perm_b32 v76, v191, v187, s51
  v_perm_b32 v77, v199, v195, s51
  v_perm_b32 v78, v207, v203, s51
  v_perm_b32 v79, v215, v211, s51
  s_nop 1
  v_mfma_f32_16x16x32_bf16 v[64:67], v[72:75], v[20:23], v[64:67]
  v_mfma_f32_16x16x32_bf16 v[68:71], v[76:79], v[20:23], v[68:71]
  s_add_u32 s47, s47, 0x2000
  buffer_load_dwordx4 v[156:159], v87, s[32:35], s47 offen
  s_add_u32 s47, s47, 0x2000
  buffer_load_dwordx4 v[160:163], v87, s[32:35], s47 offen
  s_add_u32 s47, s47, 0x2000
  buffer_load_dwordx4 v[164:167], v87, s[32:35], s47 offen
  s_add_u32 s47, s47, 0x2000
  buffer_load_dwordx4 v[168:171], v87, s[32:35], s47 offen
  s_add_u32 s47, s47, 0x2000
  buffer_load_dwordx4 v[172:175], v87, s[32:35], s47 offen
  s_waitcnt vmcnt(14)
  v_perm_b32 v72, v92, v88, s50
  v_perm_b32 v73, v100, v96, s50
  v_perm_b32 v74, v108, v104, s50
  v_perm_b32 v75, v116, v112, s50
  v_perm_b32 v76, v92, v88, s51
  v_perm_b32 v77, v100, v96, s51
  v_perm_b32 v78, v108, v104, s51
  v_perm_b32 v79, v116, v112, s51
  s_nop 1
  v_mfma_f32_16x16x32_bf16 v[40:43], v[72:75], v[24:27], v[40:43]
  v_mfma_f32_16x16x32_bf16 v[44:47], v[76:79], v[24:27], v[44:47]
  s_add_u32 s47, s47, 0x2000
  buffer_load_dwordx4 v[176:179], v87, s[32:35], s47 offen
  v_perm_b32 v72, v93, v89, s50
  v_perm_b32 v73, v101, v97, s50
  v_perm_b32 v74, v109, v105, s50
  v_perm_b32 v75, v117, v113, s50
  v_perm_b32 v76, v93, v89, s51
  v_perm_b32 v77, v101, v97, s51
  v_perm_b32 v78, v109, v105, s51
  v_perm_b32 v79, v117, v113, s51
  s_nop 1
  v_mfma_f32_16x16x32_bf16 v[48:51], v[72:75], v[24:27], v[48:51]
  v_mfma_f32_16x16x32_bf16 v[52:55], v[76:79], v[24:27], v[52:55]
  s_add_u32 s47, s47, 0x2000
  buffer_load_dwordx4 v[180:183], v87, s[32:35], s47 offen
  v_perm_b32 v72, v94, v90, s50
  v_perm_b32 v73, v102, v98, s50
  v_perm_b32 v74, v110, v106, s50
  v_perm_b32 v75, v118, v114, s50
  v_perm_b32 v76, v94, v90, s51
  v_perm_b32 v77, v102, v98, s51
  v_perm_b32 v78, v110, v106, s51
  v_perm_b32 v79, v118, v114, s51
  s_nop 1
  v_mfma_f32_16x16x32_bf16 v[56:59], v[72:75], v[24:27], v[56:59]
  v_mfma_f32_16x16x32_bf16 v[60:63], v[76:79], v[24:27], v[60:63]
  s_add_u32 s48, s42, 7
  s_and_b32 s48, s48, 7
  s_lshl_b32 s47, s48, 18
  s_add_u32 s47, s47, s85
  buffer_load_dwordx4 v[184:187], v87, s[32:35], s47 offen
  v_perm_b32 v72, v95, v91, s50
  v_perm_b32 v73, v103, v99, s50
  v_perm_b32 v74, v111, v107, s50
  v_perm_b32 v75, v119, v115, s50
  v_perm_b32 v76, v95, v91, s51
  v_perm_b32 v77, v103, v99, s51
  v_perm_b32 v78, v111, v107, s51
  v_perm_b32 v79, v119, v115, s51
  s_nop 1
  v_mfma_f32_16x16x32_bf16 v[64:67], v[72:75], v[24:27], v[64:67]
  v_mfma_f32_16x16x32_bf16 v[68:71], v[76:79], v[24:27], v[68:71]
  s_add_u32 s47, s47, 0x2000
  buffer_load_dwordx4 v[188:191], v87, s[32:35], s47 offen
  s_add_u32 s47, s47, 0x2000
  buffer_load_dwordx4 v[192:195], v87, s[32:35], s47 offen
  s_add_u32 s47, s47, 0x2000
  buffer_load_dwordx4 v[196:199], v87, s[32:35], s47 offen
  s_add_u32 s47, s47, 0x2000
  buffer_load_dwordx4 v[200:203], v87, s[32:35], s47 offen
  s_add_u32 s47, s47, 0x2000
  buffer_load_dwordx4 v[204:207], v87, s[32:35], s47 offen
  s_waitcnt vmcnt(14)
  v_perm_b32 v72, v124, v120, s50
  v_perm_b32 v73, v132, v128, s50
  v_perm_b32 v74, v140, v136, s50
  v_perm_b32 v75, v148, v144, s50
  v_perm_b32 v76, v124, v120, s51
  v_perm_b32 v77, v132, v128, s51
  v_perm_b32 v78, v140, v136, s51
  v_perm_b32 v79, v148, v144, s51
  s_nop 1
  v_mfma_f32_16x16x32_bf16 v[40:43], v[72:75], v[28:31], v[40:43]
  v_mfma_f32_16x16x32_bf16 v[44:47], v[76:79], v[28:31], v[44:47]
  s_add_u32 s47, s47, 0x2000
  buffer_load_dwordx4 v[208:211], v87, s[32:35], s47 offen
  v_perm_b32 v72, v125, v121, s50
  v_perm_b32 v73, v133, v129, s50
  v_perm_b32 v74, v141, v137, s50
  v_perm_b32 v75, v149, v145, s50
  v_perm_b32 v76, v125, v121, s51
  v_perm_b32 v77, v133, v129, s51
  v_perm_b32 v78, v141, v137, s51
  v_perm_b32 v79, v149, v145, s51
  s_nop 1
  v_mfma_f32_16x16x32_bf16 v[48:51], v[72:75], v[28:31], v[48:51]
  v_mfma_f32_16x16x32_bf16 v[52:55], v[76:79], v[28:31], v[52:55]
  s_add_u32 s47, s47, 0x2000
  buffer_load_dwordx4 v[212:215], v87, s[32:35], s47 offen
  v_perm_b32 v72, v126, v122, s50
  v_perm_b32 v73, v134, v130, s50
  v_perm_b32 v74, v142, v138, s50
  v_perm_b32 v75, v150, v146, s50
  v_perm_b32 v76, v126, v122, s51
  v_perm_b32 v77, v134, v130, s51
  v_perm_b32 v78, v142, v138, s51
  v_perm_b32 v79, v150, v146, s51
  s_nop 1
  v_mfma_f32_16x16x32_bf16 v[56:59], v[72:75], v[28:31], v[56:59]
  v_mfma_f32_16x16x32_bf16 v[60:63], v[76:79], v[28:31], v[60:63]
  buffer_load_dwordx4 a[0:3], v1, s[24:27], s44 offen offset:0 nt
  v_perm_b32 v72, v127, v123, s50
  v_perm_b32 v73, v135, v131, s50
  v_perm_b32 v74, v143, v139, s50
  v_perm_b32 v75, v151, v147, s50
  v_perm_b32 v76, v127, v123, s51
  v_perm_b32 v77, v135, v131, s51
  v_perm_b32 v78, v143, v139, s51
  v_perm_b32 v79, v151, v147, s51
  s_nop 1
  v_mfma_f32_16x16x32_bf16 v[64:67], v[72:75], v[28:31], v[64:67]
  v_mfma_f32_16x16x32_bf16 v[68:71], v[76:79], v[28:31], v[68:71]
  buffer_load_dwordx4 a[4:7], v1, s[24:27], s44 offen offset:1024 nt
  buffer_load_dwordx4 a[8:11], v1, s[24:27], s44 offen offset:2048 nt
  buffer_load_dwordx4 a[12:15], v1, s[24:27], s44 offen offset:3072 nt
  s_add_u32 s77, s44, 0x1000
  buffer_load_dwordx4 a[16:19], v1, s[24:27], s77 offen offset:0 nt
  s_add_u32 s77, s44, 0x1000
  buffer_load_dwordx4 a[20:23], v1, s[24:27], s77 offen offset:1024 nt
  s_waitcnt vmcnt(14)
  v_perm_b32 v72, v156, v152, s50
  v_perm_b32 v73, v164, v160, s50
  v_perm_b32 v74, v172, v168, s50
  v_perm_b32 v75, v180, v176, s50
  v_perm_b32 v76, v156, v152, s51
  v_perm_b32 v77, v164, v160, s51
  v_perm_b32 v78, v172, v168, s51
  v_perm_b32 v79, v180, v176, s51
  s_nop 1
  v_mfma_f32_16x16x32_bf16 v[40:43], v[72:75], v[32:35], v[40:43]
  v_mfma_f32_16x16x32_bf16 v[44:47], v[76:79], v[32:35], v[44:47]
  s_add_u32 s77, s44, 0x1000
  buffer_load_dwordx4 a[24:27], v1, s[24:27], s77 offen offset:2048 nt
  v_perm_b32 v72, v157, v153, s50
  v_perm_b32 v73, v165, v161, s50
  v_perm_b32 v74, v173, v169, s50
  v_perm_b32 v75, v181, v177, s50
  v_perm_b32 v76, v157, v153, s51
  v_perm_b32 v77, v165, v161, s51
  v_perm_b32 v78, v173, v169, s51
  v_perm_b32 v79, v181, v177, s51
  s_nop 1
  v_mfma_f32_16x16x32_bf16 v[48:51], v[72:75], v[32:35], v[48:51]
  v_mfma_f32_16x16x32_bf16 v[52:55], v[76:79], v[32:35], v[52:55]
  s_add_u32 s77, s44, 0x1000
  buffer_load_dwordx4 a[28:31], v1, s[24:27], s77 offen offset:3072 nt
  s_or_b32 s44, s44, 0x17f00
  s_add_u32 s44, s44, 0x100
  s_and_b32 s44, s44, 0x68000
  s_or_b32 s44, s44, s78
  v_perm_b32 v72, v158, v154, s50
  v_perm_b32 v73, v166, v162, s50
  v_perm_b32 v74, v174, v170, s50
  v_perm_b32 v75, v182, v178, s50
  v_perm_b32 v76, v158, v154, s51
  v_perm_b32 v77, v166, v162, s51
  v_perm_b32 v78, v174, v170, s51
  v_perm_b32 v79, v182, v178, s51
  s_nop 1
  v_mfma_f32_16x16x32_bf16 v[56:59], v[72:75], v[32:35], v[56:59]
  v_mfma_f32_16x16x32_bf16 v[60:63], v[76:79], v[32:35], v[60:63]
  buffer_load_dwordx4 a[32:35], v1, s[24:27], s44 offen offset:0 nt
  v_perm_b32 v72, v159, v155, s50
  v_perm_b32 v73, v167, v163, s50
  v_perm_b32 v74, v175, v171, s50
  v_perm_b32 v75, v183, v179, s50
  v_perm_b32 v76, v159, v155, s51
  v_perm_b32 v77, v167, v163, s51
  v_perm_b32 v78, v175, v171, s51
  v_perm_b32 v79, v183, v179, s51
  s_nop 1
  v_mfma_f32_16x16x32_bf16 v[64:67], v[72:75], v[32:35], v[64:67]
  v_mfma_f32_16x16x32_bf16 v[68:71], v[76:79], v[32:35], v[68:71]
  buffer_load_dwordx4 a[36:39], v1, s[24:27], s44 offen offset:1024 nt
  s_waitcnt vmcnt(9)
  buffer_load_dwordx4 a[40:43], v1, s[24:27], s44 offen offset:2048 nt
  s_waitcnt vmcnt(9)
  buffer_load_dwordx4 a[44:47], v1, s[24:27], s44 offen offset:3072 nt
  s_waitcnt vmcnt(9)
  s_add_u32 s77, s44, 0x1000
  buffer_load_dwordx4 a[48:51], v1, s[24:27], s77 offen offset:0 nt
  s_waitcnt vmcnt(9)
  s_add_u32 s77, s44, 0x1000
  buffer_load_dwordx4 a[52:55], v1, s[24:27], s77 offen offset:1024 nt
  v_perm_b32 v72, v188, v184, s50
  v_perm_b32 v73, v196, v192, s50
  v_perm_b32 v74, v204, v200, s50
  v_perm_b32 v75, v212, v208, s50
  v_perm_b32 v76, v188, v184, s51
  v_perm_b32 v77, v196, v192, s51
  v_perm_b32 v78, v204, v200, s51
  v_perm_b32 v79, v212, v208, s51
  s_nop 1
  v_mfma_f32_16x16x32_bf16 v[40:43], v[72:75], v[36:39], v[40:43]
  v_mfma_f32_16x16x32_bf16 v[44:47], v[76:79], v[36:39], v[44:47]
  s_waitcnt vmcnt(9)
  s_add_u32 s77, s44, 0x1000
  buffer_load_dwordx4 a[56:59], v1, s[24:27], s77 offen offset:2048 nt
  v_perm_b32 v72, v189, v185, s50
  v_perm_b32 v73, v197, v193, s50
  v_perm_b32 v74, v205, v201, s50
  v_perm_b32 v75, v213, v209, s50
  v_perm_b32 v76, v189, v185, s51
  v_perm_b32 v77, v197, v193, s51
  v_perm_b32 v78, v205, v201, s51
  v_perm_b32 v79, v213, v209, s51
  s_nop 1
  v_mfma_f32_16x16x32_bf16 v[48:51], v[72:75], v[36:39], v[48:51]
  v_mfma_f32_16x16x32_bf16 v[52:55], v[76:79], v[36:39], v[52:55]
  s_waitcnt vmcnt(9)
  s_add_u32 s77, s44, 0x1000
  buffer_load_dwordx4 a[60:63], v1, s[24:27], s77 offen offset:3072 nt
  s_or_b32 s44, s44, 0x17f00
  s_add_u32 s44, s44, 0x100
  s_and_b32 s44, s44, 0x68000
  s_or_b32 s44, s44, s78
  v_perm_b32 v72, v190, v186, s50
  v_perm_b32 v73, v198, v194, s50
  v_perm_b32 v74, v206, v202, s50
  v_perm_b32 v75, v214, v210, s50
  v_perm_b32 v76, v190, v186, s51
  v_perm_b32 v77, v198, v194, s51
  v_perm_b32 v78, v206, v202, s51
  v_perm_b32 v79, v214, v210, s51
  s_nop 1
  v_mfma_f32_16x16x32_bf16 v[56:59], v[72:75], v[36:39], v[56:59]
  v_mfma_f32_16x16x32_bf16 v[60:63], v[76:79], v[36:39], v[60:63]
  s_waitcnt vmcnt(9)
  buffer_load_dwordx4 a[64:67], v1, s[24:27], s44 offen offset:0 nt
  v_perm_b32 v72, v191, v187, s50
  v_perm_b32 v73, v199, v195, s50
  v_perm_b32 v74, v207, v203, s50
  v_perm_b32 v75, v215, v211, s50
  v_perm_b32 v76, v191, v187, s51
  v_perm_b32 v77, v199, v195, s51
  v_perm_b32 v78, v207, v203, s51
  v_perm_b32 v79, v215, v211, s51
  s_nop 1
  v_mfma_f32_16x16x32_bf16 v[64:67], v[72:75], v[36:39], v[64:67]
  v_mfma_f32_16x16x32_bf16 v[68:71], v[76:79], v[36:39], v[68:71]
  s_waitcnt vmcnt(9)
  buffer_load_dwordx4 a[68:71], v1, s[24:27], s44 offen offset:1024 nt
  s_lshl_b32 s48, s40, 13
  v_add_u32 v8, s48, v2
  s_lshl_b32 s48, s40, 11
  v_add_u32 v9, s48, v2
  v_lshlrev_b32 v10, 10, v7
  v_lshl_add_u32 v10, v6, 4, v10
  s_lshl_b32 s48, s40, 2
  s_add_u32 s48, s48, 0x19000
  v_add_u32 v10, s48, v10
  s_mov_b32 s20, s18
  s_mov_b32 s21, s19
  s_cmp_lt_u32 s40, 2
  s_cselect_b32 s22, 0x1c00000, 0
  s_nop 7
  ds_write_b128 v8, v[40:43] offset:0
  ds_write_b128 v8, v[44:47] offset:1024
  ds_write_b128 v8, v[48:51] offset:2048
  ds_write_b128 v8, v[52:55] offset:3072
  ds_write_b128 v8, v[56:59] offset:4096
  ds_write_b128 v8, v[60:63] offset:5120
  ds_write_b128 v8, v[64:67] offset:6144
  ds_write_b128 v8, v[68:71] offset:7168
  s_waitcnt vmcnt(9)
  buffer_load_dwordx4 a[72:75], v1, s[24:27], s44 offen offset:2048 nt
  s_waitcnt vmcnt(9)
  buffer_load_dwordx4 a[76:79], v1, s[24:27], s44 offen offset:3072 nt
  s_waitcnt lgkmcnt(0)
  s_barrier
  ds_read_b128 v[40:43], v9 offset:0
  ds_read_b128 v[44:47], v9 offset:1024
  ds_read_b128 v[48:51], v9 offset:8192
  ds_read_b128 v[52:55], v9 offset:9216
  ds_read_b128 v[56:59], v9 offset:16384
  ds_read_b128 v[60:63], v9 offset:17408
  ds_read_b128 v[64:67], v9 offset:24576
  ds_read_b128 v[68:71], v9 offset:25600
  s_waitcnt vmcnt(9)
  s_add_u32 s77, s44, 0x1000
  buffer_load_dwordx4 a[80:83], v1, s[24:27], s77 offen offset:0 nt
  s_waitcnt lgkmcnt(0)
  v_add_f32 v40, v40, v48
  v_add_f32 v56, v56, v64
  v_add_f32 v41, v41, v49
  v_add_f32 v57, v57, v65
  v_add_f32 v42, v42, v50
  v_add_f32 v58, v58, v66
  v_add_f32 v43, v43, v51
  v_add_f32 v59, v59, v67
  v_add_f32 v44, v44, v52
  v_add_f32 v60, v60, v68
  v_add_f32 v45, v45, v53
  v_add_f32 v61, v61, v69
  v_add_f32 v46, v46, v54
  v_add_f32 v62, v62, v70
  v_add_f32 v47, v47, v55
  v_add_f32 v63, v63, v71
  v_add_f32 v40, v40, v56
  v_add_f32 v41, v41, v57
  v_add_f32 v42, v42, v58
  v_add_f32 v43, v43, v59
  v_add_f32 v44, v44, v60
  v_add_f32 v45, v45, v61
  v_add_f32 v46, v46, v62
  v_add_f32 v47, v47, v63
  v_cvt_pk_bf16_f32 v12, v40, v44
  v_cvt_pk_bf16_f32 v13, v41, v45
  v_cvt_pk_bf16_f32 v14, v42, v46
  v_cvt_pk_bf16_f32 v15, v43, v47
  ds_write_b32 v10, v12 offset:0
  ds_write_b32 v10, v13 offset:256
  ds_write_b32 v10, v14 offset:512
  ds_write_b32 v10, v15 offset:768
  s_waitcnt vmcnt(9)
  s_add_u32 s77, s44, 0x1000
  buffer_load_dwordx4 a[84:87], v1, s[24:27], s77 offen offset:1024 nt
  s_waitcnt lgkmcnt(0)
  s_barrier
  ds_read_b128 v[24:27], v82 offset:0
  ds_read_b128 v[28:31], v82 offset:512
  ds_read_b128 v[32:35], v82 offset:128
  ds_read_b128 v[36:39], v82 offset:640
  v_mov_b32 v40, 0
  v_mov_b32 v41, 0
  v_mov_b32 v42, 0
  v_mov_b32 v43, 0
  v_mov_b32 v44, 0
  v_mov_b32 v45, 0
  v_mov_b32 v46, 0
  v_mov_b32 v47, 0
  v_mov_b32 v48, 0
  v_mov_b32 v49, 0
  v_mov_b32 v50, 0
  v_mov_b32 v51, 0
  v_mov_b32 v52, 0
  v_mov_b32 v53, 0
  v_mov_b32 v54, 0
  v_mov_b32 v55, 0
  v_mov_b32 v56, 0
  v_mov_b32 v57, 0
  v_mov_b32 v58, 0
  v_mov_b32 v59, 0
  v_mov_b32 v60, 0
  v_mov_b32 v61, 0
  v_mov_b32 v62, 0
  v_mov_b32 v63, 0
  v_mov_b32 v64, 0
  v_mov_b32 v65, 0
  v_mov_b32 v66, 0
  v_mov_b32 v67, 0
  v_mov_b32 v68, 0
  v_mov_b32 v69, 0
  v_mov_b32 v70, 0
  v_mov_b32 v71, 0
  v_mov_b32 v5, 0xff800000
  v_mov_b32 v6, 0
  s_waitcnt lgkmcnt(0)
  s_waitcnt vmcnt(9)
  s_add_u32 s77, s44, 0x1000
  buffer_load_dwordx4 a[88:91], v1, s[24:27], s77 offen offset:2048 nt
  s_waitcnt vmcnt(9)
  s_add_u32 s77, s44, 0x1000
  buffer_load_dwordx4 a[92:95], v1, s[24:27], s77 offen offset:3072 nt
  s_or_b32 s44, s44, 0x17f00
  s_add_u32 s44, s44, 0x100
  s_and_b32 s44, s44, 0x68000
  s_or_b32 s44, s44, s78
  s_waitcnt vmcnt(9)
  buffer_load_dwordx4 a[96:99], v1, s[24:27], s44 offen offset:0 nt
  s_waitcnt vmcnt(9)
  buffer_load_dwordx4 a[100:103], v1, s[24:27], s44 offen offset:1024 nt
  s_waitcnt vmcnt(9)
  buffer_load_dwordx4 a[104:107], v1, s[24:27], s44 offen offset:2048 nt
  s_waitcnt vmcnt(9)
  buffer_load_dwordx4 a[108:111], v1, s[24:27], s44 offen offset:3072 nt
  s_waitcnt vmcnt(9)
  s_add_u32 s77, s44, 0x1000
  buffer_load_dwordx4 a[112:115], v1, s[24:27], s77 offen offset:0 nt
  s_waitcnt vmcnt(9)
  s_add_u32 s77, s44, 0x1000
  buffer_load_dwordx4 a[116:119], v1, s[24:27], s77 offen offset:1024 nt
  s_waitcnt vmcnt(9)
  s_add_u32 s77, s44, 0x1000
  buffer_load_dwordx4 a[120:123], v1, s[24:27], s77 offen offset:2048 nt
  s_waitcnt vmcnt(9)
  s_add_u32 s77, s44, 0x1000
  buffer_load_dwordx4 a[124:127], v1, s[24:27], s77 offen offset:3072 nt
  s_or_b32 s44, s44, 0x17f00
  s_add_u32 s44, s44, 0x100
  s_and_b32 s44, s44, 0x68000
  s_or_b32 s44, s44, s78
  s_waitcnt vmcnt(9)
  buffer_load_dwordx4 a[128:131], v1, s[24:27], s44 offen offset:0 nt
  s_waitcnt vmcnt(9)
  buffer_load_dwordx4 a[132:135], v1, s[24:27], s44 offen offset:1024 nt
  s_waitcnt vmcnt(9)
  buffer_load_dwordx4 a[136:139], v1, s[24:27], s44 offen offset:2048 nt
  s_waitcnt vmcnt(9)
  buffer_load_dwordx4 a[140:143], v1, s[24:27], s44 offen offset:3072 nt
  s_waitcnt vmcnt(9)
  s_add_u32 s77, s44, 0x1000
  buffer_load_dwordx4 a[144:147], v1, s[24:27], s77 offen offset:0 nt
  s_waitcnt vmcnt(9)
  s_add_u32 s77, s44, 0x1000
  buffer_load_dwordx4 a[148:151], v1, s[24:27], s77 offen offset:1024 nt
  s_waitcnt vmcnt(9)
  s_add_u32 s77, s44, 0x1000
  buffer_load_dwordx4 a[152:155], v1, s[24:27], s77 offen offset:2048 nt
  s_waitcnt vmcnt(9)
  s_add_u32 s77, s44, 0x1000
  buffer_load_dwordx4 a[156:159], v1, s[24:27], s77 offen offset:3072 nt
  s_or_b32 s44, s44, 0x17f00
  s_add_u32 s44, s44, 0x100
  s_and_b32 s44, s44, 0x68000
  s_or_b32 s44, s44, s78
  s_waitcnt vmcnt(9)
  buffer_load_dwordx4 a[160:163], v1, s[24:27], s44 offen offset:0 nt
  s_waitcnt vmcnt(9)
  buffer_load_dwordx4 a[164:167], v1, s[24:27], s44 offen offset:1024 nt
  s_waitcnt vmcnt(9)
  buffer_load_dwordx4 a[168:171], v1, s[24:27], s44 offen offset:2048 nt
  s_waitcnt vmcnt(9)
  buffer_load_dwordx4 a[172:175], v1, s[24:27], s44 offen offset:3072 nt
  s_waitcnt vmcnt(9)
  s_add_u32 s77, s44, 0x1000
  buffer_load_dwordx4 a[176:179], v1, s[24:27], s77 offen offset:0 nt
  s_waitcnt vmcnt(9)
  s_add_u32 s77, s44, 0x1000
  buffer_load_dwordx4 a[180:183], v1, s[24:27], s77 offen offset:1024 nt
  s_waitcnt vmcnt(9)
  s_add_u32 s77, s44, 0x1000
  buffer_load_dwordx4 a[184:187], v1, s[24:27], s77 offen offset:2048 nt
  s_waitcnt vmcnt(9)
  s_add_u32 s77, s44, 0x1000
  buffer_load_dwordx4 a[188:191], v1, s[24:27], s77 offen offset:3072 nt
  s_or_b32 s44, s44, 0x17f00
  s_add_u32 s44, s44, 0x100
  s_and_b32 s44, s44, 0x68000
  s_or_b32 s44, s44, s78
  s_waitcnt vmcnt(9)
  buffer_load_dwordx4 a[192:195], v1, s[24:27], s44 offen offset:0 nt
  s_waitcnt vmcnt(9)
  buffer_load_dwordx4 a[196:199], v1, s[24:27], s44 offen offset:1024 nt
  s_waitcnt vmcnt(9)
  buffer_load_dwordx4 a[200:203], v1, s[24:27], s44 offen offset:2048 nt
  s_waitcnt vmcnt(9)
  buffer_load_dwordx4 a[204:207], v1, s[24:27], s44 offen offset:3072 nt
  s_waitcnt vmcnt(9)
  s_add_u32 s77, s44, 0x1000
  buffer_load_dwordx4 a[208:211], v1, s[24:27], s77 offen offset:0 nt
  s_waitcnt vmcnt(9)
  s_add_u32 s77, s44, 0x1000
  buffer_load_dwordx4 a[212:215], v1, s[24:27], s77 offen offset:1024 nt
  s_waitcnt vmcnt(9)
  s_add_u32 s77, s44, 0x1000
  buffer_load_dwordx4 a[216:219], v1, s[24:27], s77 offen offset:2048 nt
  s_waitcnt vmcnt(9)
  s_add_u32 s77, s44, 0x1000
  buffer_load_dwordx4 a[220:223], v1, s[24:27], s77 offen offset:3072 nt
  s_or_b32 s44, s44, 0x17f00
  s_add_u32 s44, s44, 0x100
  s_and_b32 s44, s44, 0x68000
  s_or_b32 s44, s44, s78
  s_waitcnt vmcnt(9)
  buffer_load_dwordx4 a[224:227], v1, s[24:27], s44 offen offset:0 nt
  s_waitcnt vmcnt(9)
  buffer_load_dwordx4 a[228:231], v1, s[24:27], s44 offen offset:1024 nt
  s_waitcnt vmcnt(9)
  buffer_load_dwordx4 a[232:235], v1, s[24:27], s44 offen offset:2048 nt
  s_waitcnt vmcnt(9)
  buffer_load_dwordx4 a[236:239], v1, s[24:27], s44 offen offset:3072 nt
  s_waitcnt vmcnt(9)
  s_add_u32 s77, s44, 0x1000
  buffer_load_dwordx4 a[240:243], v1, s[24:27], s77 offen offset:0 nt
  s_waitcnt vmcnt(9)
  s_add_u32 s77, s44, 0x1000
  buffer_load_dwordx4 a[244:247], v1, s[24:27], s77 offen offset:1024 nt
  s_waitcnt vmcnt(9)
  s_add_u32 s77, s44, 0x1000
  buffer_load_dwordx4 a[248:251], v1, s[24:27], s77 offen offset:2048 nt
  s_waitcnt vmcnt(9)
  s_add_u32 s77, s44, 0x1000
  buffer_load_dwordx4 a[252:255], v1, s[24:27], s77 offen offset:3072 nt
  s_or_b32 s44, s44, 0x17f00
  s_add_u32 s44, s44, 0x100
  s_and_b32 s44, s44, 0x68000
  s_or_b32 s44, s44, s78
  s_or_b32 s44, s44, 0x4000
  s_waitcnt vmcnt(5)
  buffer_load_dwordx4 v[88:91], v1, s[24:27], s44 offen offset:0 nt
  s_waitcnt vmcnt(5)
  buffer_load_dwordx4 v[92:95], v1, s[24:27], s44 offen offset:1024 nt
  s_waitcnt vmcnt(5)
  buffer_load_dwordx4 v[96:99], v1, s[24:27], s44 offen offset:2048 nt
  s_waitcnt vmcnt(5)
  buffer_load_dwordx4 v[100:103], v1, s[24:27], s44 offen offset:3072 nt
  s_waitcnt vmcnt(5)
  s_add_u32 s77, s44, 0x1000
  buffer_load_dwordx4 v[104:107], v1, s[24:27], s77 offen offset:0 nt
  s_waitcnt vmcnt(5)
  s_add_u32 s77, s44, 0x1000
  buffer_load_dwordx4 v[108:111], v1, s[24:27], s77 offen offset:1024 nt
  s_waitcnt vmcnt(5)
  s_add_u32 s77, s44, 0x1000
  buffer_load_dwordx4 v[112:115], v1, s[24:27], s77 offen offset:2048 nt
  s_waitcnt vmcnt(5)
  s_add_u32 s77, s44, 0x1000
  buffer_load_dwordx4 v[116:119], v1, s[24:27], s77 offen offset:3072 nt
  s_or_b32 s44, s44, 0x17f00
  s_add_u32 s44, s44, 0x100
  s_and_b32 s44, s44, 0x68000
  s_or_b32 s44, s44, s78
  s_or_b32 s44, s44, 0x4000
  s_waitcnt vmcnt(8)
  s_branch L_pJ
L_pc28:
  buffer_load_dwordx4 a[0:3], v1, s[24:27], s44 offen offset:0 nt
  buffer_load_dwordx4 a[4:7], v1, s[24:27], s44 offen offset:1024 nt
  buffer_load_dwordx4 a[8:11], v1, s[24:27], s44 offen offset:2048 nt
  buffer_load_dwordx4 a[12:15], v1, s[24:27], s44 offen offset:3072 nt
  s_add_u32 s77, s44, 0x1000
  buffer_load_dwordx4 a[16:19], v1, s[24:27], s77 offen offset:0 nt
  s_add_u32 s77, s44, 0x1000
  buffer_load_dwordx4 a[20:23], v1, s[24:27], s77 offen offset:1024 nt
  s_add_u32 s77, s44, 0x1000
  buffer_load_dwordx4 a[24:27], v1, s[24:27], s77 offen offset:2048 nt
  s_add_u32 s77, s44, 0x1000
  buffer_load_dwordx4 a[28:31], v1, s[24:27], s77 offen offset:3072 nt
  s_or_b32 s44, s44, 0x17f00
  s_add_u32 s44, s44, 0x100
  s_and_b32 s44, s44, 0x68000
  s_or_b32 s44, s44, s78
  buffer_load_dwordx4 a[32:35], v1, s[24:27], s44 offen offset:0 nt
  buffer_load_dwordx4 a[36:39], v1, s[24:27], s44 offen offset:1024 nt
  v_lshl_add_u32 v241, v7, 6, v243
  v_lshlrev_b32 v241, 4, v241
  v_lshl_add_u32 v241, v242, 8, v241
  v_add_u32 v82, 0x19000, v241
  v_mov_b32 v248, 0x1a000
  v_mov_b32 v83, 0
  ds_write_b32 v248, v83
  ds_write_b32 v248, v83 offset:4
  ds_write_b32 v248, v83 offset:8
  ds_write_b32 v248, v83 offset:12
  ds_write_b32 v248, v83 offset:16
  ds_write_b32 v248, v83 offset:24
  ds_write_b32 v248, v83 offset:28
  v_lshl_add_u32 v241, v243, 2, v248
  ds_write_b32 v241, v83 offset:32
  v_lshl_add_u32 v241, v7, 3, v243
  v_lshlrev_b32 v241, 4, v241
  s_lshl_b32 s48, s40, 12
  s_add_u32 s48, s48, 0x8000
  v_add_u32 v80, s48, v241
  s_lshl_b32 s48, s40, 8
  s_add_u32 s48, s48, 0x18000
  v_lshlrev_b32 v241, 2, v5
  v_add_u32 v81, s48, v241
  v_lshrrev_b32 v241, 3, v5
  v_lshlrev_b32 v85, 11, v241
  v_lshl_add_u32 v85, v243, 4, v85
  v_and_b32 v241, 1, v7
  v_lshlrev_b32 v84, 5, v241
  v_xor_b32 v85, v85, v84
  v_bfe_u32 v241, v6, 2, 1
  v_lshl_add_u32 v84, v241, 6, v84
  v_lshrrev_b32 v241, 2, v6
  v_lshl_add_u32 v84, v241, 10, v84
  v_lshl_add_u32 v84, v7, 8, v84
  v_lshl_add_u32 v84, v242, 7, v84
  v_lshl_add_u32 v84, v240, 1, v84
  s_lshl_b32 s59, s40, 14
  s_lshr_b32 s48, s40, 1
  s_lshl_b32 s48, s48, 15
  s_add_u32 s59, s59, s48
  s_lshl_b32 s49, s48, 1
  v_add_u32 v84, s49, v84
  v_mov_b32 v83, 1
  s_mov_b32 s52, 0x3e0293ee
  s_mov_b32 s56, 0x00ff00ff
  s_mov_b32 s57, 0x00ff00ff
  s_mov_b32 s36, s18
  s_mov_b32 s37, s19
  s_mov_b32 s38, 0x1c00000
  s_mov_b32 s39, 0x00020000
  s_mov_b32 s60, s12
  s_mov_b32 s61, s13
  s_mov_b32 s62, 0x800000
  s_mov_b32 s63, 0x00020000
  s_mov_b32 s64, s14
  s_mov_b32 s65, s15
  s_mov_b32 s66, 0x40000
  s_mov_b32 s67, 0x00020000
  s_mov_b32 s96, s18
  s_mov_b32 s97, s19
  s_mov_b32 s98, 0x0
  s_mov_b32 s99, 0x00020000
  s_and_b32 s48, s2, 7
  s_lshl_b32 s93, s48, 15
  s_lshl_b32 s58, s48, 20
  s_lshl_b32 s48, s40, 18
  s_add_u32 s58, s58, s48
  s_lshr_b32 s48, s2, 4
  s_lshl_b32 s48, s48, 7
  s_add_u32 s58, s58, s48
  s_and_b32 s48, s2, 8
  s_lshl_b32 s48, s48, 19
  s_add_u32 s93, s93, s48
  s_and_b32 s48, s40, 1
  s_lshl_b32 s48, s48, 21
  s_add_u32 s93, s93, s48
  s_and_b32 s48, s40, 2
  s_lshl_b32 s48, s48, 18
  s_add_u32 s93, s93, s48
  s_add_u32 s93, s93, 0xc00000
  s_lshl_b32 s94, s2, 15
  s_add_u32 s48, s42, 3
  s_and_b32 s48, s48, 3
  s_lshl_b32 s48, s48, 13
  s_add_u32 s94, s94, s48
  s_add_u32 s94, s94, 0xc00000
  s_and_b32 s48, s40, 1
  s_lshl_b32 s48, s48, 10
  s_add_u32 s94, s94, s48
  s_waitcnt vmcnt(9)
  buffer_load_dwordx4 a[40:43], v1, s[24:27], s44 offen offset:2048 nt
  s_waitcnt vmcnt(9)
  buffer_load_dwordx4 a[44:47], v1, s[24:27], s44 offen offset:3072 nt
  s_waitcnt vmcnt(9)
  s_add_u32 s77, s44, 0x1000
  buffer_load_dwordx4 a[48:51], v1, s[24:27], s77 offen offset:0 nt
  s_waitcnt vmcnt(9)
  s_add_u32 s77, s44, 0x1000
  buffer_load_dwordx4 a[52:55], v1, s[24:27], s77 offen offset:1024 nt
  v_perm_b32 v72, v92, v88, s50
  v_perm_b32 v73, v100, v96, s50
  v_perm_b32 v74, v108, v104, s50
  v_perm_b32 v75, v116, v112, s50
  v_perm_b32 v76, v92, v88, s51
  v_perm_b32 v77, v100, v96, s51
  v_perm_b32 v78, v108, v104, s51
  v_perm_b32 v79, v116, v112, s51
  s_nop 1
  v_mfma_f32_16x16x32_bf16 v[40:43], v[72:75], v[8:11], 0
  v_mfma_f32_16x16x32_bf16 v[44:47], v[76:79], v[8:11], 0
  s_waitcnt vmcnt(9)
  s_add_u32 s77, s44, 0x1000
  buffer_load_dwordx4 a[56:59], v1, s[24:27], s77 offen offset:2048 nt
  v_perm_b32 v72, v93, v89, s50
  v_perm_b32 v73, v101, v97, s50
  v_perm_b32 v74, v109, v105, s50
  v_perm_b32 v75, v117, v113, s50
  v_perm_b32 v76, v93, v89, s51
  v_perm_b32 v77, v101, v97, s51
  v_perm_b32 v78, v109, v105, s51
  v_perm_b32 v79, v117, v113, s51
  s_nop 1
  v_mfma_f32_16x16x32_bf16 v[48:51], v[72:75], v[8:11], 0
  v_mfma_f32_16x16x32_bf16 v[52:55], v[76:79], v[8:11], 0
  s_waitcnt vmcnt(9)
  s_add_u32 s77, s44, 0x1000
  buffer_load_dwordx4 a[60:63], v1, s[24:27], s77 offen offset:3072 nt
  s_or_b32 s44, s44, 0x17f00
  s_add_u32 s44, s44, 0x100
  s_and_b32 s44, s44, 0x68000
  s_or_b32 s44, s44, s78
  v_perm_b32 v72, v94, v90, s50
  v_perm_b32 v73, v102, v98, s50
  v_perm_b32 v74, v110, v106, s50
  v_perm_b32 v75, v118, v114, s50
  v_perm_b32 v76, v94, v90, s51
  v_perm_b32 v77, v102, v98, s51
  v_perm_b32 v78, v110, v106, s51
  v_perm_b32 v79, v118, v114, s51
  s_nop 1
  v_mfma_f32_16x16x32_bf16 v[56:59], v[72:75], v[8:11], 0
  v_mfma_f32_16x16x32_bf16 v[60:63], v[76:79], v[8:11], 0
  s_waitcnt vmcnt(9)
  buffer_load_dwordx4 a[64:67], v1, s[24:27], s44 offen offset:0 nt
  v_perm_b32 v72, v95, v91, s50
  v_perm_b32 v73, v103, v99, s50
  v_perm_b32 v74, v111, v107, s50
  v_perm_b32 v75, v119, v115, s50
  v_perm_b32 v76, v95, v91, s51
  v_perm_b32 v77, v103, v99, s51
  v_perm_b32 v78, v111, v107, s51
  v_perm_b32 v79, v119, v115, s51
  s_nop 1
  v_mfma_f32_16x16x32_bf16 v[64:67], v[72:75], v[8:11], 0
  v_mfma_f32_16x16x32_bf16 v[68:71], v[76:79], v[8:11], 0
  s_waitcnt vmcnt(9)
  buffer_load_dwordx4 a[68:71], v1, s[24:27], s44 offen offset:1024 nt
  s_waitcnt vmcnt(9)
  buffer_load_dwordx4 a[72:75], v1, s[24:27], s44 offen offset:2048 nt
  s_waitcnt vmcnt(9)
  buffer_load_dwordx4 a[76:79], v1, s[24:27], s44 offen offset:3072 nt
  s_waitcnt vmcnt(9)
  s_add_u32 s77, s44, 0x1000
  buffer_load_dwordx4 a[80:83], v1, s[24:27], s77 offen offset:0 nt
  s_waitcnt vmcnt(9)
  s_add_u32 s77, s44, 0x1000
  buffer_load_dwordx4 a[84:87], v1, s[24:27], s77 offen offset:1024 nt
  s_waitcnt vmcnt(9)
  s_add_u32 s77, s44, 0x1000
  buffer_load_dwordx4 a[88:91], v1, s[24:27], s77 offen offset:2048 nt
  s_waitcnt vmcnt(9)
  s_add_u32 s77, s44, 0x1000
  buffer_load_dwordx4 a[92:95], v1, s[24:27], s77 offen offset:3072 nt
  s_or_b32 s44, s44, 0x17f00
  s_add_u32 s44, s44, 0x100
  s_and_b32 s44, s44, 0x68000
  s_or_b32 s44, s44, s78
  s_waitcnt vmcnt(9)
  buffer_load_dwordx4 a[96:99], v1, s[24:27], s44 offen offset:0 nt
  s_waitcnt vmcnt(9)
  buffer_load_dwordx4 a[100:103], v1, s[24:27], s44 offen offset:1024 nt
  s_waitcnt vmcnt(9)
  buffer_load_dwordx4 a[104:107], v1, s[24:27], s44 offen offset:2048 nt
  s_waitcnt vmcnt(9)
  buffer_load_dwordx4 a[108:111], v1, s[24:27], s44 offen offset:3072 nt
  s_add_u32 s48, s42, 1
  s_and_b32 s48, s48, 7
  s_lshl_b32 s48, s48, 6
  s_add_u32 s48, s48, s84
  buffer_load_dwordx4 v[12:15], v86, s[20:23], s48 offen
  s_add_u32 s48, s42, 2
  s_and_b32 s48, s48, 7
  s_lshl_b32 s48, s48, 6
  s_add_u32 s48, s48, s84
  buffer_load_dwordx4 v[16:19], v86, s[20:23], s48 offen
  s_add_u32 s48, s42, 3
  s_and_b32 s48, s48, 7
  s_lshl_b32 s48, s48, 6
  s_add_u32 s48, s48, s84
  buffer_load_dwordx4 v[20:23], v86, s[20:23], s48 offen
  s_add_u32 s48, s42, 4
  s_and_b32 s48, s48, 7
  s_lshl_b32 s48, s48, 6
  s_add_u32 s48, s48, s84
  buffer_load_dwordx4 v[24:27], v86, s[20:23], s48 offen
  s_add_u32 s48, s42, 5
  s_and_b32 s48, s48, 7
  s_lshl_b32 s48, s48, 6
  s_add_u32 s48, s48, s84
  buffer_load_dwordx4 v[28:31], v86, s[20:23], s48 offen
  s_add_u32 s48, s42, 6
  s_and_b32 s48, s48, 7
  s_lshl_b32 s48, s48, 6
  s_add_u32 s48, s48, s84
  buffer_load_dwordx4 v[32:35], v86, s[20:23], s48 offen
  s_add_u32 s48, s42, 7
  s_and_b32 s48, s48, 7
  s_lshl_b32 s48, s48, 6
  s_add_u32 s48, s48, s84
  buffer_load_dwordx4 v[36:39], v86, s[20:23], s48 offen
  s_add_u32 s48, s42, 1
  s_and_b32 s48, s48, 7
  s_lshl_b32 s47, s48, 18
  s_add_u32 s47, s47, s85
  buffer_load_dwordx4 v[120:123], v87, s[32:35], s47 offen
  s_add_u32 s47, s47, 0x2000
  buffer_load_dwordx4 v[124:127], v87, s[32:35], s47 offen
  s_add_u32 s47, s47, 0x2000
  buffer_load_dwordx4 v[128:131], v87, s[32:35], s47 offen
  s_add_u32 s47, s47, 0x2000
  buffer_load_dwordx4 v[132:135], v87, s[32:35], s47 offen
  s_add_u32 s47, s47, 0x2000
  buffer_load_dwordx4 v[136:139], v87, s[32:35], s47 offen
  s_add_u32 s47, s47, 0x2000
  buffer_load_dwordx4 v[140:143], v87, s[32:35], s47 offen
  s_add_u32 s47, s47, 0x2000
  buffer_load_dwordx4 v[144:147], v87, s[32:35], s47 offen
  s_add_u32 s47, s47, 0x2000
  buffer_load_dwordx4 v[148:151], v87, s[32:35], s47 offen
  s_add_u32 s48, s42, 2
  s_and_b32 s48, s48, 7
  s_lshl_b32 s47, s48, 18
  s_add_u32 s47, s47, s85
  buffer_load_dwordx4 v[152:155], v87, s[32:35], s47 offen
  s_add_u32 s47, s47, 0x2000
  buffer_load_dwordx4 v[156:159], v87, s[32:35], s47 offen
  s_add_u32 s47, s47, 0x2000
  buffer_load_dwordx4 v[160:163], v87, s[32:35], s47 offen
  s_add_u32 s47, s47, 0x2000
  buffer_load_dwordx4 v[164:167], v87, s[32:35], s47 offen
  s_add_u32 s47, s47, 0x2000
  buffer_load_dwordx4 v[168:171], v87, s[32:35], s47 offen
  s_add_u32 s47, s47, 0x2000
  buffer_load_dwordx4 v[172:175], v87, s[32:35], s47 offen
  s_add_u32 s47, s47, 0x2000
  buffer_load_dwordx4 v[176:179], v87, s[32:35], s47 offen
  s_add_u32 s47, s47, 0x2000
  buffer_load_dwordx4 v[180:183], v87, s[32:35], s47 offen
  s_add_u32 s48, s42, 3
  s_and_b32 s48, s48, 7
  s_lshl_b32 s47, s48, 18
  s_add_u32 s47, s47, s85
  buffer_load_dwordx4 v[184:187], v87, s[32:35], s47 offen
  s_add_u32 s47, s47, 0x2000
  buffer_load_dwordx4 v[188:191], v87, s[32:35], s47 offen
  s_add_u32 s47, s47, 0x2000
  buffer_load_dwordx4 v[192:195], v87, s[32:35], s47 offen
  s_add_u32 s47, s47, 0x2000
  buffer_load_dwordx4 v[196:199], v87, s[32:35], s47 offen
  s_add_u32 s47, s47, 0x2000
  buffer_load_dwordx4 v[200:203], v87, s[32:35], s47 offen
  s_add_u32 s47, s47, 0x2000
  buffer_load_dwordx4 v[204:207], v87, s[32:35], s47 offen
  s_waitcnt vmcnt(14)
  v_perm_b32 v72, v124, v120, s50
  v_perm_b32 v73, v132, v128, s50
  v_perm_b32 v74, v140, v136, s50
  v_perm_b32 v75, v148, v144, s50
  v_perm_b32 v76, v124, v120, s51
  v_perm_b32 v77, v132, v128, s51
  v_perm_b32 v78, v140, v136, s51
  v_perm_b32 v79, v148, v144, s51
  s_nop 1
  v_mfma_f32_16x16x32_bf16 v[40:43], v[72:75], v[12:15], v[40:43]
  v_mfma_f32_16x16x32_bf16 v[44:47], v[76:79], v[12:15], v[44:47]
  s_add_u32 s47, s47, 0x2000
  buffer_load_dwordx4 v[208:211], v87, s[32:35], s47 offen
  v_perm_b32 v72, v125, v121, s50
  v_perm_b32 v73, v133, v129, s50
  v_perm_b32 v74, v141, v137, s50
  v_perm_b32 v75, v149, v145, s50
  v_perm_b32 v76, v125, v121, s51
  v_perm_b32 v77, v133, v129, s51
  v_perm_b32 v78, v141, v137, s51
  v_perm_b32 v79, v149, v145, s51
  s_nop 1
  v_mfma_f32_16x16x32_bf16 v[48:51], v[72:75], v[12:15], v[48:51]
  v_mfma_f32_16x16x32_bf16 v[52:55], v[76:79], v[12:15], v[52:55]
  s_add_u32 s47, s47, 0x2000
  buffer_load_dwordx4 v[212:215], v87, s[32:35], s47 offen
  v_perm_b32 v72, v126, v122, s50
  v_perm_b32 v73, v134, v130, s50
  v_perm_b32 v74, v142, v138, s50
  v_perm_b32 v75, v150, v146, s50
  v_perm_b32 v76, v126, v122, s51
  v_perm_b32 v77, v134, v130, s51
  v_perm_b32 v78, v142, v138, s51
  v_perm_b32 v79, v150, v146, s51
  s_nop 1
  v_mfma_f32_16x16x32_bf16 v[56:59], v[72:75], v[12:15], v[56:59]
  v_mfma_f32_16x16x32_bf16 v[60:63], v[76:79], v[12:15], v[60:63]
  s_add_u32 s48, s42, 4
  s_and_b32 s48, s48, 7
  s_lshl_b32 s47, s48, 18
  s_add_u32 s47, s47, s85
  buffer_load_dwordx4 v[88:91], v87, s[32:35], s47 offen
  v_perm_b32 v72, v127, v123, s50
  v_perm_b32 v73, v135, v131, s50
  v_perm_b32 v74, v143, v139, s50
  v_perm_b32 v75, v151, v147, s50
  v_perm_b32 v76, v127, v123, s51
  v_perm_b32 v77, v135, v131, s51
  v_perm_b32 v78, v143, v139, s51
  v_perm_b32 v79, v151, v147, s51
  s_nop 1
  v_mfma_f32_16x16x32_bf16 v[64:67], v[72:75], v[12:15], v[64:67]
  v_mfma_f32_16x16x32_bf16 v[68:71], v[76:79], v[12:15], v[68:71]
  s_add_u32 s47, s47, 0x2000
  buffer_load_dwordx4 v[92:95], v87, s[32:35], s47 offen
  s_add_u32 s47, s47, 0x2000
  buffer_load_dwordx4 v[96:99], v87, s[32:35], s47 offen
  s_add_u32 s47, s47, 0x2000
  buffer_load_dwordx4 v[100:103], v87, s[32:35], s47 offen
  s_add_u32 s47, s47, 0x2000
  buffer_load_dwordx4 v[104:107], v87, s[32:35], s47 offen
  s_add_u32 s47, s47, 0x2000
  buffer_load_dwordx4 v[108:111], v87, s[32:35], s47 offen
  s_waitcnt vmcnt(14)
  v_perm_b32 v72, v156, v152, s50
  v_perm_b32 v73, v164, v160, s50
  v_perm_b32 v74, v172, v168, s50
  v_perm_b32 v75, v180, v176, s50
  v_perm_b32 v76, v156, v152, s51
  v_perm_b32 v77, v164, v160, s51
  v_perm_b32 v78, v172, v168, s51
  v_perm_b32 v79, v180, v176, s51
  s_nop 1
  v_mfma_f32_16x16x32_bf16 v[40:43], v[72:75], v[16:19], v[40:43]
  v_mfma_f32_16x16x32_bf16 v[44:47], v[76:79], v[16:19], v[44:47]
  s_add_u32 s47, s47, 0x2000
  buffer_load_dwordx4 v[112:115], v87, s[32:35], s47 offen
  v_perm_b32 v72, v157, v153, s50
  v_perm_b32 v73, v165, v161, s50
  v_perm_b32 v74, v173, v169, s50
  v_perm_b32 v75, v181, v177, s50
  v_perm_b32 v76, v157, v153, s51
  v_perm_b32 v77, v165, v161, s51
  v_perm_b32 v78, v173, v169, s51
  v_perm_b32 v79, v181, v177, s51
  s_nop 1
  v_mfma_f32_16x16x32_bf16 v[48:51], v[72:75], v[16:19], v[48:51]
  v_mfma_f32_16x16x32_bf16 v[52:55], v[76:79], v[16:19], v[52:55]
  s_add_u32 s47, s47, 0x2000
  buffer_load_dwordx4 v[116:119], v87, s[32:35], s47 offen
  v_perm_b32 v72, v158, v154, s50
  v_perm_b32 v73, v166, v162, s50
  v_perm_b32 v74, v174, v170, s50
  v_perm_b32 v75, v182, v178, s50
  v_perm_b32 v76, v158, v154, s51
  v_perm_b32 v77, v166, v162, s51
  v_perm_b32 v78, v174, v170, s51
  v_perm_b32 v79, v182, v178, s51
  s_nop 1
  v_mfma_f32_16x16x32_bf16 v[56:59], v[72:75], v[16:19], v[56:59]
  v_mfma_f32_16x16x32_bf16 v[60:63], v[76:79], v[16:19], v[60:63]
  s_add_u32 s48, s42, 5
  s_and_b32 s48, s48, 7
  s_lshl_b32 s47, s48, 18
  s_add_u32 s47, s47, s85
  buffer_load_dwordx4 v[120:123], v87, s[32:35], s47 offen
  v_perm_b32 v72, v159, v155, s50
  v_perm_b32 v73, v167, v163, s50
  v_perm_b32 v74, v175, v171, s50
  v_perm_b32 v75, v183, v179, s50
  v_perm_b32 v76, v159, v155, s51
  v_perm_b32 v77, v167, v163, s51
  v_perm_b32 v78, v175, v171, s51
  v_perm_b32 v79, v183, v179, s51
  s_nop 1
  v_mfma_f32_16x16x32_bf16 v[64:67], v[72:75], v[16:19], v[64:67]
  v_mfma_f32_16x16x32_bf16 v[68:71], v[76:79], v[16:19], v[68:71]
  s_add_u32 s47, s47, 0x2000
  buffer_load_dwordx4 v[124:127], v87, s[32:35], s47 offen
  s_add_u32 s47, s47, 0x2000
  buffer_load_dwordx4 v[128:131], v87, s[32:35], s47 offen
  s_add_u32 s47, s47, 0x2000
  buffer_load_dwordx4 v[132:135], v87, s[32:35], s47 offen
  s_add_u32 s47, s47, 0x2000
  buffer_load_dwordx4 v[136:139], v87, s[32:35], s47 offen
  s_add_u32 s47, s47, 0x2000
  buffer_load_dwordx4 v[140:143], v87, s[32:35], s47 offen
  s_waitcnt vmcnt(14)
  v_perm_b32 v72, v188, v184, s50
  v_perm_b32 v73, v196, v192, s50
  v_perm_b32 v74, v204, v200, s50
  v_perm_b32 v75, v212, v208, s50
  v_perm_b32 v76, v188, v184, s51
  v_perm_b32 v77, v196, v192, s51
  v_perm_b32 v78, v204, v200, s51
  v_perm_b32 v79, v212, v208, s51
  s_nop 1
  v_mfma_f32_16x16x32_bf16 v[40:43], v[72:75], v[20:23], v[40:43]
  v_mfma_f32_16x16x32_bf16 v[44:47], v[76:79], v[20:23], v[44:47]
  s_add_u32 s47, s47, 0x2000
  buffer_load_dwordx4 v[144:147], v87, s[32:35], s47 offen
  v_perm_b32 v72, v189, v185, s50
  v_perm_b32 v73, v197, v193, s50
  v_perm_b32 v74, v205, v201, s50
  v_perm_b32 v75, v213, v209, s50
  v_perm_b32 v76, v189, v185, s51
  v_perm_b32 v77, v197, v193, s51
  v_perm_b32 v78, v205, v201, s51
  v_perm_b32 v79, v213, v209, s51
  s_nop 1
  v_mfma_f32_16x16x32_bf16 v[48:51], v[72:75], v[20:23], v[48:51]
  v_mfma_f32_16x16x32_bf16 v[52:55], v[76:79], v[20:23], v[52:55]
  s_add_u32 s47, s47, 0x2000
  buffer_load_dwordx4 v[148:151], v87, s[32:35], s47 offen
  v_perm_b32 v72, v190, v186, s50
  v_perm_b32 v73, v198, v194, s50
  v_perm_b32 v74, v206, v202, s50
  v_perm_b32 v75, v214, v210, s50
  v_perm_b32 v76, v190, v186, s51
  v_perm_b32 v77, v198, v194, s51
  v_perm_b32 v78, v206, v202, s51
  v_perm_b32 v79, v214, v210, s51
  s_nop 1
  v_mfma_f32_16x16x32_bf16 v[56:59], v[72:75], v[20:23], v[56:59]
  v_mfma_f32_16x16x32_bf16 v[60:63], v[76:79], v[20:23], v[60:63]
  s_add_u32 s48, s42, 6
  s_and_b32 s48, s48, 7
  s_lshl_b32 s47, s48, 18
  s_add_u32 s47, s47, s85
  buffer_load_dwordx4 v[152:155], v87, s[32:35], s47 offen
  v_perm_b32 v72, v191, v187, s50
  v_perm_b32 v73, v199, v195, s50
  v_perm_b32 v74, v207, v203, s50
  v_perm_b32 v75, v215, v211, s50
  v_perm_b32 v76, v191, v187, s51
  v_perm_b32 v77, v199, v195, s51
  v_perm_b32 v78, v207, v203, s51
  v_perm_b32 v79, v215, v211, s51
  s_nop 1
  v_mfma_f32_16x16x32_bf16 v[64:67], v[72:75], v[20:23], v[64:67]
  v_mfma_f32_16x16x32_bf16 v[68:71], v[76:79], v[20:23], v[68:71]
  s_add_u32 s47, s47, 0x2000
  buffer_load_dwordx4 v[156:159], v87, s[32:35], s47 offen
  s_add_u32 s47, s47, 0x2000
  buffer_load_dwordx4 v[160:163], v87, s[32:35], s47 offen
  s_add_u32 s47, s47, 0x2000
  buffer_load_dwordx4 v[164:167], v87, s[32:35], s47 offen
  s_add_u32 s47, s47, 0x2000
  buffer_load_dwordx4 v[168:171], v87, s[32:35], s47 offen
  s_add_u32 s47, s47, 0x2000
  buffer_load_dwordx4 v[172:175], v87, s[32:35], s47 offen
  s_waitcnt vmcnt(14)
  v_perm_b32 v72, v92, v88, s50
  v_perm_b32 v73, v100, v96, s50
  v_perm_b32 v74, v108, v104, s50
  v_perm_b32 v75, v116, v112, s50
  v_perm_b32 v76, v92, v88, s51
  v_perm_b32 v77, v100, v96, s51
  v_perm_b32 v78, v108, v104, s51
  v_perm_b32 v79, v116, v112, s51
  s_nop 1
  v_mfma_f32_16x16x32_bf16 v[40:43], v[72:75], v[24:27], v[40:43]
  v_mfma_f32_16x16x32_bf16 v[44:47], v[76:79], v[24:27], v[44:47]
  s_add_u32 s47, s47, 0x2000
  buffer_load_dwordx4 v[176:179], v87, s[32:35], s47 offen
  v_perm_b32 v72, v93, v89, s50
  v_perm_b32 v73, v101, v97, s50
  v_perm_b32 v74, v109, v105, s50
  v_perm_b32 v75, v117, v113, s50
  v_perm_b32 v76, v93, v89, s51
  v_perm_b32 v77, v101, v97, s51
  v_perm_b32 v78, v109, v105, s51
  v_perm_b32 v79, v117, v113, s51
  s_nop 1
  v_mfma_f32_16x16x32_bf16 v[48:51], v[72:75], v[24:27], v[48:51]
  v_mfma_f32_16x16x32_bf16 v[52:55], v[76:79], v[24:27], v[52:55]
  s_add_u32 s47, s47, 0x2000
  buffer_load_dwordx4 v[180:183], v87, s[32:35], s47 offen
  v_perm_b32 v72, v94, v90, s50
  v_perm_b32 v73, v102, v98, s50
  v_perm_b32 v74, v110, v106, s50
  v_perm_b32 v75, v118, v114, s50
  v_perm_b32 v76, v94, v90, s51
  v_perm_b32 v77, v102, v98, s51
  v_perm_b32 v78, v110, v106, s51
  v_perm_b32 v79, v118, v114, s51
  s_nop 1
  v_mfma_f32_16x16x32_bf16 v[56:59], v[72:75], v[24:27], v[56:59]
  v_mfma_f32_16x16x32_bf16 v[60:63], v[76:79], v[24:27], v[60:63]
  s_add_u32 s48, s42, 7
  s_and_b32 s48, s48, 7
  s_lshl_b32 s47, s48, 18
  s_add_u32 s47, s47, s85
  buffer_load_dwordx4 v[184:187], v87, s[32:35], s47 offen
  v_perm_b32 v72, v95, v91, s50
  v_perm_b32 v73, v103, v99, s50
  v_perm_b32 v74, v111, v107, s50
  v_perm_b32 v75, v119, v115, s50
  v_perm_b32 v76, v95, v91, s51
  v_perm_b32 v77, v103, v99, s51
  v_perm_b32 v78, v111, v107, s51
  v_perm_b32 v79, v119, v115, s51
  s_nop 1
  v_mfma_f32_16x16x32_bf16 v[64:67], v[72:75], v[24:27], v[64:67]
  v_mfma_f32_16x16x32_bf16 v[68:71], v[76:79], v[24:27], v[68:71]
  s_add_u32 s47, s47, 0x2000
  buffer_load_dwordx4 v[188:191], v87, s[32:35], s47 offen
  s_add_u32 s47, s47, 0x2000
  buffer_load_dwordx4 v[192:195], v87, s[32:35], s47 offen
  s_add_u32 s47, s47, 0x2000
  buffer_load_dwordx4 v[196:199], v87, s[32:35], s47 offen
  s_add_u32 s47, s47, 0x2000
  buffer_load_dwordx4 v[200:203], v87, s[32:35], s47 offen
  s_add_u32 s47, s47, 0x2000
  buffer_load_dwordx4 v[204:207], v87, s[32:35], s47 offen
  s_waitcnt vmcnt(14)
  v_perm_b32 v72, v124, v120, s50
  v_perm_b32 v73, v132, v128, s50
  v_perm_b32 v74, v140, v136, s50
  v_perm_b32 v75, v148, v144, s50
  v_perm_b32 v76, v124, v120, s51
  v_perm_b32 v77, v132, v128, s51
  v_perm_b32 v78, v140, v136, s51
  v_perm_b32 v79, v148, v144, s51
  s_nop 1
  v_mfma_f32_16x16x32_bf16 v[40:43], v[72:75], v[28:31], v[40:43]
  v_mfma_f32_16x16x32_bf16 v[44:47], v[76:79], v[28:31], v[44:47]
  s_add_u32 s47, s47, 0x2000
  buffer_load_dwordx4 v[208:211], v87, s[32:35], s47 offen
  v_perm_b32 v72, v125, v121, s50
  v_perm_b32 v73, v133, v129, s50
  v_perm_b32 v74, v141, v137, s50
  v_perm_b32 v75, v149, v145, s50
  v_perm_b32 v76, v125, v121, s51
  v_perm_b32 v77, v133, v129, s51
  v_perm_b32 v78, v141, v137, s51
  v_perm_b32 v79, v149, v145, s51
  s_nop 1
  v_mfma_f32_16x16x32_bf16 v[48:51], v[72:75], v[28:31], v[48:51]
  v_mfma_f32_16x16x32_bf16 v[52:55], v[76:79], v[28:31], v[52:55]
  s_add_u32 s47, s47, 0x2000
  buffer_load_dwordx4 v[212:215], v87, s[32:35], s47 offen
  v_perm_b32 v72, v126, v122, s50
  v_perm_b32 v73, v134, v130, s50
  v_perm_b32 v74, v142, v138, s50
  v_perm_b32 v75, v150, v146, s50
  v_perm_b32 v76, v126, v122, s51
  v_perm_b32 v77, v134, v130, s51
  v_perm_b32 v78, v142, v138, s51
  v_perm_b32 v79, v150, v146, s51
  s_nop 1
  v_mfma_f32_16x16x32_bf16 v[56:59], v[72:75], v[28:31], v[56:59]
  v_mfma_f32_16x16x32_bf16 v[60:63], v[76:79], v[28:31], v[60:63]
  s_add_u32 s77, s44, 0x1000
  buffer_load_dwordx4 a[112:115], v1, s[24:27], s77 offen offset:0 nt
  v_perm_b32 v72, v127, v123, s50
  v_perm_b32 v73, v135, v131, s50
  v_perm_b32 v74, v143, v139, s50
  v_perm_b32 v75, v151, v147, s50
  v_perm_b32 v76, v127, v123, s51
  v_perm_b32 v77, v135, v131, s51
  v_perm_b32 v78, v143, v139, s51
  v_perm_b32 v79, v151, v147, s51
  s_nop 1
  v_mfma_f32_16x16x32_bf16 v[64:67], v[72:75], v[28:31], v[64:67]
  v_mfma_f32_16x16x32_bf16 v[68:71], v[76:79], v[28:31], v[68:71]
  s_add_u32 s77, s44, 0x1000
  buffer_load_dwordx4 a[116:119], v1, s[24:27], s77 offen offset:1024 nt
  s_add_u32 s77, s44, 0x1000
  buffer_load_dwordx4 a[120:123], v1, s[24:27], s77 offen offset:2048 nt
  s_add_u32 s77, s44, 0x1000
  buffer_load_dwordx4 a[124:127], v1, s[24:27], s77 offen offset:3072 nt
  s_or_b32 s44, s44, 0x17f00
  s_add_u32 s44, s44, 0x100
  s_and_b32 s44, s44, 0x68000
  s_or_b32 s44, s44, s78
  buffer_load_dwordx4 a[128:131], v1, s[24:27], s44 offen offset:0 nt
  buffer_load_dwordx4 a[132:135], v1, s[24:27], s44 offen offset:1024 nt
  s_waitcnt vmcnt(14)
  v_perm_b32 v72, v156, v152, s50
  v_perm_b32 v73, v164, v160, s50
  v_perm_b32 v74, v172, v168, s50
  v_perm_b32 v75, v180, v176, s50
  v_perm_b32 v76, v156, v152, s51
  v_perm_b32 v77, v164, v160, s51
  v_perm_b32 v78, v172, v168, s51
  v_perm_b32 v79, v180, v176, s51
  s_nop 1
  v_mfma_f32_16x16x32_bf16 v[40:43], v[72:75], v[32:35], v[40:43]
  v_mfma_f32_16x16x32_bf16 v[44:47], v[76:79], v[32:35], v[44:47]
  buffer_load_dwordx4 a[136:139], v1, s[24:27], s44 offen offset:2048 nt
  v_perm_b32 v72, v157, v153, s50
  v_perm_b32 v73, v165, v161, s50
  v_perm_b32 v74, v173, v169, s50
  v_perm_b32 v75, v181, v177, s50
  v_perm_b32 v76, v157, v153, s51
  v_perm_b32 v77, v165, v161, s51
  v_perm_b32 v78, v173, v169, s51
  v_perm_b32 v79, v181, v177, s51
  s_nop 1
  v_mfma_f32_16x16x32_bf16 v[48:51], v[72:75], v[32:35], v[48:51]
  v_mfma_f32_16x16x32_bf16 v[52:55], v[76:79], v[32:35], v[52:55]
  buffer_load_dwordx4 a[140:143], v1, s[24:27], s44 offen offset:3072 nt
  v_perm_b32 v72, v158, v154, s50
  v_perm_b32 v73, v166, v162, s50
  v_perm_b32 v74, v174, v170, s50
  v_perm_b32 v75, v182, v178, s50
  v_perm_b32 v76, v158, v154, s51
  v_perm_b32 v77, v166, v162, s51
  v_perm_b32 v78, v174, v170, s51
  v_perm_b32 v79, v182, v178, s51
  s_nop 1
  v_mfma_f32_16x16x32_bf16 v[56:59], v[72:75], v[32:35], v[56:59]
  v_mfma_f32_16x16x32_bf16 v[60:63], v[76:79], v[32:35], v[60:63]
  s_add_u32 s77, s44, 0x1000
  buffer_load_dwordx4 a[144:147], v1, s[24:27], s77 offen offset:0 nt
  v_perm_b32 v72, v159, v155, s50
  v_perm_b32 v73, v167, v163, s50
  v_perm_b32 v74, v175, v171, s50
  v_perm_b32 v75, v183, v179, s50
  v_perm_b32 v76, v159, v155, s51
  v_perm_b32 v77, v167, v163, s51
  v_perm_b32 v78, v175, v171, s51
  v_perm_b32 v79, v183, v179, s51
  s_nop 1
  v_mfma_f32_16x16x32_bf16 v[64:67], v[72:75], v[32:35], v[64:67]
  v_mfma_f32_16x16x32_bf16 v[68:71], v[76:79], v[32:35], v[68:71]
  s_add_u32 s77, s44, 0x1000
  buffer_load_dwordx4 a[148:151], v1, s[24:27], s77 offen offset:1024 nt
  s_waitcnt vmcnt(9)
  s_add_u32 s77, s44, 0x1000
  buffer_load_dwordx4 a[152:155], v1, s[24:27], s77 offen offset:2048 nt
  s_waitcnt vmcnt(9)
  s_add_u32 s77, s44, 0x1000
  buffer_load_dwordx4 a[156:159], v1, s[24:27], s77 offen offset:3072 nt
  s_or_b32 s44, s44, 0x17f00
  s_add_u32 s44, s44, 0x100
  s_and_b32 s44, s44, 0x68000
  s_or_b32 s44, s44, s78
  s_waitcnt vmcnt(9)
  buffer_load_dwordx4 a[160:163], v1, s[24:27], s44 offen offset:0 nt
  s_waitcnt vmcnt(9)
  buffer_load_dwordx4 a[164:167], v1, s[24:27], s44 offen offset:1024 nt
  v_perm_b32 v72, v188, v184, s50
  v_perm_b32 v73, v196, v192, s50
  v_perm_b32 v74, v204, v200, s50
  v_perm_b32 v75, v212, v208, s50
  v_perm_b32 v76, v188, v184, s51
  v_perm_b32 v77, v196, v192, s51
  v_perm_b32 v78, v204, v200, s51
  v_perm_b32 v79, v212, v208, s51
  s_nop 1
  v_mfma_f32_16x16x32_bf16 v[40:43], v[72:75], v[36:39], v[40:43]
  v_mfma_f32_16x16x32_bf16 v[44:47], v[76:79], v[36:39], v[44:47]
  s_waitcnt vmcnt(9)
  buffer_load_dwordx4 a[168:171], v1, s[24:27], s44 offen offset:2048 nt
  v_perm_b32 v72, v189, v185, s50
  v_perm_b32 v73, v197, v193, s50
  v_perm_b32 v74, v205, v201, s50
  v_perm_b32 v75, v213, v209, s50
  v_perm_b32 v76, v189, v185, s51
  v_perm_b32 v77, v197, v193, s51
  v_perm_b32 v78, v205, v201, s51
  v_perm_b32 v79, v213, v209, s51
  s_nop 1
  v_mfma_f32_16x16x32_bf16 v[48:51], v[72:75], v[36:39], v[48:51]
  v_mfma_f32_16x16x32_bf16 v[52:55], v[76:79], v[36:39], v[52:55]
  s_waitcnt vmcnt(9)
  buffer_load_dwordx4 a[172:175], v1, s[24:27], s44 offen offset:3072 nt
  v_perm_b32 v72, v190, v186, s50
  v_perm_b32 v73, v198, v194, s50
  v_perm_b32 v74, v206, v202, s50
  v_perm_b32 v75, v214, v210, s50
  v_perm_b32 v76, v190, v186, s51
  v_perm_b32 v77, v198, v194, s51
  v_perm_b32 v78, v206, v202, s51
  v_perm_b32 v79, v214, v210, s51
  s_nop 1
  v_mfma_f32_16x16x32_bf16 v[56:59], v[72:75], v[36:39], v[56:59]
  v_mfma_f32_16x16x32_bf16 v[60:63], v[76:79], v[36:39], v[60:63]
  s_waitcnt vmcnt(9)
  s_add_u32 s77, s44, 0x1000
  buffer_load_dwordx4 a[176:179], v1, s[24:27], s77 offen offset:0 nt
  v_perm_b32 v72, v191, v187, s50
  v_perm_b32 v73, v199, v195, s50
  v_perm_b32 v74, v207, v203, s50
  v_perm_b32 v75, v215, v211, s50
  v_perm_b32 v76, v191, v187, s51
  v_perm_b32 v77, v199, v195, s51
  v_perm_b32 v78, v207, v203, s51
  v_perm_b32 v79, v215, v211, s51
  s_nop 1
  v_mfma_f32_16x16x32_bf16 v[64:67], v[72:75], v[36:39], v[64:67]
  v_mfma_f32_16x16x32_bf16 v[68:71], v[76:79], v[36:39], v[68:71]
  s_waitcnt vmcnt(9)
  s_add_u32 s77, s44, 0x1000
  buffer_load_dwordx4 a[180:183], v1, s[24:27], s77 offen offset:1024 nt
  s_lshl_b32 s48, s40, 13
  v_add_u32 v8, s48, v2
  s_lshl_b32 s48, s40, 11
  v_add_u32 v9, s48, v2
  v_lshlrev_b32 v10, 10, v7
  v_lshl_add_u32 v10, v6, 4, v10
  s_lshl_b32 s48, s40, 2
  s_add_u32 s48, s48, 0x19000
  v_add_u32 v10, s48, v10
  s_mov_b32 s20, s18
  s_mov_b32 s21, s19
  s_cmp_lt_u32 s40, 2
  s_cselect_b32 s22, 0x1c00000, 0
  s_nop 7
  ds_write_b128 v8, v[40:43] offset:0
  ds_write_b128 v8, v[44:47] offset:1024
  ds_write_b128 v8, v[48:51] offset:2048
  ds_write_b128 v8, v[52:55] offset:3072
  ds_write_b128 v8, v[56:59] offset:4096
  ds_write_b128 v8, v[60:63] offset:5120
  ds_write_b128 v8, v[64:67] offset:6144
  ds_write_b128 v8, v[68:71] offset:7168
  s_waitcnt vmcnt(9)
  s_add_u32 s77, s44, 0x1000
  buffer_load_dwordx4 a[184:187], v1, s[24:27], s77 offen offset:2048 nt
  s_waitcnt vmcnt(9)
  s_add_u32 s77, s44, 0x1000
  buffer_load_dwordx4 a[188:191], v1, s[24:27], s77 offen offset:3072 nt
  s_or_b32 s44, s44, 0x17f00
  s_add_u32 s44, s44, 0x100
  s_and_b32 s44, s44, 0x68000
  s_or_b32 s44, s44, s78
  s_waitcnt lgkmcnt(0)
  s_barrier
  ds_read_b128 v[40:43], v9 offset:0
  ds_read_b128 v[44:47], v9 offset:1024
  ds_read_b128 v[48:51], v9 offset:8192
  ds_read_b128 v[52:55], v9 offset:9216
  ds_read_b128 v[56:59], v9 offset:16384
  ds_read_b128 v[60:63], v9 offset:17408
  ds_read_b128 v[64:67], v9 offset:24576
  ds_read_b128 v[68:71], v9 offset:25600
  s_waitcnt vmcnt(9)
  buffer_load_dwordx4 a[192:195], v1, s[24:27], s44 offen offset:0 nt
  s_waitcnt lgkmcnt(0)
  v_add_f32 v40, v40, v48
  v_add_f32 v56, v56, v64
  v_add_f32 v41, v41, v49
  v_add_f32 v57, v57, v65
  v_add_f32 v42, v42, v50
  v_add_f32 v58, v58, v66
  v_add_f32 v43, v43, v51
  v_add_f32 v59, v59, v67
  v_add_f32 v44, v44, v52
  v_add_f32 v60, v60, v68
  v_add_f32 v45, v45, v53
  v_add_f32 v61, v61, v69
  v_add_f32 v46, v46, v54
  v_add_f32 v62, v62, v70
  v_add_f32 v47, v47, v55
  v_add_f32 v63, v63, v71
  v_add_f32 v40, v40, v56
  v_add_f32 v41, v41, v57
  v_add_f32 v42, v42, v58
  v_add_f32 v43, v43, v59
  v_add_f32 v44, v44, v60
  v_add_f32 v45, v45, v61
  v_add_f32 v46, v46, v62
  v_add_f32 v47, v47, v63
  v_cvt_pk_bf16_f32 v12, v40, v44
  v_cvt_pk_bf16_f32 v13, v41, v45
  v_cvt_pk_bf16_f32 v14, v42, v46
  v_cvt_pk_bf16_f32 v15, v43, v47
  ds_write_b32 v10, v12 offset:0
  ds_write_b32 v10, v13 offset:256
  ds_write_b32 v10, v14 offset:512
  ds_write_b32 v10, v15 offset:768
  s_waitcnt vmcnt(9)
  buffer_load_dwordx4 a[196:199], v1, s[24:27], s44 offen offset:1024 nt
  s_waitcnt lgkmcnt(0)
  s_barrier
  ds_read_b128 v[24:27], v82 offset:0
  ds_read_b128 v[28:31], v82 offset:512
  ds_read_b128 v[32:35], v82 offset:128
  ds_read_b128 v[36:39], v82 offset:640
  v_mov_b32 v40, 0
  v_mov_b32 v41, 0
  v_mov_b32 v42, 0
  v_mov_b32 v43, 0
  v_mov_b32 v44, 0
  v_mov_b32 v45, 0
  v_mov_b32 v46, 0
  v_mov_b32 v47, 0
  v_mov_b32 v48, 0
  v_mov_b32 v49, 0
  v_mov_b32 v50, 0
  v_mov_b32 v51, 0
  v_mov_b32 v52, 0
  v_mov_b32 v53, 0
  v_mov_b32 v54, 0
  v_mov_b32 v55, 0
  v_mov_b32 v56, 0
  v_mov_b32 v57, 0
  v_mov_b32 v58, 0
  v_mov_b32 v59, 0
  v_mov_b32 v60, 0
  v_mov_b32 v61, 0
  v_mov_b32 v62, 0
  v_mov_b32 v63, 0
  v_mov_b32 v64, 0
  v_mov_b32 v65, 0
  v_mov_b32 v66, 0
  v_mov_b32 v67, 0
  v_mov_b32 v68, 0
  v_mov_b32 v69, 0
  v_mov_b32 v70, 0
  v_mov_b32 v71, 0
  v_mov_b32 v5, 0xff800000
  v_mov_b32 v6, 0
  s_waitcnt lgkmcnt(0)
  s_waitcnt vmcnt(9)
  buffer_load_dwordx4 a[200:203], v1, s[24:27], s44 offen offset:2048 nt
  s_waitcnt vmcnt(9)
  buffer_load_dwordx4 a[204:207], v1, s[24:27], s44 offen offset:3072 nt
  s_waitcnt vmcnt(9)
  s_add_u32 s77, s44, 0x1000
  buffer_load_dwordx4 a[208:211], v1, s[24:27], s77 offen offset:0 nt
  s_waitcnt vmcnt(9)
  s_add_u32 s77, s44, 0x1000
  buffer_load_dwordx4 a[212:215], v1, s[24:27], s77 offen offset:1024 nt
  s_waitcnt vmcnt(9)
  s_add_u32 s77, s44, 0x1000
  buffer_load_dwordx4 a[216:219], v1, s[24:27], s77 offen offset:2048 nt
  s_waitcnt vmcnt(9)
  s_add_u32 s77, s44, 0x1000
  buffer_load_dwordx4 a[220:223], v1, s[24:27], s77 offen offset:3072 nt
  s_or_b32 s44, s44, 0x17f00
  s_add_u32 s44, s44, 0x100
  s_and_b32 s44, s44, 0x68000
  s_or_b32 s44, s44, s78
  s_waitcnt vmcnt(9)
  buffer_load_dwordx4 a[224:227], v1, s[24:27], s44 offen offset:0 nt
  s_waitcnt vmcnt(9)
  buffer_load_dwordx4 a[228:231], v1, s[24:27], s44 offen offset:1024 nt
  s_waitcnt vmcnt(9)
  buffer_load_dwordx4 a[232:235], v1, s[24:27], s44 offen offset:2048 nt
  s_waitcnt vmcnt(9)
  buffer_load_dwordx4 a[236:239], v1, s[24:27], s44 offen offset:3072 nt
  s_waitcnt vmcnt(9)
  s_add_u32 s77, s44, 0x1000
  buffer_load_dwordx4 a[240:243], v1, s[24:27], s77 offen offset:0 nt
  s_waitcnt vmcnt(9)
  s_add_u32 s77, s44, 0x1000
  buffer_load_dwordx4 a[244:247], v1, s[24:27], s77 offen offset:1024 nt
  s_waitcnt vmcnt(9)
  s_add_u32 s77, s44, 0x1000
  buffer_load_dwordx4 a[248:251], v1, s[24:27], s77 offen offset:2048 nt
  s_waitcnt vmcnt(9)
  s_add_u32 s77, s44, 0x1000
  buffer_load_dwordx4 a[252:255], v1, s[24:27], s77 offen offset:3072 nt
  s_or_b32 s44, s44, 0x17f00
  s_add_u32 s44, s44, 0x100
  s_and_b32 s44, s44, 0x68000
  s_or_b32 s44, s44, s78
  s_or_b32 s44, s44, 0x4000
  s_waitcnt vmcnt(5)
  buffer_load_dwordx4 v[88:91], v1, s[24:27], s44 offen offset:0 nt
  s_waitcnt vmcnt(5)
  buffer_load_dwordx4 v[92:95], v1, s[24:27], s44 offen offset:1024 nt
  s_waitcnt vmcnt(5)
  buffer_load_dwordx4 v[96:99], v1, s[24:27], s44 offen offset:2048 nt
  s_waitcnt vmcnt(5)
  buffer_load_dwordx4 v[100:103], v1, s[24:27], s44 offen offset:3072 nt
  s_waitcnt vmcnt(5)
  s_add_u32 s77, s44, 0x1000
  buffer_load_dwordx4 v[104:107], v1, s[24:27], s77 offen offset:0 nt
  s_waitcnt vmcnt(5)
  s_add_u32 s77, s44, 0x1000
  buffer_load_dwordx4 v[108:111], v1, s[24:27], s77 offen offset:1024 nt
  s_waitcnt vmcnt(5)
  s_add_u32 s77, s44, 0x1000
  buffer_load_dwordx4 v[112:115], v1, s[24:27], s77 offen offset:2048 nt
  s_waitcnt vmcnt(5)
  s_add_u32 s77, s44, 0x1000
  buffer_load_dwordx4 v[116:119], v1, s[24:27], s77 offen offset:3072 nt
  s_or_b32 s44, s44, 0x17f00
  s_add_u32 s44, s44, 0x100
  s_and_b32 s44, s44, 0x68000
  s_or_b32 s44, s44, s78
  s_or_b32 s44, s44, 0x4000
  s_waitcnt vmcnt(8)
  s_branch L_pJ
L_pc56:
  buffer_load_dwordx4 a[0:3], v1, s[24:27], s44 offen offset:0 nt
  buffer_load_dwordx4 a[4:7], v1, s[24:27], s44 offen offset:1024 nt
  buffer_load_dwordx4 a[8:11], v1, s[24:27], s44 offen offset:2048 nt
  buffer_load_dwordx4 a[12:15], v1, s[24:27], s44 offen offset:3072 nt
  s_add_u32 s77, s44, 0x1000
  buffer_load_dwordx4 a[16:19], v1, s[24:27], s77 offen offset:0 nt
  s_add_u32 s77, s44, 0x1000
  buffer_load_dwordx4 a[20:23], v1, s[24:27], s77 offen offset:1024 nt
  s_add_u32 s77, s44, 0x1000
  buffer_load_dwordx4 a[24:27], v1, s[24:27], s77 offen offset:2048 nt
  s_add_u32 s77, s44, 0x1000
  buffer_load_dwordx4 a[28:31], v1, s[24:27], s77 offen offset:3072 nt
  s_or_b32 s44, s44, 0x17f00
  s_add_u32 s44, s44, 0x100
  s_and_b32 s44, s44, 0x68000
  s_or_b32 s44, s44, s78
  buffer_load_dwordx4 a[32:35], v1, s[24:27], s44 offen offset:0 nt
  buffer_load_dwordx4 a[36:39], v1, s[24:27], s44 offen offset:1024 nt
  v_lshl_add_u32 v241, v7, 6, v243
  v_lshlrev_b32 v241, 4, v241
  v_lshl_add_u32 v241, v242, 8, v241
  v_add_u32 v82, 0x19000, v241
  v_mov_b32 v248, 0x1a000
  v_mov_b32 v83, 0
  ds_write_b32 v248, v83
  ds_write_b32 v248, v83 offset:4
  ds_write_b32 v248, v83 offset:8
  ds_write_b32 v248, v83 offset:12
  ds_write_b32 v248, v83 offset:16
  ds_write_b32 v248, v83 offset:24
  ds_write_b32 v248, v83 offset:28
  v_lshl_add_u32 v241, v243, 2, v248
  ds_write_b32 v241, v83 offset:32
  v_lshl_add_u32 v241, v7, 3, v243
  v_lshlrev_b32 v241, 4, v241
  s_lshl_b32 s48, s40, 12
  s_add_u32 s48, s48, 0x8000
  v_add_u32 v80, s48, v241
  s_lshl_b32 s48, s40, 8
  s_add_u32 s48, s48, 0x18000
  v_lshlrev_b32 v241, 2, v5
  v_add_u32 v81, s48, v241
  v_lshrrev_b32 v241, 3, v5
  v_lshlrev_b32 v85, 11, v241
  v_lshl_add_u32 v85, v243, 4, v85
  v_and_b32 v241, 1, v7
  v_lshlrev_b32 v84, 5, v241
  v_xor_b32 v85, v85, v84
  v_bfe_u32 v241, v6, 2, 1
  v_lshl_add_u32 v84, v241, 6, v84
  v_lshrrev_b32 v241, 2, v6
  v_lshl_add_u32 v84, v241, 10, v84
  v_lshl_add_u32 v84, v7, 8, v84
  v_lshl_add_u32 v84, v242, 7, v84
  v_lshl_add_u32 v84, v240, 1, v84
  s_lshl_b32 s59, s40, 14
  s_lshr_b32 s48, s40, 1
  s_lshl_b32 s48, s48, 15
  s_add_u32 s59, s59, s48
  s_lshl_b32 s49, s48, 1
  v_add_u32 v84, s49, v84
  v_mov_b32 v83, 1
  s_mov_b32 s52, 0x3e0293ee
  s_mov_b32 s56, 0x00ff00ff
  s_mov_b32 s57, 0x00ff00ff
  s_mov_b32 s36, s18
  s_mov_b32 s37, s19
  s_mov_b32 s38, 0x1c00000
  s_mov_b32 s39, 0x00020000
  s_mov_b32 s60, s12
  s_mov_b32 s61, s13
  s_mov_b32 s62, 0x800000
  s_mov_b32 s63, 0x00020000
  s_mov_b32 s64, s14
  s_mov_b32 s65, s15
  s_mov_b32 s66, 0x40000
  s_mov_b32 s67, 0x00020000
  s_mov_b32 s96, s18
  s_mov_b32 s97, s19
  s_mov_b32 s98, 0x0
  s_mov_b32 s99, 0x00020000
  s_and_b32 s48, s2, 7
  s_lshl_b32 s93, s48, 15
  s_lshl_b32 s58, s48, 20
  s_lshl_b32 s48, s40, 18
  s_add_u32 s58, s58, s48
  s_lshr_b32 s48, s2, 4
  s_lshl_b32 s48, s48, 7
  s_add_u32 s58, s58, s48
  s_and_b32 s48, s2, 8
  s_lshl_b32 s48, s48, 19
  s_add_u32 s93, s93, s48
  s_and_b32 s48, s40, 1
  s_lshl_b32 s48, s48, 21
  s_add_u32 s93, s93, s48
  s_and_b32 s48, s40, 2
  s_lshl_b32 s48, s48, 18
  s_add_u32 s93, s93, s48
  s_add_u32 s93, s93, 0xc00000
  s_lshl_b32 s94, s2, 15
  s_add_u32 s48, s42, 3
  s_and_b32 s48, s48, 3
  s_lshl_b32 s48, s48, 13
  s_add_u32 s94, s94, s48
  s_add_u32 s94, s94, 0xc00000
  s_and_b32 s48, s40, 1
  s_lshl_b32 s48, s48, 10
  s_add_u32 s94, s94, s48
  s_waitcnt vmcnt(9)
  buffer_load_dwordx4 a[40:43], v1, s[24:27], s44 offen offset:2048 nt
  s_waitcnt vmcnt(9)
  buffer_load_dwordx4 a[44:47], v1, s[24:27], s44 offen offset:3072 nt
  s_waitcnt vmcnt(9)
  s_add_u32 s77, s44, 0x1000
  buffer_load_dwordx4 a[48:51], v1, s[24:27], s77 offen offset:0 nt
  s_waitcnt vmcnt(9)
  s_add_u32 s77, s44, 0x1000
  buffer_load_dwordx4 a[52:55], v1, s[24:27], s77 offen offset:1024 nt
  v_perm_b32 v72, v92, v88, s50
  v_perm_b32 v73, v100, v96, s50
  v_perm_b32 v74, v108, v104, s50
  v_perm_b32 v75, v116, v112, s50
  v_perm_b32 v76, v92, v88, s51
  v_perm_b32 v77, v100, v96, s51
  v_perm_b32 v78, v108, v104, s51
  v_perm_b32 v79, v116, v112, s51
  s_nop 1
  v_mfma_f32_16x16x32_bf16 v[40:43], v[72:75], v[8:11], 0
  v_mfma_f32_16x16x32_bf16 v[44:47], v[76:79], v[8:11], 0
  s_waitcnt vmcnt(9)
  s_add_u32 s77, s44, 0x1000
  buffer_load_dwordx4 a[56:59], v1, s[24:27], s77 offen offset:2048 nt
  v_perm_b32 v72, v93, v89, s50
  v_perm_b32 v73, v101, v97, s50
  v_perm_b32 v74, v109, v105, s50
  v_perm_b32 v75, v117, v113, s50
  v_perm_b32 v76, v93, v89, s51
  v_perm_b32 v77, v101, v97, s51
  v_perm_b32 v78, v109, v105, s51
  v_perm_b32 v79, v117, v113, s51
  s_nop 1
  v_mfma_f32_16x16x32_bf16 v[48:51], v[72:75], v[8:11], 0
  v_mfma_f32_16x16x32_bf16 v[52:55], v[76:79], v[8:11], 0
  s_waitcnt vmcnt(9)
  s_add_u32 s77, s44, 0x1000
  buffer_load_dwordx4 a[60:63], v1, s[24:27], s77 offen offset:3072 nt
  s_or_b32 s44, s44, 0x17f00
  s_add_u32 s44, s44, 0x100
  s_and_b32 s44, s44, 0x68000
  s_or_b32 s44, s44, s78
  v_perm_b32 v72, v94, v90, s50
  v_perm_b32 v73, v102, v98, s50
  v_perm_b32 v74, v110, v106, s50
  v_perm_b32 v75, v118, v114, s50
  v_perm_b32 v76, v94, v90, s51
  v_perm_b32 v77, v102, v98, s51
  v_perm_b32 v78, v110, v106, s51
  v_perm_b32 v79, v118, v114, s51
  s_nop 1
  v_mfma_f32_16x16x32_bf16 v[56:59], v[72:75], v[8:11], 0
  v_mfma_f32_16x16x32_bf16 v[60:63], v[76:79], v[8:11], 0
  s_waitcnt vmcnt(9)
  buffer_load_dwordx4 a[64:67], v1, s[24:27], s44 offen offset:0 nt
  v_perm_b32 v72, v95, v91, s50
  v_perm_b32 v73, v103, v99, s50
  v_perm_b32 v74, v111, v107, s50
  v_perm_b32 v75, v119, v115, s50
  v_perm_b32 v76, v95, v91, s51
  v_perm_b32 v77, v103, v99, s51
  v_perm_b32 v78, v111, v107, s51
  v_perm_b32 v79, v119, v115, s51
  s_nop 1
  v_mfma_f32_16x16x32_bf16 v[64:67], v[72:75], v[8:11], 0
  v_mfma_f32_16x16x32_bf16 v[68:71], v[76:79], v[8:11], 0
  s_waitcnt vmcnt(9)
  buffer_load_dwordx4 a[68:71], v1, s[24:27], s44 offen offset:1024 nt
  s_waitcnt vmcnt(9)
  buffer_load_dwordx4 a[72:75], v1, s[24:27], s44 offen offset:2048 nt
  s_waitcnt vmcnt(9)
  buffer_load_dwordx4 a[76:79], v1, s[24:27], s44 offen offset:3072 nt
  s_waitcnt vmcnt(9)
  s_add_u32 s77, s44, 0x1000
  buffer_load_dwordx4 a[80:83], v1, s[24:27], s77 offen offset:0 nt
  s_waitcnt vmcnt(9)
  s_add_u32 s77, s44, 0x1000
  buffer_load_dwordx4 a[84:87], v1, s[24:27], s77 offen offset:1024 nt
  s_waitcnt vmcnt(9)
  s_add_u32 s77, s44, 0x1000
  buffer_load_dwordx4 a[88:91], v1, s[24:27], s77 offen offset:2048 nt
  s_waitcnt vmcnt(9)
  s_add_u32 s77, s44, 0x1000
  buffer_load_dwordx4 a[92:95], v1, s[24:27], s77 offen offset:3072 nt
  s_or_b32 s44, s44, 0x17f00
  s_add_u32 s44, s44, 0x100
  s_and_b32 s44, s44, 0x68000
  s_or_b32 s44, s44, s78
  s_waitcnt vmcnt(9)
  buffer_load_dwordx4 a[96:99], v1, s[24:27], s44 offen offset:0 nt
  s_waitcnt vmcnt(9)
  buffer_load_dwordx4 a[100:103], v1, s[24:27], s44 offen offset:1024 nt
  s_waitcnt vmcnt(9)
  buffer_load_dwordx4 a[104:107], v1, s[24:27], s44 offen offset:2048 nt
  s_waitcnt vmcnt(9)
  buffer_load_dwordx4 a[108:111], v1, s[24:27], s44 offen offset:3072 nt
  s_waitcnt vmcnt(9)
  s_add_u32 s77, s44, 0x1000
  buffer_load_dwordx4 a[112:115], v1, s[24:27], s77 offen offset:0 nt
  s_waitcnt vmcnt(9)
  s_add_u32 s77, s44, 0x1000
  buffer_load_dwordx4 a[116:119], v1, s[24:27], s77 offen offset:1024 nt
  s_waitcnt vmcnt(9)
  s_add_u32 s77, s44, 0x1000
  buffer_load_dwordx4 a[120:123], v1, s[24:27], s77 offen offset:2048 nt
  s_waitcnt vmcnt(9)
  s_add_u32 s77, s44, 0x1000
  buffer_load_dwordx4 a[124:127], v1, s[24:27], s77 offen offset:3072 nt
  s_or_b32 s44, s44, 0x17f00
  s_add_u32 s44, s44, 0x100
  s_and_b32 s44, s44, 0x68000
  s_or_b32 s44, s44, s78
  s_waitcnt vmcnt(9)
  buffer_load_dwordx4 a[128:131], v1, s[24:27], s44 offen offset:0 nt
  s_waitcnt vmcnt(9)
  buffer_load_dwordx4 a[132:135], v1, s[24:27], s44 offen offset:1024 nt
  s_waitcnt vmcnt(9)
  buffer_load_dwordx4 a[136:139], v1, s[24:27], s44 offen offset:2048 nt
  s_waitcnt vmcnt(9)
  buffer_load_dwordx4 a[140:143], v1, s[24:27], s44 offen offset:3072 nt
  s_waitcnt vmcnt(9)
  s_add_u32 s77, s44, 0x1000
  buffer_load_dwordx4 a[144:147], v1, s[24:27], s77 offen offset:0 nt
  s_waitcnt vmcnt(9)
  s_add_u32 s77, s44, 0x1000
  buffer_load_dwordx4 a[148:151], v1, s[24:27], s77 offen offset:1024 nt
  s_waitcnt vmcnt(9)
  s_add_u32 s77, s44, 0x1000
  buffer_load_dwordx4 a[152:155], v1, s[24:27], s77 offen offset:2048 nt
  s_waitcnt vmcnt(9)
  s_add_u32 s77, s44, 0x1000
  buffer_load_dwordx4 a[156:159], v1, s[24:27], s77 offen offset:3072 nt
  s_or_b32 s44, s44, 0x17f00
  s_add_u32 s44, s44, 0x100
  s_and_b32 s44, s44, 0x68000
  s_or_b32 s44, s44, s78
  s_waitcnt vmcnt(9)
  buffer_load_dwordx4 a[160:163], v1, s[24:27], s44 offen offset:0 nt
  s_waitcnt vmcnt(9)
  buffer_load_dwordx4 a[164:167], v1, s[24:27], s44 offen offset:1024 nt
  s_waitcnt vmcnt(9)
  buffer_load_dwordx4 a[168:171], v1, s[24:27], s44 offen offset:2048 nt
  s_waitcnt vmcnt(9)
  buffer_load_dwordx4 a[172:175], v1, s[24:27], s44 offen offset:3072 nt
  s_waitcnt vmcnt(9)
  s_add_u32 s77, s44, 0x1000
  buffer_load_dwordx4 a[176:179], v1, s[24:27], s77 offen offset:0 nt
  s_waitcnt vmcnt(9)
  s_add_u32 s77, s44, 0x1000
  buffer_load_dwordx4 a[180:183], v1, s[24:27], s77 offen offset:1024 nt
  s_waitcnt vmcnt(9)
  s_add_u32 s77, s44, 0x1000
  buffer_load_dwordx4 a[184:187], v1, s[24:27], s77 offen offset:2048 nt
  s_waitcnt vmcnt(9)
  s_add_u32 s77, s44, 0x1000
  buffer_load_dwordx4 a[188:191], v1, s[24:27], s77 offen offset:3072 nt
  s_or_b32 s44, s44, 0x17f00
  s_add_u32 s44, s44, 0x100
  s_and_b32 s44, s44, 0x68000
  s_or_b32 s44, s44, s78
  s_waitcnt vmcnt(9)
  buffer_load_dwordx4 a[192:195], v1, s[24:27], s44 offen offset:0 nt
  s_waitcnt vmcnt(9)
  buffer_load_dwordx4 a[196:199], v1, s[24:27], s44 offen offset:1024 nt
  s_waitcnt vmcnt(9)
  buffer_load_dwordx4 a[200:203], v1, s[24:27], s44 offen offset:2048 nt
  s_waitcnt vmcnt(9)
  buffer_load_dwordx4 a[204:207], v1, s[24:27], s44 offen offset:3072 nt
  s_waitcnt vmcnt(9)
  s_add_u32 s77, s44, 0x1000
  buffer_load_dwordx4 a[208:211], v1, s[24:27], s77 offen offset:0 nt
  s_waitcnt vmcnt(9)
  s_add_u32 s77, s44, 0x1000
  buffer_load_dwordx4 a[212:215], v1, s[24:27], s77 offen offset:1024 nt
  s_waitcnt vmcnt(9)
  s_add_u32 s77, s44, 0x1000
  buffer_load_dwordx4 a[216:219], v1, s[24:27], s77 offen offset:2048 nt
  s_waitcnt vmcnt(9)
  s_add_u32 s77, s44, 0x1000
  buffer_load_dwordx4 a[220:223], v1, s[24:27], s77 offen offset:3072 nt
  s_or_b32 s44, s44, 0x17f00
  s_add_u32 s44, s44, 0x100
  s_and_b32 s44, s44, 0x68000
  s_or_b32 s44, s44, s78
  s_add_u32 s48, s42, 1
  s_and_b32 s48, s48, 7
  s_lshl_b32 s48, s48, 6
  s_add_u32 s48, s48, s84
  buffer_load_dwordx4 v[12:15], v86, s[20:23], s48 offen
  s_add_u32 s48, s42, 2
  s_and_b32 s48, s48, 7
  s_lshl_b32 s48, s48, 6
  s_add_u32 s48, s48, s84
  buffer_load_dwordx4 v[16:19], v86, s[20:23], s48 offen
  s_add_u32 s48, s42, 3
  s_and_b32 s48, s48, 7
  s_lshl_b32 s48, s48, 6
  s_add_u32 s48, s48, s84
  buffer_load_dwordx4 v[20:23], v86, s[20:23], s48 offen
  s_add_u32 s48, s42, 4
  s_and_b32 s48, s48, 7
  s_lshl_b32 s48, s48, 6
  s_add_u32 s48, s48, s84
  buffer_load_dwordx4 v[24:27], v86, s[20:23], s48 offen
  s_add_u32 s48, s42, 5
  s_and_b32 s48, s48, 7
  s_lshl_b32 s48, s48, 6
  s_add_u32 s48, s48, s84
  buffer_load_dwordx4 v[28:31], v86, s[20:23], s48 offen
  s_add_u32 s48, s42, 6
  s_and_b32 s48, s48, 7
  s_lshl_b32 s48, s48, 6
  s_add_u32 s48, s48, s84
  buffer_load_dwordx4 v[32:35], v86, s[20:23], s48 offen
  s_add_u32 s48, s42, 7
  s_and_b32 s48, s48, 7
  s_lshl_b32 s48, s48, 6
  s_add_u32 s48, s48, s84
  buffer_load_dwordx4 v[36:39], v86, s[20:23], s48 offen
  s_add_u32 s48, s42, 1
  s_and_b32 s48, s48, 7
  s_lshl_b32 s47, s48, 18
  s_add_u32 s47, s47, s85
  buffer_load_dwordx4 v[120:123], v87, s[32:35], s47 offen
  s_add_u32 s47, s47, 0x2000
  buffer_load_dwordx4 v[124:127], v87, s[32:35], s47 offen
  s_add_u32 s47, s47, 0x2000
  buffer_load_dwordx4 v[128:131], v87, s[32:35], s47 offen
  s_add_u32 s47, s47, 0x2000
  buffer_load_dwordx4 v[132:135], v87, s[32:35], s47 offen
  s_add_u32 s47, s47, 0x2000
  buffer_load_dwordx4 v[136:139], v87, s[32:35], s47 offen
  s_add_u32 s47, s47, 0x2000
  buffer_load_dwordx4 v[140:143], v87, s[32:35], s47 offen
  s_add_u32 s47, s47, 0x2000
  buffer_load_dwordx4 v[144:147], v87, s[32:35], s47 offen
  s_add_u32 s47, s47, 0x2000
  buffer_load_dwordx4 v[148:151], v87, s[32:35], s47 offen
  s_add_u32 s48, s42, 2
  s_and_b32 s48, s48, 7
  s_lshl_b32 s47, s48, 18
  s_add_u32 s47, s47, s85
  buffer_load_dwordx4 v[152:155], v87, s[32:35], s47 offen
  s_add_u32 s47, s47, 0x2000
  buffer_load_dwordx4 v[156:159], v87, s[32:35], s47 offen
  s_add_u32 s47, s47, 0x2000
  buffer_load_dwordx4 v[160:163], v87, s[32:35], s47 offen
  s_add_u32 s47, s47, 0x2000
  buffer_load_dwordx4 v[164:167], v87, s[32:35], s47 offen
  s_add_u32 s47, s47, 0x2000
  buffer_load_dwordx4 v[168:171], v87, s[32:35], s47 offen
  s_add_u32 s47, s47, 0x2000
  buffer_load_dwordx4 v[172:175], v87, s[32:35], s47 offen
  s_add_u32 s47, s47, 0x2000
  buffer_load_dwordx4 v[176:179], v87, s[32:35], s47 offen
  s_add_u32 s47, s47, 0x2000
  buffer_load_dwordx4 v[180:183], v87, s[32:35], s47 offen
  s_add_u32 s48, s42, 3
  s_and_b32 s48, s48, 7
  s_lshl_b32 s47, s48, 18
  s_add_u32 s47, s47, s85
  buffer_load_dwordx4 v[184:187], v87, s[32:35], s47 offen
  s_add_u32 s47, s47, 0x2000
  buffer_load_dwordx4 v[188:191], v87, s[32:35], s47 offen
  s_add_u32 s47, s47, 0x2000
  buffer_load_dwordx4 v[192:195], v87, s[32:35], s47 offen
  s_add_u32 s47, s47, 0x2000
  buffer_load_dwordx4 v[196:199], v87, s[32:35], s47 offen
  s_add_u32 s47, s47, 0x2000
  buffer_load_dwordx4 v[200:203], v87, s[32:35], s47 offen
  s_add_u32 s47, s47, 0x2000
  buffer_load_dwordx4 v[204:207], v87, s[32:35], s47 offen
  s_waitcnt vmcnt(14)
  v_perm_b32 v72, v124, v120, s50
  v_perm_b32 v73, v132, v128, s50
  v_perm_b32 v74, v140, v136, s50
  v_perm_b32 v75, v148, v144, s50
  v_perm_b32 v76, v124, v120, s51
  v_perm_b32 v77, v132, v128, s51
  v_perm_b32 v78, v140, v136, s51
  v_perm_b32 v79, v148, v144, s51
  s_nop 1
  v_mfma_f32_16x16x32_bf16 v[40:43], v[72:75], v[12:15], v[40:43]
  v_mfma_f32_16x16x32_bf16 v[44:47], v[76:79], v[12:15], v[44:47]
  s_add_u32 s47, s47, 0x2000
  buffer_load_dwordx4 v[208:211], v87, s[32:35], s47 offen
  v_perm_b32 v72, v125, v121, s50
  v_perm_b32 v73, v133, v129, s50
  v_perm_b32 v74, v141, v137, s50
  v_perm_b32 v75, v149, v145, s50
  v_perm_b32 v76, v125, v121, s51
  v_perm_b32 v77, v133, v129, s51
  v_perm_b32 v78, v141, v137, s51
  v_perm_b32 v79, v149, v145, s51
  s_nop 1
  v_mfma_f32_16x16x32_bf16 v[48:51], v[72:75], v[12:15], v[48:51]
  v_mfma_f32_16x16x32_bf16 v[52:55], v[76:79], v[12:15], v[52:55]
  s_add_u32 s47, s47, 0x2000
  buffer_load_dwordx4 v[212:215], v87, s[32:35], s47 offen
  v_perm_b32 v72, v126, v122, s50
  v_perm_b32 v73, v134, v130, s50
  v_perm_b32 v74, v142, v138, s50
  v_perm_b32 v75, v150, v146, s50
  v_perm_b32 v76, v126, v122, s51
  v_perm_b32 v77, v134, v130, s51
  v_perm_b32 v78, v142, v138, s51
  v_perm_b32 v79, v150, v146, s51
  s_nop 1
  v_mfma_f32_16x16x32_bf16 v[56:59], v[72:75], v[12:15], v[56:59]
  v_mfma_f32_16x16x32_bf16 v[60:63], v[76:79], v[12:15], v[60:63]
  s_add_u32 s48, s42, 4
  s_and_b32 s48, s48, 7
  s_lshl_b32 s47, s48, 18
  s_add_u32 s47, s47, s85
  buffer_load_dwordx4 v[88:91], v87, s[32:35], s47 offen
  v_perm_b32 v72, v127, v123, s50
  v_perm_b32 v73, v135, v131, s50
  v_perm_b32 v74, v143, v139, s50
  v_perm_b32 v75, v151, v147, s50
  v_perm_b32 v76, v127, v123, s51
  v_perm_b32 v77, v135, v131, s51
  v_perm_b32 v78, v143, v139, s51
  v_perm_b32 v79, v151, v147, s51
  s_nop 1
  v_mfma_f32_16x16x32_bf16 v[64:67], v[72:75], v[12:15], v[64:67]
  v_mfma_f32_16x16x32_bf16 v[68:71], v[76:79], v[12:15], v[68:71]
  s_add_u32 s47, s47, 0x2000
  buffer_load_dwordx4 v[92:95], v87, s[32:35], s47 offen
  s_add_u32 s47, s47, 0x2000
  buffer_load_dwordx4 v[96:99], v87, s[32:35], s47 offen
  s_add_u32 s47, s47, 0x2000
  buffer_load_dwordx4 v[100:103], v87, s[32:35], s47 offen
  s_add_u32 s47, s47, 0x2000
  buffer_load_dwordx4 v[104:107], v87, s[32:35], s47 offen
  s_add_u32 s47, s47, 0x2000
  buffer_load_dwordx4 v[108:111], v87, s[32:35], s47 offen
  s_waitcnt vmcnt(14)
  v_perm_b32 v72, v156, v152, s50
  v_perm_b32 v73, v164, v160, s50
  v_perm_b32 v74, v172, v168, s50
  v_perm_b32 v75, v180, v176, s50
  v_perm_b32 v76, v156, v152, s51
  v_perm_b32 v77, v164, v160, s51
  v_perm_b32 v78, v172, v168, s51
  v_perm_b32 v79, v180, v176, s51
  s_nop 1
  v_mfma_f32_16x16x32_bf16 v[40:43], v[72:75], v[16:19], v[40:43]
  v_mfma_f32_16x16x32_bf16 v[44:47], v[76:79], v[16:19], v[44:47]
  s_add_u32 s47, s47, 0x2000
  buffer_load_dwordx4 v[112:115], v87, s[32:35], s47 offen
  v_perm_b32 v72, v157, v153, s50
  v_perm_b32 v73, v165, v161, s50
  v_perm_b32 v74, v173, v169, s50
  v_perm_b32 v75, v181, v177, s50
  v_perm_b32 v76, v157, v153, s51
  v_perm_b32 v77, v165, v161, s51
  v_perm_b32 v78, v173, v169, s51
  v_perm_b32 v79, v181, v177, s51
  s_nop 1
  v_mfma_f32_16x16x32_bf16 v[48:51], v[72:75], v[16:19], v[48:51]
  v_mfma_f32_16x16x32_bf16 v[52:55], v[76:79], v[16:19], v[52:55]
  s_add_u32 s47, s47, 0x2000
  buffer_load_dwordx4 v[116:119], v87, s[32:35], s47 offen
  v_perm_b32 v72, v158, v154, s50
  v_perm_b32 v73, v166, v162, s50
  v_perm_b32 v74, v174, v170, s50
  v_perm_b32 v75, v182, v178, s50
  v_perm_b32 v76, v158, v154, s51
  v_perm_b32 v77, v166, v162, s51
  v_perm_b32 v78, v174, v170, s51
  v_perm_b32 v79, v182, v178, s51
  s_nop 1
  v_mfma_f32_16x16x32_bf16 v[56:59], v[72:75], v[16:19], v[56:59]
  v_mfma_f32_16x16x32_bf16 v[60:63], v[76:79], v[16:19], v[60:63]
  s_add_u32 s48, s42, 5
  s_and_b32 s48, s48, 7
  s_lshl_b32 s47, s48, 18
  s_add_u32 s47, s47, s85
  buffer_load_dwordx4 v[120:123], v87, s[32:35], s47 offen
  v_perm_b32 v72, v159, v155, s50
  v_perm_b32 v73, v167, v163, s50
  v_perm_b32 v74, v175, v171, s50
  v_perm_b32 v75, v183, v179, s50
  v_perm_b32 v76, v159, v155, s51
  v_perm_b32 v77, v167, v163, s51
  v_perm_b32 v78, v175, v171, s51
  v_perm_b32 v79, v183, v179, s51
  s_nop 1
  v_mfma_f32_16x16x32_bf16 v[64:67], v[72:75], v[16:19], v[64:67]
  v_mfma_f32_16x16x32_bf16 v[68:71], v[76:79], v[16:19], v[68:71]
  s_add_u32 s47, s47, 0x2000
  buffer_load_dwordx4 v[124:127], v87, s[32:35], s47 offen
  s_add_u32 s47, s47, 0x2000
  buffer_load_dwordx4 v[128:131], v87, s[32:35], s47 offen
  s_add_u32 s47, s47, 0x2000
  buffer_load_dwordx4 v[132:135], v87, s[32:35], s47 offen
  s_add_u32 s47, s47, 0x2000
  buffer_load_dwordx4 v[136:139], v87, s[32:35], s47 offen
  s_add_u32 s47, s47, 0x2000
  buffer_load_dwordx4 v[140:143], v87, s[32:35], s47 offen
  s_waitcnt vmcnt(14)
  v_perm_b32 v72, v188, v184, s50
  v_perm_b32 v73, v196, v192, s50
  v_perm_b32 v74, v204, v200, s50
  v_perm_b32 v75, v212, v208, s50
  v_perm_b32 v76, v188, v184, s51
  v_perm_b32 v77, v196, v192, s51
  v_perm_b32 v78, v204, v200, s51
  v_perm_b32 v79, v212, v208, s51
  s_nop 1
  v_mfma_f32_16x16x32_bf16 v[40:43], v[72:75], v[20:23], v[40:43]
  v_mfma_f32_16x16x32_bf16 v[44:47], v[76:79], v[20:23], v[44:47]
  s_add_u32 s47, s47, 0x2000
  buffer_load_dwordx4 v[144:147], v87, s[32:35], s47 offen
  v_perm_b32 v72, v189, v185, s50
  v_perm_b32 v73, v197, v193, s50
  v_perm_b32 v74, v205, v201, s50
  v_perm_b32 v75, v213, v209, s50
  v_perm_b32 v76, v189, v185, s51
  v_perm_b32 v77, v197, v193, s51
  v_perm_b32 v78, v205, v201, s51
  v_perm_b32 v79, v213, v209, s51
  s_nop 1
  v_mfma_f32_16x16x32_bf16 v[48:51], v[72:75], v[20:23], v[48:51]
  v_mfma_f32_16x16x32_bf16 v[52:55], v[76:79], v[20:23], v[52:55]
  s_add_u32 s47, s47, 0x2000
  buffer_load_dwordx4 v[148:151], v87, s[32:35], s47 offen
  v_perm_b32 v72, v190, v186, s50
  v_perm_b32 v73, v198, v194, s50
  v_perm_b32 v74, v206, v202, s50
  v_perm_b32 v75, v214, v210, s50
  v_perm_b32 v76, v190, v186, s51
  v_perm_b32 v77, v198, v194, s51
  v_perm_b32 v78, v206, v202, s51
  v_perm_b32 v79, v214, v210, s51
  s_nop 1
  v_mfma_f32_16x16x32_bf16 v[56:59], v[72:75], v[20:23], v[56:59]
  v_mfma_f32_16x16x32_bf16 v[60:63], v[76:79], v[20:23], v[60:63]
  s_add_u32 s48, s42, 6
  s_and_b32 s48, s48, 7
  s_lshl_b32 s47, s48, 18
  s_add_u32 s47, s47, s85
  buffer_load_dwordx4 v[152:155], v87, s[32:35], s47 offen
  v_perm_b32 v72, v191, v187, s50
  v_perm_b32 v73, v199, v195, s50
  v_perm_b32 v74, v207, v203, s50
  v_perm_b32 v75, v215, v211, s50
  v_perm_b32 v76, v191, v187, s51
  v_perm_b32 v77, v199, v195, s51
  v_perm_b32 v78, v207, v203, s51
  v_perm_b32 v79, v215, v211, s51
  s_nop 1
  v_mfma_f32_16x16x32_bf16 v[64:67], v[72:75], v[20:23], v[64:67]
  v_mfma_f32_16x16x32_bf16 v[68:71], v[76:79], v[20:23], v[68:71]
  s_add_u32 s47, s47, 0x2000
  buffer_load_dwordx4 v[156:159], v87, s[32:35], s47 offen
  s_add_u32 s47, s47, 0x2000
  buffer_load_dwordx4 v[160:163], v87, s[32:35], s47 offen
  s_add_u32 s47, s47, 0x2000
  buffer_load_dwordx4 v[164:167], v87, s[32:35], s47 offen
  s_add_u32 s47, s47, 0x2000
  buffer_load_dwordx4 v[168:171], v87, s[32:35], s47 offen
  s_add_u32 s47, s47, 0x2000
  buffer_load_dwordx4 v[172:175], v87, s[32:35], s47 offen
  s_waitcnt vmcnt(14)
  v_perm_b32 v72, v92, v88, s50
  v_perm_b32 v73, v100, v96, s50
  v_perm_b32 v74, v108, v104, s50
  v_perm_b32 v75, v116, v112, s50
  v_perm_b32 v76, v92, v88, s51
  v_perm_b32 v77, v100, v96, s51
  v_perm_b32 v78, v108, v104, s51
  v_perm_b32 v79, v116, v112, s51
  s_nop 1
  v_mfma_f32_16x16x32_bf16 v[40:43], v[72:75], v[24:27], v[40:43]
  v_mfma_f32_16x16x32_bf16 v[44:47], v[76:79], v[24:27], v[44:47]
  s_add_u32 s47, s47, 0x2000
  buffer_load_dwordx4 v[176:179], v87, s[32:35], s47 offen
  v_perm_b32 v72, v93, v89, s50
  v_perm_b32 v73, v101, v97, s50
  v_perm_b32 v74, v109, v105, s50
  v_perm_b32 v75, v117, v113, s50
  v_perm_b32 v76, v93, v89, s51
  v_perm_b32 v77, v101, v97, s51
  v_perm_b32 v78, v109, v105, s51
  v_perm_b32 v79, v117, v113, s51
  s_nop 1
  v_mfma_f32_16x16x32_bf16 v[48:51], v[72:75], v[24:27], v[48:51]
  v_mfma_f32_16x16x32_bf16 v[52:55], v[76:79], v[24:27], v[52:55]
  s_add_u32 s47, s47, 0x2000
  buffer_load_dwordx4 v[180:183], v87, s[32:35], s47 offen
  v_perm_b32 v72, v94, v90, s50
  v_perm_b32 v73, v102, v98, s50
  v_perm_b32 v74, v110, v106, s50
  v_perm_b32 v75, v118, v114, s50
  v_perm_b32 v76, v94, v90, s51
  v_perm_b32 v77, v102, v98, s51
  v_perm_b32 v78, v110, v106, s51
  v_perm_b32 v79, v118, v114, s51
  s_nop 1
  v_mfma_f32_16x16x32_bf16 v[56:59], v[72:75], v[24:27], v[56:59]
  v_mfma_f32_16x16x32_bf16 v[60:63], v[76:79], v[24:27], v[60:63]
  s_add_u32 s48, s42, 7
  s_and_b32 s48, s48, 7
  s_lshl_b32 s47, s48, 18
  s_add_u32 s47, s47, s85
  buffer_load_dwordx4 v[184:187], v87, s[32:35], s47 offen
  v_perm_b32 v72, v95, v91, s50
  v_perm_b32 v73, v103, v99, s50
  v_perm_b32 v74, v111, v107, s50
  v_perm_b32 v75, v119, v115, s50
  v_perm_b32 v76, v95, v91, s51
  v_perm_b32 v77, v103, v99, s51
  v_perm_b32 v78, v111, v107, s51
  v_perm_b32 v79, v119, v115, s51
  s_nop 1
  v_mfma_f32_16x16x32_bf16 v[64:67], v[72:75], v[24:27], v[64:67]
  v_mfma_f32_16x16x32_bf16 v[68:71], v[76:79], v[24:27], v[68:71]
  s_add_u32 s47, s47, 0x2000
  buffer_load_dwordx4 v[188:191], v87, s[32:35], s47 offen
  s_add_u32 s47, s47, 0x2000
  buffer_load_dwordx4 v[192:195], v87, s[32:35], s47 offen
  s_add_u32 s47, s47, 0x2000
  buffer_load_dwordx4 v[196:199], v87, s[32:35], s47 offen
  s_add_u32 s47, s47, 0x2000
  buffer_load_dwordx4 v[200:203], v87, s[32:35], s47 offen
  s_add_u32 s47, s47, 0x2000
  buffer_load_dwordx4 v[204:207], v87, s[32:35], s47 offen
  s_waitcnt vmcnt(14)
  v_perm_b32 v72, v124, v120, s50
  v_perm_b32 v73, v132, v128, s50
  v_perm_b32 v74, v140, v136, s50
  v_perm_b32 v75, v148, v144, s50
  v_perm_b32 v76, v124, v120, s51
  v_perm_b32 v77, v132, v128, s51
  v_perm_b32 v78, v140, v136, s51
  v_perm_b32 v79, v148, v144, s51
  s_nop 1
  v_mfma_f32_16x16x32_bf16 v[40:43], v[72:75], v[28:31], v[40:43]
  v_mfma_f32_16x16x32_bf16 v[44:47], v[76:79], v[28:31], v[44:47]
  s_add_u32 s47, s47, 0x2000
  buffer_load_dwordx4 v[208:211], v87, s[32:35], s47 offen
  v_perm_b32 v72, v125, v121, s50
  v_perm_b32 v73, v133, v129, s50
  v_perm_b32 v74, v141, v137, s50
  v_perm_b32 v75, v149, v145, s50
  v_perm_b32 v76, v125, v121, s51
  v_perm_b32 v77, v133, v129, s51
  v_perm_b32 v78, v141, v137, s51
  v_perm_b32 v79, v149, v145, s51
  s_nop 1
  v_mfma_f32_16x16x32_bf16 v[48:51], v[72:75], v[28:31], v[48:51]
  v_mfma_f32_16x16x32_bf16 v[52:55], v[76:79], v[28:31], v[52:55]
  s_add_u32 s47, s47, 0x2000
  buffer_load_dwordx4 v[212:215], v87, s[32:35], s47 offen
  v_perm_b32 v72, v126, v122, s50
  v_perm_b32 v73, v134, v130, s50
  v_perm_b32 v74, v142, v138, s50
  v_perm_b32 v75, v150, v146, s50
  v_perm_b32 v76, v126, v122, s51
  v_perm_b32 v77, v134, v130, s51
  v_perm_b32 v78, v142, v138, s51
  v_perm_b32 v79, v150, v146, s51
  s_nop 1
  v_mfma_f32_16x16x32_bf16 v[56:59], v[72:75], v[28:31], v[56:59]
  v_mfma_f32_16x16x32_bf16 v[60:63], v[76:79], v[28:31], v[60:63]
  buffer_load_dwordx4 a[224:227], v1, s[24:27], s44 offen offset:0 nt
  v_perm_b32 v72, v127, v123, s50
  v_perm_b32 v73, v135, v131, s50
  v_perm_b32 v74, v143, v139, s50
  v_perm_b32 v75, v151, v147, s50
  v_perm_b32 v76, v127, v123, s51
  v_perm_b32 v77, v135, v131, s51
  v_perm_b32 v78, v143, v139, s51
  v_perm_b32 v79, v151, v147, s51
  s_nop 1
  v_mfma_f32_16x16x32_bf16 v[64:67], v[72:75], v[28:31], v[64:67]
  v_mfma_f32_16x16x32_bf16 v[68:71], v[76:79], v[28:31], v[68:71]
  buffer_load_dwordx4 a[228:231], v1, s[24:27], s44 offen offset:1024 nt
  buffer_load_dwordx4 a[232:235], v1, s[24:27], s44 offen offset:2048 nt
  buffer_load_dwordx4 a[236:239], v1, s[24:27], s44 offen offset:3072 nt
  s_add_u32 s77, s44, 0x1000
  buffer_load_dwordx4 a[240:243], v1, s[24:27], s77 offen offset:0 nt
  s_add_u32 s77, s44, 0x1000
  buffer_load_dwordx4 a[244:247], v1, s[24:27], s77 offen offset:1024 nt
  s_waitcnt vmcnt(14)
  v_perm_b32 v72, v156, v152, s50
  v_perm_b32 v73, v164, v160, s50
  v_perm_b32 v74, v172, v168, s50
  v_perm_b32 v75, v180, v176, s50
  v_perm_b32 v76, v156, v152, s51
  v_perm_b32 v77, v164, v160, s51
  v_perm_b32 v78, v172, v168, s51
  v_perm_b32 v79, v180, v176, s51
  s_nop 1
  v_mfma_f32_16x16x32_bf16 v[40:43], v[72:75], v[32:35], v[40:43]
  v_mfma_f32_16x16x32_bf16 v[44:47], v[76:79], v[32:35], v[44:47]
  s_add_u32 s77, s44, 0x1000
  buffer_load_dwordx4 a[248:251], v1, s[24:27], s77 offen offset:2048 nt
  v_perm_b32 v72, v157, v153, s50
  v_perm_b32 v73, v165, v161, s50
  v_perm_b32 v74, v173, v169, s50
  v_perm_b32 v75, v181, v177, s50
  v_perm_b32 v76, v157, v153, s51
  v_perm_b32 v77, v165, v161, s51
  v_perm_b32 v78, v173, v169, s51
  v_perm_b32 v79, v181, v177, s51
  s_nop 1
  v_mfma_f32_16x16x32_bf16 v[48:51], v[72:75], v[32:35], v[48:51]
  v_mfma_f32_16x16x32_bf16 v[52:55], v[76:79], v[32:35], v[52:55]
  s_add_u32 s77, s44, 0x1000
  buffer_load_dwordx4 a[252:255], v1, s[24:27], s77 offen offset:3072 nt
  s_or_b32 s44, s44, 0x17f00
  s_add_u32 s44, s44, 0x100
  s_and_b32 s44, s44, 0x68000
  s_or_b32 s44, s44, s78
  s_or_b32 s44, s44, 0x4000
  v_perm_b32 v72, v158, v154, s50
  v_perm_b32 v73, v166, v162, s50
  v_perm_b32 v74, v174, v170, s50
  v_perm_b32 v75, v182, v178, s50
  v_perm_b32 v76, v158, v154, s51
  v_perm_b32 v77, v166, v162, s51
  v_perm_b32 v78, v174, v170, s51
  v_perm_b32 v79, v182, v178, s51
  s_nop 1
  v_mfma_f32_16x16x32_bf16 v[56:59], v[72:75], v[32:35], v[56:59]
  v_mfma_f32_16x16x32_bf16 v[60:63], v[76:79], v[32:35], v[60:63]
  buffer_load_dwordx4 v[88:91], v1, s[24:27], s44 offen offset:0 nt
  v_perm_b32 v72, v159, v155, s50
  v_perm_b32 v73, v167, v163, s50
  v_perm_b32 v74, v175, v171, s50
  v_perm_b32 v75, v183, v179, s50
  v_perm_b32 v76, v159, v155, s51
  v_perm_b32 v77, v167, v163, s51
  v_perm_b32 v78, v175, v171, s51
  v_perm_b32 v79, v183, v179, s51
  s_nop 1
  v_mfma_f32_16x16x32_bf16 v[64:67], v[72:75], v[32:35], v[64:67]
  v_mfma_f32_16x16x32_bf16 v[68:71], v[76:79], v[32:35], v[68:71]
  buffer_load_dwordx4 v[92:95], v1, s[24:27], s44 offen offset:1024 nt
  s_waitcnt vmcnt(9)
  buffer_load_dwordx4 v[96:99], v1, s[24:27], s44 offen offset:2048 nt
  s_waitcnt vmcnt(9)
  buffer_load_dwordx4 v[100:103], v1, s[24:27], s44 offen offset:3072 nt
  s_waitcnt vmcnt(9)
  s_add_u32 s77, s44, 0x1000
  buffer_load_dwordx4 v[104:107], v1, s[24:27], s77 offen offset:0 nt
  s_waitcnt vmcnt(9)
  s_add_u32 s77, s44, 0x1000
  buffer_load_dwordx4 v[108:111], v1, s[24:27], s77 offen offset:1024 nt
  v_perm_b32 v72, v188, v184, s50
  v_perm_b32 v73, v196, v192, s50
  v_perm_b32 v74, v204, v200, s50
  v_perm_b32 v75, v212, v208, s50
  v_perm_b32 v76, v188, v184, s51
  v_perm_b32 v77, v196, v192, s51
  v_perm_b32 v78, v204, v200, s51
  v_perm_b32 v79, v212, v208, s51
  s_nop 1
  v_mfma_f32_16x16x32_bf16 v[40:43], v[72:75], v[36:39], v[40:43]
  v_mfma_f32_16x16x32_bf16 v[44:47], v[76:79], v[36:39], v[44:47]
  s_waitcnt vmcnt(9)
  s_add_u32 s77, s44, 0x1000
  buffer_load_dwordx4 v[112:115], v1, s[24:27], s77 offen offset:2048 nt
  v_perm_b32 v72, v189, v185, s50
  v_perm_b32 v73, v197, v193, s50
  v_perm_b32 v74, v205, v201, s50
  v_perm_b32 v75, v213, v209, s50
  v_perm_b32 v76, v189, v185, s51
  v_perm_b32 v77, v197, v193, s51
  v_perm_b32 v78, v205, v201, s51
  v_perm_b32 v79, v213, v209, s51
  s_nop 1
  v_mfma_f32_16x16x32_bf16 v[48:51], v[72:75], v[36:39], v[48:51]
  v_mfma_f32_16x16x32_bf16 v[52:55], v[76:79], v[36:39], v[52:55]
  s_waitcnt vmcnt(9)
  s_add_u32 s77, s44, 0x1000
  buffer_load_dwordx4 v[116:119], v1, s[24:27], s77 offen offset:3072 nt
  s_or_b32 s44, s44, 0x17f00
  s_add_u32 s44, s44, 0x100
  s_and_b32 s44, s44, 0x68000
  s_or_b32 s44, s44, s78
  s_or_b32 s44, s44, 0x4000
  v_perm_b32 v72, v190, v186, s50
  v_perm_b32 v73, v198, v194, s50
  v_perm_b32 v74, v206, v202, s50
  v_perm_b32 v75, v214, v210, s50
  v_perm_b32 v76, v190, v186, s51
  v_perm_b32 v77, v198, v194, s51
  v_perm_b32 v78, v206, v202, s51
  v_perm_b32 v79, v214, v210, s51
  s_nop 1
  v_mfma_f32_16x16x32_bf16 v[56:59], v[72:75], v[36:39], v[56:59]
  v_mfma_f32_16x16x32_bf16 v[60:63], v[76:79], v[36:39], v[60:63]
  v_perm_b32 v72, v191, v187, s50
  v_perm_b32 v73, v199, v195, s50
  v_perm_b32 v74, v207, v203, s50
  v_perm_b32 v75, v215, v211, s50
  v_perm_b32 v76, v191, v187, s51
  v_perm_b32 v77, v199, v195, s51
  v_perm_b32 v78, v207, v203, s51
  v_perm_b32 v79, v215, v211, s51
  s_nop 1
  v_mfma_f32_16x16x32_bf16 v[64:67], v[72:75], v[36:39], v[64:67]
  v_mfma_f32_16x16x32_bf16 v[68:71], v[76:79], v[36:39], v[68:71]
  s_lshl_b32 s48, s40, 13
  v_add_u32 v8, s48, v2
  s_lshl_b32 s48, s40, 11
  v_add_u32 v9, s48, v2
  v_lshlrev_b32 v10, 10, v7
  v_lshl_add_u32 v10, v6, 4, v10
  s_lshl_b32 s48, s40, 2
  s_add_u32 s48, s48, 0x19000
  v_add_u32 v10, s48, v10
  s_mov_b32 s20, s18
  s_mov_b32 s21, s19
  s_cmp_lt_u32 s40, 2
  s_cselect_b32 s22, 0x1c00000, 0
  s_nop 7
  ds_write_b128 v8, v[40:43] offset:0
  ds_write_b128 v8, v[44:47] offset:1024
  ds_write_b128 v8, v[48:51] offset:2048
  ds_write_b128 v8, v[52:55] offset:3072
  ds_write_b128 v8, v[56:59] offset:4096
  ds_write_b128 v8, v[60:63] offset:5120
  ds_write_b128 v8, v[64:67] offset:6144
  ds_write_b128 v8, v[68:71] offset:7168
  s_waitcnt lgkmcnt(0)
  s_barrier
  ds_read_b128 v[40:43], v9 offset:0
  ds_read_b128 v[44:47], v9 offset:1024
  ds_read_b128 v[48:51], v9 offset:8192
  ds_read_b128 v[52:55], v9 offset:9216
  ds_read_b128 v[56:59], v9 offset:16384
  ds_read_b128 v[60:63], v9 offset:17408
  ds_read_b128 v[64:67], v9 offset:24576
  ds_read_b128 v[68:71], v9 offset:25600
  s_waitcnt lgkmcnt(0)
  v_add_f32 v40, v40, v48
  v_add_f32 v56, v56, v64
  v_add_f32 v41, v41, v49
  v_add_f32 v57, v57, v65
  v_add_f32 v42, v42, v50
  v_add_f32 v58, v58, v66
  v_add_f32 v43, v43, v51
  v_add_f32 v59, v59, v67
  v_add_f32 v44, v44, v52
  v_add_f32 v60, v60, v68
  v_add_f32 v45, v45, v53
  v_add_f32 v61, v61, v69
  v_add_f32 v46, v46, v54
  v_add_f32 v62, v62, v70
  v_add_f32 v47, v47, v55
  v_add_f32 v63, v63, v71
  v_add_f32 v40, v40, v56
  v_add_f32 v41, v41, v57
  v_add_f32 v42, v42, v58
  v_add_f32 v43, v43, v59
  v_add_f32 v44, v44, v60
  v_add_f32 v45, v45, v61
  v_add_f32 v46, v46, v62
  v_add_f32 v47, v47, v63
  v_cvt_pk_bf16_f32 v12, v40, v44
  v_cvt_pk_bf16_f32 v13, v41, v45
  v_cvt_pk_bf16_f32 v14, v42, v46
  v_cvt_pk_bf16_f32 v15, v43, v47
  ds_write_b32 v10, v12 offset:0
  ds_write_b32 v10, v13 offset:256
  ds_write_b32 v10, v14 offset:512
  ds_write_b32 v10, v15 offset:768
  s_waitcnt lgkmcnt(0)
  s_barrier
  ds_read_b128 v[24:27], v82 offset:0
  ds_read_b128 v[28:31], v82 offset:512
  ds_read_b128 v[32:35], v82 offset:128
  ds_read_b128 v[36:39], v82 offset:640
  v_mov_b32 v40, 0
  v_mov_b32 v41, 0
  v_mov_b32 v42, 0
  v_mov_b32 v43, 0
  v_mov_b32 v44, 0
  v_mov_b32 v45, 0
  v_mov_b32 v46, 0
  v_mov_b32 v47, 0
  v_mov_b32 v48, 0
  v_mov_b32 v49, 0
  v_mov_b32 v50, 0
  v_mov_b32 v51, 0
  v_mov_b32 v52, 0
  v_mov_b32 v53, 0
  v_mov_b32 v54, 0
  v_mov_b32 v55, 0
  v_mov_b32 v56, 0
  v_mov_b32 v57, 0
  v_mov_b32 v58, 0
  v_mov_b32 v59, 0
  v_mov_b32 v60, 0
  v_mov_b32 v61, 0
  v_mov_b32 v62, 0
  v_mov_b32 v63, 0
  v_mov_b32 v64, 0
  v_mov_b32 v65, 0
  v_mov_b32 v66, 0
  v_mov_b32 v67, 0
  v_mov_b32 v68, 0
  v_mov_b32 v69, 0
  v_mov_b32 v70, 0
  v_mov_b32 v71, 0
  v_mov_b32 v5, 0xff800000
  v_mov_b32 v6, 0
  s_waitcnt lgkmcnt(0)
  s_waitcnt vmcnt(8)
L_pJ:
  v_bfe_u32 v245, v0, 4, 2
  v_lshlrev_b32 v245, 3, v245
  v_and_or_b32 v245, v0, 7, v245
  s_mul_i32 s48, s40, 10240
  s_add_u32 s48, s48, 0x1a040
  v_lshl_add_u32 v244, v245, 4, s48
  s_add_u32 s48, s48, 512
  v_lshl_add_u32 v245, v245, 2, s48
  s_waitcnt vmcnt(5)
  buffer_load_dwordx4 v[120:123], v1, s[24:27], s44 offen offset:0 nt
  buffer_load_dword v255, off, s[80:83], 0 sc1
  v_bfe_u32 v168, v0, 3, 1
  v_bfe_u32 v169, v0, 4, 2
  v_and_b32 v170, 7, v0
  s_lshl_b32 s48, s40, 1
  s_add_u32 s48, s48, 3
  v_add_u32 v86, s48, v168
  v_and_b32 v86, 3, v86
  v_lshlrev_b32 v86, 13, v86
  v_lshl_add_u32 v86, v168, 20, v86
  v_lshl_add_u32 v86, v169, 8, v86
  v_lshl_add_u32 v86, v170, 4, v86
  v_lshlrev_b32 v87, 15, v168
  v_lshl_add_u32 v87, v169, 7, v87
  v_lshl_add_u32 v87, v170, 4, v87
  v_bfe_u32 v168, v0, 3, 3
  v_lshlrev_b32 v82, 11, v170
  v_lshl_add_u32 v82, v168, 3, v82
  s_andn2_b32 s48, s2, 15
  s_and_b32 s49, s2, 8
  s_lshr_b32 s49, s49, 1
  s_add_u32 s48, s48, s49
  s_and_b32 s49, s40, 1
  s_lshl_b32 s49, s49, 1
  s_add_u32 s48, s48, s49
  s_lshl_b32 s84, s48, 15
  s_and_b32 s48, s2, 7
  s_lshl_b32 s86, s48, 14
  s_lshl_b32 s48, s48, 10
  s_add_u32 s84, s84, s48
  s_add_u32 s48, s42, 1
  s_and_b32 s48, s48, 3
  s_lshl_b32 s48, s48, 13
  s_add_u32 s49, s42, 2
  s_and_b32 s49, s49, 3
  s_lshl_b32 s49, s49, 13
  s_sub_u32 s4, s49, s48
  s_add_u32 s48, s48, 0xc00000
  s_add_u32 s84, s84, s48
  s_lshl_b32 s85, s2, 15
  s_add_u32 s85, s85, s48
  s_lshr_b32 s48, s2, 3
  s_lshl_b32 s48, s48, 6
  s_add_u32 s86, s86, s48
  s_bitcmp1_b32 s40, 0
  s_cselect_b32 s48, s4, 0
  s_add_u32 s85, s85, s48
  s_bitcmp1_b32 s40, 0
  s_cselect_b32 s48, 0x20000, 0
  s_add_u32 s86, s86, s48
  s_or_b32 s45, s44, 0x17f00
  s_add_u32 s45, s45, 0x100
  s_and_b32 s45, s45, 0x68000
  s_or_b32 s45, s45, s78
  s_or_b32 s45, s45, 0x4000
  v_mfma_f32_16x16x32_bf16 v[152:155], a[0:3], v[24:27], 0
  v_mfma_f32_16x16x32_bf16 v[156:159], a[0:3], v[28:31], 0
  v_mfma_f32_16x16x32_bf16 v[160:163], a[4:7], v[24:27], 0
  v_mfma_f32_16x16x32_bf16 v[164:167], a[4:7], v[28:31], 0
  v_mfma_f32_16x16x32_bf16 v[168:171], a[8:11], v[24:27], 0
  v_mfma_f32_16x16x32_bf16 v[172:175], a[8:11], v[28:31], 0
  v_mfma_f32_16x16x32_bf16 v[176:179], a[12:15], v[24:27], 0
  v_mfma_f32_16x16x32_bf16 v[180:183], a[12:15], v[28:31], 0
  v_mfma_f32_16x16x32_bf16 v[184:187], a[16:19], v[24:27], 0
  v_mfma_f32_16x16x32_bf16 v[188:191], a[16:19], v[28:31], 0
  v_mfma_f32_16x16x32_bf16 v[192:195], a[20:23], v[24:27], 0
  v_mfma_f32_16x16x32_bf16 v[196:199], a[20:23], v[28:31], 0
  v_mfma_f32_16x16x32_bf16 v[200:203], a[24:27], v[24:27], 0
  v_mfma_f32_16x16x32_bf16 v[204:207], a[24:27], v[28:31], 0
  v_mfma_f32_16x16x32_bf16 v[208:211], a[28:31], v[24:27], 0
  v_mfma_f32_16x16x32_bf16 v[212:215], a[28:31], v[28:31], 0
  s_waitcnt vmcnt(6)
  buffer_load_dwordx4 v[124:127], v1, s[24:27], s44 offen offset:1024 nt
  s_nop 3
  v_add_f32 v153, v153, v159
  v_add_f32 v152, v152, v158
  v_add_f32 v161, v161, v167
  v_add_f32 v160, v160, v166
  v_add_f32 v169, v169, v175
  v_add_f32 v168, v168, v174
  v_add_f32 v177, v177, v183
  v_add_f32 v176, v176, v182
  v_add_f32 v185, v185, v191
  v_add_f32 v184, v184, v190
  v_add_f32 v193, v193, v199
  v_add_f32 v192, v192, v198
  v_add_f32 v201, v201, v207
  v_add_f32 v200, v200, v206
  v_add_f32 v209, v209, v215
  v_add_f32 v208, v208, v214
  v_add_f32_dpp v8, v153, v152 row_ror:8 row_mask:0xf bank_mask:0xf
  v_add_f32_dpp v9, v161, v160 row_ror:8 row_mask:0xf bank_mask:0xf
  v_add_f32_dpp v10, v169, v168 row_ror:8 row_mask:0xf bank_mask:0xf
  v_add_f32_dpp v11, v177, v176 row_ror:8 row_mask:0xf bank_mask:0xf
  v_add_f32_dpp v12, v185, v184 row_ror:8 row_mask:0xf bank_mask:0xf
  v_add_f32_dpp v13, v193, v192 row_ror:8 row_mask:0xf bank_mask:0xf
  v_add_f32_dpp v14, v201, v200 row_ror:8 row_mask:0xf bank_mask:0xf
  v_add_f32_dpp v15, v209, v208 row_ror:8 row_mask:0xf bank_mask:0xf
  v_max3_f32 v7, v8, v9, v10
  v_max3_f32 v7, v7, v11, v12
  v_max3_f32 v7, v7, v13, v14
  v_max_f32 v7, v7, v15
  v_mov_b32 v20, v7
  s_nop 1
  v_permlane16_swap_b32 v7, v20
  s_nop 1
  v_max_f32 v7, v7, v20
  v_mov_b32 v20, v7
  s_nop 1
  v_permlane32_swap_b32 v7, v20
  s_nop 1
  v_max_f32 v7, v7, v20
  v_mul_f32 v7, s52, v7
  v_max_f32 v7, v7, v5
  v_sub_f32 v21, v5, v7
  v_exp_f32 v21, v21
  v_mov_b32 v5, v7
  s_waitcnt vmcnt(6)
  buffer_load_dwordx4 v[128:131], v1, s[24:27], s44 offen offset:2048 nt
  v_fma_f32 v8, v8, s52, -v5
  v_fma_f32 v9, v9, s52, -v5
  v_fma_f32 v10, v10, s52, -v5
  v_fma_f32 v11, v11, s52, -v5
  v_fma_f32 v12, v12, s52, -v5
  v_fma_f32 v13, v13, s52, -v5
  v_fma_f32 v14, v14, s52, -v5
  v_fma_f32 v15, v15, s52, -v5
  v_exp_f32 v8, v8
  v_exp_f32 v9, v9
  v_exp_f32 v10, v10
  v_exp_f32 v11, v11
  v_exp_f32 v12, v12
  v_exp_f32 v13, v13
  v_exp_f32 v14, v14
  v_exp_f32 v15, v15
  s_nop 0
  v_add_f32 v22, v8, v9
  v_add_f32 v23, v10, v11
  v_add_f32 v7, v12, v13
  v_add_f32 v20, v14, v15
  v_add_f32 v22, v22, v23
  v_add_f32 v7, v7, v20
  v_add_f32 v22, v22, v7
  v_fma_f32 v6, v6, v21, v22
  v_cvt_pk_bf16_f32 v16, v8, v9
  v_cvt_pk_bf16_f32 v17, v10, v11
  v_cvt_pk_bf16_f32 v18, v12, v13
  v_cvt_pk_bf16_f32 v19, v14, v15
  s_mov_b64 exec, s[56:57]
  ds_write_b128 v244, v[16:19] offset:0
  ds_write_b32 v245, v21 offset:0
  s_mov_b64 exec, -1
  s_waitcnt vmcnt(6)
  buffer_load_dwordx4 v[132:135], v1, s[24:27], s44 offen offset:3072 nt
  s_waitcnt vmcnt(6)
  s_add_u32 s77, s44, 0x1000
  buffer_load_dwordx4 v[136:139], v1, s[24:27], s77 offen offset:0 nt
  s_waitcnt vmcnt(6)
  s_add_u32 s77, s44, 0x1000
  buffer_load_dwordx4 v[140:143], v1, s[24:27], s77 offen offset:1024 nt
  v_mfma_f32_16x16x32_bf16 v[152:155], v[88:91], v[24:27], 0
  v_mfma_f32_16x16x32_bf16 v[156:159], v[88:91], v[28:31], 0
  v_mfma_f32_16x16x32_bf16 v[160:163], v[92:95], v[24:27], 0
  v_mfma_f32_16x16x32_bf16 v[164:167], v[92:95], v[28:31], 0
  v_mfma_f32_16x16x32_bf16 v[168:171], v[96:99], v[24:27], 0
  v_mfma_f32_16x16x32_bf16 v[172:175], v[96:99], v[28:31], 0
  v_mfma_f32_16x16x32_bf16 v[176:179], v[100:103], v[24:27], 0
  v_mfma_f32_16x16x32_bf16 v[180:183], v[100:103], v[28:31], 0
  v_mfma_f32_16x16x32_bf16 v[184:187], v[104:107], v[24:27], 0
  v_mfma_f32_16x16x32_bf16 v[188:191], v[104:107], v[28:31], 0
  v_mfma_f32_16x16x32_bf16 v[192:195], v[108:111], v[24:27], 0
  v_mfma_f32_16x16x32_bf16 v[196:199], v[108:111], v[28:31], 0
  v_mfma_f32_16x16x32_bf16 v[200:203], v[112:115], v[24:27], 0
  v_mfma_f32_16x16x32_bf16 v[204:207], v[112:115], v[28:31], 0
  v_mfma_f32_16x16x32_bf16 v[208:211], v[116:119], v[24:27], 0
  v_mfma_f32_16x16x32_bf16 v[212:215], v[116:119], v[28:31], 0
  s_waitcnt vmcnt(6)
  s_add_u32 s77, s44, 0x1000
  buffer_load_dwordx4 v[144:147], v1, s[24:27], s77 offen offset:2048 nt
  s_nop 3
  v_add_f32 v153, v153, v159
  v_add_f32 v152, v152, v158
  v_add_f32 v161, v161, v167
  v_add_f32 v160, v160, v166
  v_add_f32 v169, v169, v175
  v_add_f32 v168, v168, v174
  v_add_f32 v177, v177, v183
  v_add_f32 v176, v176, v182
  v_add_f32 v185, v185, v191
  v_add_f32 v184, v184, v190
  v_add_f32 v193, v193, v199
  v_add_f32 v192, v192, v198
  v_add_f32 v201, v201, v207
  v_add_f32 v200, v200, v206
  v_add_f32 v209, v209, v215
  v_add_f32 v208, v208, v214
  v_add_f32_dpp v8, v153, v152 row_ror:8 row_mask:0xf bank_mask:0xf
  v_add_f32_dpp v9, v161, v160 row_ror:8 row_mask:0xf bank_mask:0xf
  v_add_f32_dpp v10, v169, v168 row_ror:8 row_mask:0xf bank_mask:0xf
  v_add_f32_dpp v11, v177, v176 row_ror:8 row_mask:0xf bank_mask:0xf
  v_add_f32_dpp v12, v185, v184 row_ror:8 row_mask:0xf bank_mask:0xf
  v_add_f32_dpp v13, v193, v192 row_ror:8 row_mask:0xf bank_mask:0xf
  v_add_f32_dpp v14, v201, v200 row_ror:8 row_mask:0xf bank_mask:0xf
  v_add_f32_dpp v15, v209, v208 row_ror:8 row_mask:0xf bank_mask:0xf
  v_max3_f32 v7, v8, v9, v10
  v_max3_f32 v7, v7, v11, v12
  v_max3_f32 v7, v7, v13, v14
  v_max_f32 v7, v7, v15
  v_mov_b32 v20, v7
  s_nop 1
  v_permlane16_swap_b32 v7, v20
  s_nop 1
  v_max_f32 v7, v7, v20
  v_mov_b32 v20, v7
  s_nop 1
  v_permlane32_swap_b32 v7, v20
  s_nop 1
  v_max_f32 v7, v7, v20
  v_mul_f32 v7, s52, v7
  v_max_f32 v7, v7, v5
  v_sub_f32 v21, v5, v7
  v_exp_f32 v21, v21
  v_mov_b32 v5, v7
  s_waitcnt vmcnt(5)
  s_add_u32 s77, s44, 0x1000
  buffer_load_dwordx4 v[148:151], v1, s[24:27], s77 offen offset:3072 nt
  v_fma_f32 v8, v8, s52, -v5
  v_fma_f32 v9, v9, s52, -v5
  v_fma_f32 v10, v10, s52, -v5
  v_fma_f32 v11, v11, s52, -v5
  v_fma_f32 v12, v12, s52, -v5
  v_fma_f32 v13, v13, s52, -v5
  v_fma_f32 v14, v14, s52, -v5
  v_fma_f32 v15, v15, s52, -v5
  v_exp_f32 v8, v8
  v_exp_f32 v9, v9
  v_exp_f32 v10, v10
  v_exp_f32 v11, v11
  v_exp_f32 v12, v12
  v_exp_f32 v13, v13
  v_exp_f32 v14, v14
  v_exp_f32 v15, v15
  s_nop 0
  v_add_f32 v22, v8, v9
  v_add_f32 v23, v10, v11
  v_add_f32 v7, v12, v13
  v_add_f32 v20, v14, v15
  v_add_f32 v22, v22, v23
  v_add_f32 v7, v7, v20
  v_add_f32 v22, v22, v7
  v_fma_f32 v6, v6, v21, v22
  v_cvt_pk_bf16_f32 v16, v8, v9
  v_cvt_pk_bf16_f32 v17, v10, v11
  v_cvt_pk_bf16_f32 v18, v12, v13
  v_cvt_pk_bf16_f32 v19, v14, v15
  s_mov_b64 exec, s[56:57]
  ds_write_b128 v244, v[16:19] offset:640
  ds_write_b32 v245, v21 offset:640
  s_mov_b64 exec, -1
  s_waitcnt vmcnt(5)
  buffer_load_dwordx4 v[88:91], v1, s[24:27], s45 offen offset:0 nt
  v_mfma_f32_16x16x32_bf16 v[152:155], a[32:35], v[24:27], 0
  v_mfma_f32_16x16x32_bf16 v[156:159], a[32:35], v[28:31], 0
  v_mfma_f32_16x16x32_bf16 v[160:163], a[36:39], v[24:27], 0
  v_mfma_f32_16x16x32_bf16 v[164:167], a[36:39], v[28:31], 0
  v_mfma_f32_16x16x32_bf16 v[168:171], a[40:43], v[24:27], 0
  v_mfma_f32_16x16x32_bf16 v[172:175], a[40:43], v[28:31], 0
  v_mfma_f32_16x16x32_bf16 v[176:179], a[44:47], v[24:27], 0
  v_mfma_f32_16x16x32_bf16 v[180:183], a[44:47], v[28:31], 0
  v_mfma_f32_16x16x32_bf16 v[184:187], a[48:51], v[24:27], 0
  v_mfma_f32_16x16x32_bf16 v[188:191], a[48:51], v[28:31], 0
  v_mfma_f32_16x16x32_bf16 v[192:195], a[52:55], v[24:27], 0
  v_mfma_f32_16x16x32_bf16 v[196:199], a[52:55], v[28:31], 0
  v_mfma_f32_16x16x32_bf16 v[200:203], a[56:59], v[24:27], 0
  v_mfma_f32_16x16x32_bf16 v[204:207], a[56:59], v[28:31], 0
  v_mfma_f32_16x16x32_bf16 v[208:211], a[60:63], v[24:27], 0
  v_mfma_f32_16x16x32_bf16 v[212:215], a[60:63], v[28:31], 0
  s_waitcnt vmcnt(5)
  buffer_load_dwordx4 v[92:95], v1, s[24:27], s45 offen offset:1024 nt
  s_nop 3
  v_add_f32 v153, v153, v159
  v_add_f32 v152, v152, v158
  v_add_f32 v161, v161, v167
  v_add_f32 v160, v160, v166
  v_add_f32 v169, v169, v175
  v_add_f32 v168, v168, v174
  v_add_f32 v177, v177, v183
  v_add_f32 v176, v176, v182
  v_add_f32 v185, v185, v191
  v_add_f32 v184, v184, v190
  v_add_f32 v193, v193, v199
  v_add_f32 v192, v192, v198
  v_add_f32 v201, v201, v207
  v_add_f32 v200, v200, v206
  v_add_f32 v209, v209, v215
  v_add_f32 v208, v208, v214
  v_add_f32_dpp v8, v153, v152 row_ror:8 row_mask:0xf bank_mask:0xf
  v_add_f32_dpp v9, v161, v160 row_ror:8 row_mask:0xf bank_mask:0xf
  v_add_f32_dpp v10, v169, v168 row_ror:8 row_mask:0xf bank_mask:0xf
  v_add_f32_dpp v11, v177, v176 row_ror:8 row_mask:0xf bank_mask:0xf
  v_add_f32_dpp v12, v185, v184 row_ror:8 row_mask:0xf bank_mask:0xf
  v_add_f32_dpp v13, v193, v192 row_ror:8 row_mask:0xf bank_mask:0xf
  v_add_f32_dpp v14, v201, v200 row_ror:8 row_mask:0xf bank_mask:0xf
  v_add_f32_dpp v15, v209, v208 row_ror:8 row_mask:0xf bank_mask:0xf
  v_max3_f32 v7, v8, v9, v10
  v_max3_f32 v7, v7, v11, v12
  v_max3_f32 v7, v7, v13, v14
  v_max_f32 v7, v7, v15
  v_mov_b32 v20, v7
  s_nop 1
  v_permlane16_swap_b32 v7, v20
  s_nop 1
  v_max_f32 v7, v7, v20
  v_mov_b32 v20, v7
  s_nop 1
  v_permlane32_swap_b32 v7, v20
  s_nop 1
  v_max_f32 v7, v7, v20
  v_mul_f32 v7, s52, v7
  v_max_f32 v7, v7, v5
  v_sub_f32 v21, v5, v7
  v_exp_f32 v21, v21
  v_mov_b32 v5, v7
  s_waitcnt vmcnt(5)
  buffer_load_dwordx4 v[96:99], v1, s[24:27], s45 offen offset:2048 nt
  v_fma_f32 v8, v8, s52, -v5
  v_fma_f32 v9, v9, s52, -v5
  v_fma_f32 v10, v10, s52, -v5
  v_fma_f32 v11, v11, s52, -v5
  v_fma_f32 v12, v12, s52, -v5
  v_fma_f32 v13, v13, s52, -v5
  v_fma_f32 v14, v14, s52, -v5
  v_fma_f32 v15, v15, s52, -v5
  v_exp_f32 v8, v8
  v_exp_f32 v9, v9
  v_exp_f32 v10, v10
  v_exp_f32 v11, v11
  v_exp_f32 v12, v12
  v_exp_f32 v13, v13
  v_exp_f32 v14, v14
  v_exp_f32 v15, v15
  s_nop 0
  v_add_f32 v22, v8, v9
  v_add_f32 v23, v10, v11
  v_add_f32 v7, v12, v13
  v_add_f32 v20, v14, v15
  v_add_f32 v22, v22, v23
  v_add_f32 v7, v7, v20
  v_add_f32 v22, v22, v7
  v_fma_f32 v6, v6, v21, v22
  v_cvt_pk_bf16_f32 v16, v8, v9
  v_cvt_pk_bf16_f32 v17, v10, v11
  v_cvt_pk_bf16_f32 v18, v12, v13
  v_cvt_pk_bf16_f32 v19, v14, v15
  s_mov_b64 exec, s[56:57]
  ds_write_b128 v244, v[16:19] offset:1280
  ds_write_b32 v245, v21 offset:1280
  s_mov_b64 exec, -1
  s_waitcnt vmcnt(5)
  buffer_load_dwordx4 v[100:103], v1, s[24:27], s45 offen offset:3072 nt
  s_waitcnt vmcnt(5)
  s_add_u32 s77, s45, 0x1000
  buffer_load_dwordx4 v[104:107], v1, s[24:27], s77 offen offset:0 nt
  s_waitcnt vmcnt(5)
  s_add_u32 s77, s45, 0x1000
  buffer_load_dwordx4 v[108:111], v1, s[24:27], s77 offen offset:1024 nt
  v_mfma_f32_16x16x32_bf16 v[152:155], v[120:123], v[24:27], 0
  v_mfma_f32_16x16x32_bf16 v[156:159], v[120:123], v[28:31], 0
  v_mfma_f32_16x16x32_bf16 v[160:163], v[124:127], v[24:27], 0
  v_mfma_f32_16x16x32_bf16 v[164:167], v[124:127], v[28:31], 0
  v_mfma_f32_16x16x32_bf16 v[168:171], v[128:131], v[24:27], 0
  v_mfma_f32_16x16x32_bf16 v[172:175], v[128:131], v[28:31], 0
  v_mfma_f32_16x16x32_bf16 v[176:179], v[132:135], v[24:27], 0
  v_mfma_f32_16x16x32_bf16 v[180:183], v[132:135], v[28:31], 0
  v_mfma_f32_16x16x32_bf16 v[184:187], v[136:139], v[24:27], 0
  v_mfma_f32_16x16x32_bf16 v[188:191], v[136:139], v[28:31], 0
  v_mfma_f32_16x16x32_bf16 v[192:195], v[140:143], v[24:27], 0
  v_mfma_f32_16x16x32_bf16 v[196:199], v[140:143], v[28:31], 0
  v_mfma_f32_16x16x32_bf16 v[200:203], v[144:147], v[24:27], 0
  v_mfma_f32_16x16x32_bf16 v[204:207], v[144:147], v[28:31], 0
  v_mfma_f32_16x16x32_bf16 v[208:211], v[148:151], v[24:27], 0
  v_mfma_f32_16x16x32_bf16 v[212:215], v[148:151], v[28:31], 0
  s_waitcnt vmcnt(5)
  s_add_u32 s77, s45, 0x1000
  buffer_load_dwordx4 v[112:115], v1, s[24:27], s77 offen offset:2048 nt
  s_nop 3
  v_add_f32 v153, v153, v159
  v_add_f32 v152, v152, v158
  v_add_f32 v161, v161, v167
  v_add_f32 v160, v160, v166
  v_add_f32 v169, v169, v175
  v_add_f32 v168, v168, v174
  v_add_f32 v177, v177, v183
  v_add_f32 v176, v176, v182
  v_add_f32 v185, v185, v191
  v_add_f32 v184, v184, v190
  v_add_f32 v193, v193, v199
  v_add_f32 v192, v192, v198
  v_add_f32 v201, v201, v207
  v_add_f32 v200, v200, v206
  v_add_f32 v209, v209, v215
  v_add_f32 v208, v208, v214
  v_add_f32_dpp v8, v153, v152 row_ror:8 row_mask:0xf bank_mask:0xf
  v_add_f32_dpp v9, v161, v160 row_ror:8 row_mask:0xf bank_mask:0xf
  v_add_f32_dpp v10, v169, v168 row_ror:8 row_mask:0xf bank_mask:0xf
  v_add_f32_dpp v11, v177, v176 row_ror:8 row_mask:0xf bank_mask:0xf
  v_add_f32_dpp v12, v185, v184 row_ror:8 row_mask:0xf bank_mask:0xf
  v_add_f32_dpp v13, v193, v192 row_ror:8 row_mask:0xf bank_mask:0xf
  v_add_f32_dpp v14, v201, v200 row_ror:8 row_mask:0xf bank_mask:0xf
  v_add_f32_dpp v15, v209, v208 row_ror:8 row_mask:0xf bank_mask:0xf
  v_max3_f32 v7, v8, v9, v10
  v_max3_f32 v7, v7, v11, v12
  v_max3_f32 v7, v7, v13, v14
  v_max_f32 v7, v7, v15
  v_mov_b32 v20, v7
  s_nop 1
  v_permlane16_swap_b32 v7, v20
  s_nop 1
  v_max_f32 v7, v7, v20
  v_mov_b32 v20, v7
  s_nop 1
  v_permlane32_swap_b32 v7, v20
  s_nop 1
  v_max_f32 v7, v7, v20
  v_mul_f32 v7, s52, v7
  v_max_f32 v7, v7, v5
  v_sub_f32 v21, v5, v7
  v_exp_f32 v21, v21
  v_mov_b32 v5, v7
  s_waitcnt vmcnt(5)
  s_add_u32 s77, s45, 0x1000
  buffer_load_dwordx4 v[116:119], v1, s[24:27], s77 offen offset:3072 nt
  v_fma_f32 v8, v8, s52, -v5
  v_fma_f32 v9, v9, s52, -v5
  v_fma_f32 v10, v10, s52, -v5
  v_fma_f32 v11, v11, s52, -v5
  v_fma_f32 v12, v12, s52, -v5
  v_fma_f32 v13, v13, s52, -v5
  v_fma_f32 v14, v14, s52, -v5
  v_fma_f32 v15, v15, s52, -v5
  v_exp_f32 v8, v8
  v_exp_f32 v9, v9
  v_exp_f32 v10, v10
  v_exp_f32 v11, v11
  v_exp_f32 v12, v12
  v_exp_f32 v13, v13
  v_exp_f32 v14, v14
  v_exp_f32 v15, v15
  s_nop 0
  v_add_f32 v22, v8, v9
  v_add_f32 v23, v10, v11
  v_add_f32 v7, v12, v13
  v_add_f32 v20, v14, v15
  v_add_f32 v22, v22, v23
  v_add_f32 v7, v7, v20
  v_add_f32 v22, v22, v7
  v_fma_f32 v6, v6, v21, v22
  v_cvt_pk_bf16_f32 v16, v8, v9
  v_cvt_pk_bf16_f32 v17, v10, v11
  v_cvt_pk_bf16_f32 v18, v12, v13
  v_cvt_pk_bf16_f32 v19, v14, v15
  s_mov_b64 exec, s[56:57]
  ds_write_b128 v244, v[16:19] offset:1920
  ds_write_b32 v245, v21 offset:1920
  s_mov_b64 exec, -1
  s_or_b32 s44, s45, 0x17f00
  s_add_u32 s44, s44, 0x100
  s_and_b32 s44, s44, 0x68000
  s_or_b32 s44, s44, s78
  s_or_b32 s44, s44, 0x4000
  s_waitcnt vmcnt(5)
  buffer_load_dwordx4 v[120:123], v1, s[24:27], s44 offen offset:0 nt
  s_or_b32 s45, s44, 0x17f00
  s_add_u32 s45, s45, 0x100
  s_and_b32 s45, s45, 0x68000
  s_or_b32 s45, s45, s78
  s_or_b32 s45, s45, 0x4000
  v_mfma_f32_16x16x32_bf16 v[152:155], a[64:67], v[24:27], 0
  v_mfma_f32_16x16x32_bf16 v[156:159], a[64:67], v[28:31], 0
  v_mfma_f32_16x16x32_bf16 v[160:163], a[68:71], v[24:27], 0
  v_mfma_f32_16x16x32_bf16 v[164:167], a[68:71], v[28:31], 0
  v_mfma_f32_16x16x32_bf16 v[168:171], a[72:75], v[24:27], 0
  v_mfma_f32_16x16x32_bf16 v[172:175], a[72:75], v[28:31], 0
  v_mfma_f32_16x16x32_bf16 v[176:179], a[76:79], v[24:27], 0
  v_mfma_f32_16x16x32_bf16 v[180:183], a[76:79], v[28:31], 0
  v_mfma_f32_16x16x32_bf16 v[184:187], a[80:83], v[24:27], 0
  v_mfma_f32_16x16x32_bf16 v[188:191], a[80:83], v[28:31], 0
  v_mfma_f32_16x16x32_bf16 v[192:195], a[84:87], v[24:27], 0
  v_mfma_f32_16x16x32_bf16 v[196:199], a[84:87], v[28:31], 0
  v_mfma_f32_16x16x32_bf16 v[200:203], a[88:91], v[24:27], 0
  v_mfma_f32_16x16x32_bf16 v[204:207], a[88:91], v[28:31], 0
  v_mfma_f32_16x16x32_bf16 v[208:211], a[92:95], v[24:27], 0
  v_mfma_f32_16x16x32_bf16 v[212:215], a[92:95], v[28:31], 0
  s_waitcnt vmcnt(5)
  buffer_load_dwordx4 v[124:127], v1, s[24:27], s44 offen offset:1024 nt
  s_nop 3
  v_add_f32 v153, v153, v159
  v_add_f32 v152, v152, v158
  v_add_f32 v161, v161, v167
  v_add_f32 v160, v160, v166
  v_add_f32 v169, v169, v175
  v_add_f32 v168, v168, v174
  v_add_f32 v177, v177, v183
  v_add_f32 v176, v176, v182
  v_add_f32 v185, v185, v191
  v_add_f32 v184, v184, v190
  v_add_f32 v193, v193, v199
  v_add_f32 v192, v192, v198
  v_add_f32 v201, v201, v207
  v_add_f32 v200, v200, v206
  v_add_f32 v209, v209, v215
  v_add_f32 v208, v208, v214
  v_add_f32_dpp v8, v153, v152 row_ror:8 row_mask:0xf bank_mask:0xf
  v_add_f32_dpp v9, v161, v160 row_ror:8 row_mask:0xf bank_mask:0xf
  v_add_f32_dpp v10, v169, v168 row_ror:8 row_mask:0xf bank_mask:0xf
  v_add_f32_dpp v11, v177, v176 row_ror:8 row_mask:0xf bank_mask:0xf
  v_add_f32_dpp v12, v185, v184 row_ror:8 row_mask:0xf bank_mask:0xf
  v_add_f32_dpp v13, v193, v192 row_ror:8 row_mask:0xf bank_mask:0xf
  v_add_f32_dpp v14, v201, v200 row_ror:8 row_mask:0xf bank_mask:0xf
  v_add_f32_dpp v15, v209, v208 row_ror:8 row_mask:0xf bank_mask:0xf
  v_max3_f32 v7, v8, v9, v10
  v_max3_f32 v7, v7, v11, v12
  v_max3_f32 v7, v7, v13, v14
  v_max_f32 v7, v7, v15
  v_mov_b32 v20, v7
  s_nop 1
  v_permlane16_swap_b32 v7, v20
  s_nop 1
  v_max_f32 v7, v7, v20
  v_mov_b32 v20, v7
  s_nop 1
  v_permlane32_swap_b32 v7, v20
  s_nop 1
  v_max_f32 v7, v7, v20
  v_mul_f32 v7, s52, v7
  v_max_f32 v7, v7, v5
  v_sub_f32 v21, v5, v7
  v_exp_f32 v21, v21
  v_mov_b32 v5, v7
  s_waitcnt vmcnt(5)
  buffer_load_dwordx4 v[128:131], v1, s[24:27], s44 offen offset:2048 nt
  v_fma_f32 v8, v8, s52, -v5
  v_fma_f32 v9, v9, s52, -v5
  v_fma_f32 v10, v10, s52, -v5
  v_fma_f32 v11, v11, s52, -v5
  v_fma_f32 v12, v12, s52, -v5
  v_fma_f32 v13, v13, s52, -v5
  v_fma_f32 v14, v14, s52, -v5
  v_fma_f32 v15, v15, s52, -v5
  v_exp_f32 v8, v8
  v_exp_f32 v9, v9
  v_exp_f32 v10, v10
  v_exp_f32 v11, v11
  v_exp_f32 v12, v12
  v_exp_f32 v13, v13
  v_exp_f32 v14, v14
  v_exp_f32 v15, v15
  s_nop 0
  v_add_f32 v22, v8, v9
  v_add_f32 v23, v10, v11
  v_add_f32 v7, v12, v13
  v_add_f32 v20, v14, v15
  v_add_f32 v22, v22, v23
  v_add_f32 v7, v7, v20
  v_add_f32 v22, v22, v7
  v_fma_f32 v6, v6, v21, v22
  v_cvt_pk_bf16_f32 v16, v8, v9
  v_cvt_pk_bf16_f32 v17, v10, v11
  v_cvt_pk_bf16_f32 v18, v12, v13
  v_cvt_pk_bf16_f32 v19, v14, v15
  s_mov_b64 exec, s[56:57]
  ds_write_b128 v244, v[16:19] offset:2560
  ds_write_b32 v245, v21 offset:2560
  s_mov_b64 exec, -1
  s_waitcnt vmcnt(5)
  buffer_load_dwordx4 v[132:135], v1, s[24:27], s44 offen offset:3072 nt
  s_waitcnt vmcnt(5)
  s_add_u32 s77, s44, 0x1000
  buffer_load_dwordx4 v[136:139], v1, s[24:27], s77 offen offset:0 nt
  s_waitcnt vmcnt(5)
  s_add_u32 s77, s44, 0x1000
  buffer_load_dwordx4 v[140:143], v1, s[24:27], s77 offen offset:1024 nt
  v_mfma_f32_16x16x32_bf16 v[152:155], v[88:91], v[24:27], 0
  v_mfma_f32_16x16x32_bf16 v[156:159], v[88:91], v[28:31], 0
  v_mfma_f32_16x16x32_bf16 v[160:163], v[92:95], v[24:27], 0
  v_mfma_f32_16x16x32_bf16 v[164:167], v[92:95], v[28:31], 0
  v_mfma_f32_16x16x32_bf16 v[168:171], v[96:99], v[24:27], 0
  v_mfma_f32_16x16x32_bf16 v[172:175], v[96:99], v[28:31], 0
  v_mfma_f32_16x16x32_bf16 v[176:179], v[100:103], v[24:27], 0
  v_mfma_f32_16x16x32_bf16 v[180:183], v[100:103], v[28:31], 0
  v_mfma_f32_16x16x32_bf16 v[184:187], v[104:107], v[24:27], 0
  v_mfma_f32_16x16x32_bf16 v[188:191], v[104:107], v[28:31], 0
  v_mfma_f32_16x16x32_bf16 v[192:195], v[108:111], v[24:27], 0
  v_mfma_f32_16x16x32_bf16 v[196:199], v[108:111], v[28:31], 0
  v_mfma_f32_16x16x32_bf16 v[200:203], v[112:115], v[24:27], 0
  v_mfma_f32_16x16x32_bf16 v[204:207], v[112:115], v[28:31], 0
  v_mfma_f32_16x16x32_bf16 v[208:211], v[116:119], v[24:27], 0
  v_mfma_f32_16x16x32_bf16 v[212:215], v[116:119], v[28:31], 0
  s_waitcnt vmcnt(5)
  s_add_u32 s77, s44, 0x1000
  buffer_load_dwordx4 v[144:147], v1, s[24:27], s77 offen offset:2048 nt
  s_nop 3
  v_add_f32 v153, v153, v159
  v_add_f32 v152, v152, v158
  v_add_f32 v161, v161, v167
  v_add_f32 v160, v160, v166
  v_add_f32 v169, v169, v175
  v_add_f32 v168, v168, v174
  v_add_f32 v177, v177, v183
  v_add_f32 v176, v176, v182
  v_add_f32 v185, v185, v191
  v_add_f32 v184, v184, v190
  v_add_f32 v193, v193, v199
  v_add_f32 v192, v192, v198
  v_add_f32 v201, v201, v207
  v_add_f32 v200, v200, v206
  v_add_f32 v209, v209, v215
  v_add_f32 v208, v208, v214
  v_add_f32_dpp v8, v153, v152 row_ror:8 row_mask:0xf bank_mask:0xf
  v_add_f32_dpp v9, v161, v160 row_ror:8 row_mask:0xf bank_mask:0xf
  v_add_f32_dpp v10, v169, v168 row_ror:8 row_mask:0xf bank_mask:0xf
  v_add_f32_dpp v11, v177, v176 row_ror:8 row_mask:0xf bank_mask:0xf
  v_add_f32_dpp v12, v185, v184 row_ror:8 row_mask:0xf bank_mask:0xf
  v_add_f32_dpp v13, v193, v192 row_ror:8 row_mask:0xf bank_mask:0xf
  v_add_f32_dpp v14, v201, v200 row_ror:8 row_mask:0xf bank_mask:0xf
  v_add_f32_dpp v15, v209, v208 row_ror:8 row_mask:0xf bank_mask:0xf
  v_max3_f32 v7, v8, v9, v10
  v_max3_f32 v7, v7, v11, v12
  v_max3_f32 v7, v7, v13, v14
  v_max_f32 v7, v7, v15
  v_mov_b32 v20, v7
  s_nop 1
  v_permlane16_swap_b32 v7, v20
  s_nop 1
  v_max_f32 v7, v7, v20
  v_mov_b32 v20, v7
  s_nop 1
  v_permlane32_swap_b32 v7, v20
  s_nop 1
  v_max_f32 v7, v7, v20
  v_mul_f32 v7, s52, v7
  v_max_f32 v7, v7, v5
  v_sub_f32 v21, v5, v7
  v_exp_f32 v21, v21
  v_mov_b32 v5, v7
  s_waitcnt vmcnt(5)
  s_add_u32 s77, s44, 0x1000
  buffer_load_dwordx4 v[148:151], v1, s[24:27], s77 offen offset:3072 nt
  v_fma_f32 v8, v8, s52, -v5
  v_fma_f32 v9, v9, s52, -v5
  v_fma_f32 v10, v10, s52, -v5
  v_fma_f32 v11, v11, s52, -v5
  v_fma_f32 v12, v12, s52, -v5
  v_fma_f32 v13, v13, s52, -v5
  v_fma_f32 v14, v14, s52, -v5
  v_fma_f32 v15, v15, s52, -v5
  v_exp_f32 v8, v8
  v_exp_f32 v9, v9
  v_exp_f32 v10, v10
  v_exp_f32 v11, v11
  v_exp_f32 v12, v12
  v_exp_f32 v13, v13
  v_exp_f32 v14, v14
  v_exp_f32 v15, v15
  s_nop 0
  v_add_f32 v22, v8, v9
  v_add_f32 v23, v10, v11
  v_add_f32 v7, v12, v13
  v_add_f32 v20, v14, v15
  v_add_f32 v22, v22, v23
  v_add_f32 v7, v7, v20
  v_add_f32 v22, v22, v7
  v_fma_f32 v6, v6, v21, v22
  v_cvt_pk_bf16_f32 v16, v8, v9
  v_cvt_pk_bf16_f32 v17, v10, v11
  v_cvt_pk_bf16_f32 v18, v12, v13
  v_cvt_pk_bf16_f32 v19, v14, v15
  s_mov_b64 exec, s[56:57]
  ds_write_b128 v244, v[16:19] offset:3200
  ds_write_b32 v245, v21 offset:3200
  s_mov_b64 exec, -1
  s_waitcnt vmcnt(5)
  buffer_load_dwordx4 v[88:91], v1, s[24:27], s45 offen offset:0 nt
  v_mfma_f32_16x16x32_bf16 v[152:155], a[96:99], v[24:27], 0
  v_mfma_f32_16x16x32_bf16 v[156:159], a[96:99], v[28:31], 0
  v_mfma_f32_16x16x32_bf16 v[160:163], a[100:103], v[24:27], 0
  v_mfma_f32_16x16x32_bf16 v[164:167], a[100:103], v[28:31], 0
  v_mfma_f32_16x16x32_bf16 v[168:171], a[104:107], v[24:27], 0
  v_mfma_f32_16x16x32_bf16 v[172:175], a[104:107], v[28:31], 0
  v_mfma_f32_16x16x32_bf16 v[176:179], a[108:111], v[24:27], 0
  v_mfma_f32_16x16x32_bf16 v[180:183], a[108:111], v[28:31], 0
  v_mfma_f32_16x16x32_bf16 v[184:187], a[112:115], v[24:27], 0
  v_mfma_f32_16x16x32_bf16 v[188:191], a[112:115], v[28:31], 0
  v_mfma_f32_16x16x32_bf16 v[192:195], a[116:119], v[24:27], 0
  v_mfma_f32_16x16x32_bf16 v[196:199], a[116:119], v[28:31], 0
  v_mfma_f32_16x16x32_bf16 v[200:203], a[120:123], v[24:27], 0
  v_mfma_f32_16x16x32_bf16 v[204:207], a[120:123], v[28:31], 0
  v_mfma_f32_16x16x32_bf16 v[208:211], a[124:127], v[24:27], 0
  v_mfma_f32_16x16x32_bf16 v[212:215], a[124:127], v[28:31], 0
  s_waitcnt vmcnt(5)
  buffer_load_dwordx4 v[92:95], v1, s[24:27], s45 offen offset:1024 nt
  s_nop 3
  v_add_f32 v153, v153, v159
  v_add_f32 v152, v152, v158
  v_add_f32 v161, v161, v167
  v_add_f32 v160, v160, v166
  v_add_f32 v169, v169, v175
  v_add_f32 v168, v168, v174
  v_add_f32 v177, v177, v183
  v_add_f32 v176, v176, v182
  v_add_f32 v185, v185, v191
  v_add_f32 v184, v184, v190
  v_add_f32 v193, v193, v199
  v_add_f32 v192, v192, v198
  v_add_f32 v201, v201, v207
  v_add_f32 v200, v200, v206
  v_add_f32 v209, v209, v215
  v_add_f32 v208, v208, v214
  v_add_f32_dpp v8, v153, v152 row_ror:8 row_mask:0xf bank_mask:0xf
  v_add_f32_dpp v9, v161, v160 row_ror:8 row_mask:0xf bank_mask:0xf
  v_add_f32_dpp v10, v169, v168 row_ror:8 row_mask:0xf bank_mask:0xf
  v_add_f32_dpp v11, v177, v176 row_ror:8 row_mask:0xf bank_mask:0xf
  v_add_f32_dpp v12, v185, v184 row_ror:8 row_mask:0xf bank_mask:0xf
  v_add_f32_dpp v13, v193, v192 row_ror:8 row_mask:0xf bank_mask:0xf
  v_add_f32_dpp v14, v201, v200 row_ror:8 row_mask:0xf bank_mask:0xf
  v_add_f32_dpp v15, v209, v208 row_ror:8 row_mask:0xf bank_mask:0xf
  v_max3_f32 v7, v8, v9, v10
  v_max3_f32 v7, v7, v11, v12
  v_max3_f32 v7, v7, v13, v14
  v_max_f32 v7, v7, v15
  v_mov_b32 v20, v7
  s_nop 1
  v_permlane16_swap_b32 v7, v20
  s_nop 1
  v_max_f32 v7, v7, v20
  v_mov_b32 v20, v7
  s_nop 1
  v_permlane32_swap_b32 v7, v20
  s_nop 1
  v_max_f32 v7, v7, v20
  v_mul_f32 v7, s52, v7
  v_max_f32 v7, v7, v5
  v_sub_f32 v21, v5, v7
  v_exp_f32 v21, v21
  v_mov_b32 v5, v7
  s_waitcnt vmcnt(5)
  buffer_load_dwordx4 v[96:99], v1, s[24:27], s45 offen offset:2048 nt
  v_fma_f32 v8, v8, s52, -v5
  v_fma_f32 v9, v9, s52, -v5
  v_fma_f32 v10, v10, s52, -v5
  v_fma_f32 v11, v11, s52, -v5
  v_fma_f32 v12, v12, s52, -v5
  v_fma_f32 v13, v13, s52, -v5
  v_fma_f32 v14, v14, s52, -v5
  v_fma_f32 v15, v15, s52, -v5
  v_exp_f32 v8, v8
  v_exp_f32 v9, v9
  v_exp_f32 v10, v10
  v_exp_f32 v11, v11
  v_exp_f32 v12, v12
  v_exp_f32 v13, v13
  v_exp_f32 v14, v14
  v_exp_f32 v15, v15
  s_nop 0
  v_add_f32 v22, v8, v9
  v_add_f32 v23, v10, v11
  v_add_f32 v7, v12, v13
  v_add_f32 v20, v14, v15
  v_add_f32 v22, v22, v23
  v_add_f32 v7, v7, v20
  v_add_f32 v22, v22, v7
  v_fma_f32 v6, v6, v21, v22
  v_cvt_pk_bf16_f32 v16, v8, v9
  v_cvt_pk_bf16_f32 v17, v10, v11
  v_cvt_pk_bf16_f32 v18, v12, v13
  v_cvt_pk_bf16_f32 v19, v14, v15
  s_mov_b64 exec, s[56:57]
  ds_write_b128 v244, v[16:19] offset:3840
  ds_write_b32 v245, v21 offset:3840
  s_mov_b64 exec, -1
  s_waitcnt vmcnt(5)
  buffer_load_dwordx4 v[100:103], v1, s[24:27], s45 offen offset:3072 nt
  s_waitcnt vmcnt(5)
  s_add_u32 s77, s45, 0x1000
  buffer_load_dwordx4 v[104:107], v1, s[24:27], s77 offen offset:0 nt
  s_waitcnt vmcnt(5)
  s_add_u32 s77, s45, 0x1000
  buffer_load_dwordx4 v[108:111], v1, s[24:27], s77 offen offset:1024 nt
  v_mfma_f32_16x16x32_bf16 v[152:155], v[120:123], v[24:27], 0
  v_mfma_f32_16x16x32_bf16 v[156:159], v[120:123], v[28:31], 0
  v_mfma_f32_16x16x32_bf16 v[160:163], v[124:127], v[24:27], 0
  v_mfma_f32_16x16x32_bf16 v[164:167], v[124:127], v[28:31], 0
  v_mfma_f32_16x16x32_bf16 v[168:171], v[128:131], v[24:27], 0
  v_mfma_f32_16x16x32_bf16 v[172:175], v[128:131], v[28:31], 0
  v_mfma_f32_16x16x32_bf16 v[176:179], v[132:135], v[24:27], 0
  v_mfma_f32_16x16x32_bf16 v[180:183], v[132:135], v[28:31], 0
  v_mfma_f32_16x16x32_bf16 v[184:187], v[136:139], v[24:27], 0
  v_mfma_f32_16x16x32_bf16 v[188:191], v[136:139], v[28:31], 0
  v_mfma_f32_16x16x32_bf16 v[192:195], v[140:143], v[24:27], 0
  v_mfma_f32_16x16x32_bf16 v[196:199], v[140:143], v[28:31], 0
  v_mfma_f32_16x16x32_bf16 v[200:203], v[144:147], v[24:27], 0
  v_mfma_f32_16x16x32_bf16 v[204:207], v[144:147], v[28:31], 0
  v_mfma_f32_16x16x32_bf16 v[208:211], v[148:151], v[24:27], 0
  v_mfma_f32_16x16x32_bf16 v[212:215], v[148:151], v[28:31], 0
  s_waitcnt vmcnt(5)
  s_add_u32 s77, s45, 0x1000
  buffer_load_dwordx4 v[112:115], v1, s[24:27], s77 offen offset:2048 nt
  s_nop 3
  v_add_f32 v153, v153, v159
  v_add_f32 v152, v152, v158
  v_add_f32 v161, v161, v167
  v_add_f32 v160, v160, v166
  v_add_f32 v169, v169, v175
  v_add_f32 v168, v168, v174
  v_add_f32 v177, v177, v183
  v_add_f32 v176, v176, v182
  v_add_f32 v185, v185, v191
  v_add_f32 v184, v184, v190
  v_add_f32 v193, v193, v199
  v_add_f32 v192, v192, v198
  v_add_f32 v201, v201, v207
  v_add_f32 v200, v200, v206
  v_add_f32 v209, v209, v215
  v_add_f32 v208, v208, v214
  v_add_f32_dpp v8, v153, v152 row_ror:8 row_mask:0xf bank_mask:0xf
  v_add_f32_dpp v9, v161, v160 row_ror:8 row_mask:0xf bank_mask:0xf
  v_add_f32_dpp v10, v169, v168 row_ror:8 row_mask:0xf bank_mask:0xf
  v_add_f32_dpp v11, v177, v176 row_ror:8 row_mask:0xf bank_mask:0xf
  v_add_f32_dpp v12, v185, v184 row_ror:8 row_mask:0xf bank_mask:0xf
  v_add_f32_dpp v13, v193, v192 row_ror:8 row_mask:0xf bank_mask:0xf
  v_add_f32_dpp v14, v201, v200 row_ror:8 row_mask:0xf bank_mask:0xf
  v_add_f32_dpp v15, v209, v208 row_ror:8 row_mask:0xf bank_mask:0xf
  v_max3_f32 v7, v8, v9, v10
  v_max3_f32 v7, v7, v11, v12
  v_max3_f32 v7, v7, v13, v14
  v_max_f32 v7, v7, v15
  v_mov_b32 v20, v7
  s_nop 1
  v_permlane16_swap_b32 v7, v20
  s_nop 1
  v_max_f32 v7, v7, v20
  v_mov_b32 v20, v7
  s_nop 1
  v_permlane32_swap_b32 v7, v20
  s_nop 1
  v_max_f32 v7, v7, v20
  v_mul_f32 v7, s52, v7
  v_max_f32 v7, v7, v5
  v_sub_f32 v21, v5, v7
  v_exp_f32 v21, v21
  v_mov_b32 v5, v7
  s_waitcnt vmcnt(5)
  s_add_u32 s77, s45, 0x1000
  buffer_load_dwordx4 v[116:119], v1, s[24:27], s77 offen offset:3072 nt
  v_fma_f32 v8, v8, s52, -v5
  v_fma_f32 v9, v9, s52, -v5
  v_fma_f32 v10, v10, s52, -v5
  v_fma_f32 v11, v11, s52, -v5
  v_fma_f32 v12, v12, s52, -v5
  v_fma_f32 v13, v13, s52, -v5
  v_fma_f32 v14, v14, s52, -v5
  v_fma_f32 v15, v15, s52, -v5
  v_exp_f32 v8, v8
  v_exp_f32 v9, v9
  v_exp_f32 v10, v10
  v_exp_f32 v11, v11
  v_exp_f32 v12, v12
  v_exp_f32 v13, v13
  v_exp_f32 v14, v14
  v_exp_f32 v15, v15
  s_nop 0
  v_add_f32 v22, v8, v9
  v_add_f32 v23, v10, v11
  v_add_f32 v7, v12, v13
  v_add_f32 v20, v14, v15
  v_add_f32 v22, v22, v23
  v_add_f32 v7, v7, v20
  v_add_f32 v22, v22, v7
  v_fma_f32 v6, v6, v21, v22
  v_cvt_pk_bf16_f32 v16, v8, v9
  v_cvt_pk_bf16_f32 v17, v10, v11
  v_cvt_pk_bf16_f32 v18, v12, v13
  v_cvt_pk_bf16_f32 v19, v14, v15
  s_mov_b64 exec, s[56:57]
  ds_write_b128 v244, v[16:19] offset:4480
  ds_write_b32 v245, v21 offset:4480
  s_mov_b64 exec, -1
  s_or_b32 s44, s45, 0x17f00
  s_add_u32 s44, s44, 0x100
  s_and_b32 s44, s44, 0x68000
  s_or_b32 s44, s44, s78
  s_or_b32 s44, s44, 0x4000
  s_waitcnt vmcnt(5)
  buffer_load_dwordx4 v[120:123], v1, s[24:27], s44 offen offset:0 nt
  s_or_b32 s45, s44, 0x17f00
  s_add_u32 s45, s45, 0x100
  s_and_b32 s45, s45, 0x68000
  s_or_b32 s45, s45, s78
  s_or_b32 s45, s45, 0x4000
  v_mfma_f32_16x16x32_bf16 v[152:155], a[128:131], v[24:27], 0
  v_mfma_f32_16x16x32_bf16 v[156:159], a[128:131], v[28:31], 0
  v_mfma_f32_16x16x32_bf16 v[160:163], a[132:135], v[24:27], 0
  v_mfma_f32_16x16x32_bf16 v[164:167], a[132:135], v[28:31], 0
  v_mfma_f32_16x16x32_bf16 v[168:171], a[136:139], v[24:27], 0
  v_mfma_f32_16x16x32_bf16 v[172:175], a[136:139], v[28:31], 0
  v_mfma_f32_16x16x32_bf16 v[176:179], a[140:143], v[24:27], 0
  v_mfma_f32_16x16x32_bf16 v[180:183], a[140:143], v[28:31], 0
  v_mfma_f32_16x16x32_bf16 v[184:187], a[144:147], v[24:27], 0
  v_mfma_f32_16x16x32_bf16 v[188:191], a[144:147], v[28:31], 0
  v_mfma_f32_16x16x32_bf16 v[192:195], a[148:151], v[24:27], 0
  v_mfma_f32_16x16x32_bf16 v[196:199], a[148:151], v[28:31], 0
  v_mfma_f32_16x16x32_bf16 v[200:203], a[152:155], v[24:27], 0
  v_mfma_f32_16x16x32_bf16 v[204:207], a[152:155], v[28:31], 0
  v_mfma_f32_16x16x32_bf16 v[208:211], a[156:159], v[24:27], 0
  v_mfma_f32_16x16x32_bf16 v[212:215], a[156:159], v[28:31], 0
  s_waitcnt vmcnt(5)
  buffer_load_dwordx4 v[124:127], v1, s[24:27], s44 offen offset:1024 nt
  s_nop 3
  v_add_f32 v153, v153, v159
  v_add_f32 v152, v152, v158
  v_add_f32 v161, v161, v167
  v_add_f32 v160, v160, v166
  v_add_f32 v169, v169, v175
  v_add_f32 v168, v168, v174
  v_add_f32 v177, v177, v183
  v_add_f32 v176, v176, v182
  v_add_f32 v185, v185, v191
  v_add_f32 v184, v184, v190
  v_add_f32 v193, v193, v199
  v_add_f32 v192, v192, v198
  v_add_f32 v201, v201, v207
  v_add_f32 v200, v200, v206
  v_add_f32 v209, v209, v215
  v_add_f32 v208, v208, v214
  v_add_f32_dpp v8, v153, v152 row_ror:8 row_mask:0xf bank_mask:0xf
  v_add_f32_dpp v9, v161, v160 row_ror:8 row_mask:0xf bank_mask:0xf
  v_add_f32_dpp v10, v169, v168 row_ror:8 row_mask:0xf bank_mask:0xf
  v_add_f32_dpp v11, v177, v176 row_ror:8 row_mask:0xf bank_mask:0xf
  v_add_f32_dpp v12, v185, v184 row_ror:8 row_mask:0xf bank_mask:0xf
  v_add_f32_dpp v13, v193, v192 row_ror:8 row_mask:0xf bank_mask:0xf
  v_add_f32_dpp v14, v201, v200 row_ror:8 row_mask:0xf bank_mask:0xf
  v_add_f32_dpp v15, v209, v208 row_ror:8 row_mask:0xf bank_mask:0xf
  v_max3_f32 v7, v8, v9, v10
  v_max3_f32 v7, v7, v11, v12
  v_max3_f32 v7, v7, v13, v14
  v_max_f32 v7, v7, v15
  v_mov_b32 v20, v7
  s_nop 1
  v_permlane16_swap_b32 v7, v20
  s_nop 1
  v_max_f32 v7, v7, v20
  v_mov_b32 v20, v7
  s_nop 1
  v_permlane32_swap_b32 v7, v20
  s_nop 1
  v_max_f32 v7, v7, v20
  v_mul_f32 v7, s52, v7
  v_max_f32 v7, v7, v5
  v_sub_f32 v21, v5, v7
  v_exp_f32 v21, v21
  v_mov_b32 v5, v7
  s_waitcnt vmcnt(5)
  buffer_load_dwordx4 v[128:131], v1, s[24:27], s44 offen offset:2048 nt
  v_fma_f32 v8, v8, s52, -v5
  v_fma_f32 v9, v9, s52, -v5
  v_fma_f32 v10, v10, s52, -v5
  v_fma_f32 v11, v11, s52, -v5
  v_fma_f32 v12, v12, s52, -v5
  v_fma_f32 v13, v13, s52, -v5
  v_fma_f32 v14, v14, s52, -v5
  v_fma_f32 v15, v15, s52, -v5
  v_exp_f32 v8, v8
  v_exp_f32 v9, v9
  v_exp_f32 v10, v10
  v_exp_f32 v11, v11
  v_exp_f32 v12, v12
  v_exp_f32 v13, v13
  v_exp_f32 v14, v14
  v_exp_f32 v15, v15
  s_nop 0
  v_add_f32 v22, v8, v9
  v_add_f32 v23, v10, v11
  v_add_f32 v7, v12, v13
  v_add_f32 v20, v14, v15
  v_add_f32 v22, v22, v23
  v_add_f32 v7, v7, v20
  v_add_f32 v22, v22, v7
  v_fma_f32 v6, v6, v21, v22
  v_cvt_pk_bf16_f32 v16, v8, v9
  v_cvt_pk_bf16_f32 v17, v10, v11
  v_cvt_pk_bf16_f32 v18, v12, v13
  v_cvt_pk_bf16_f32 v19, v14, v15
  s_mov_b64 exec, s[56:57]
  ds_write_b128 v244, v[16:19] offset:5120
  ds_write_b32 v245, v21 offset:5120
  s_mov_b64 exec, -1
  s_waitcnt vmcnt(5)
  buffer_load_dwordx4 v[132:135], v1, s[24:27], s44 offen offset:3072 nt
  s_waitcnt vmcnt(5)
  s_add_u32 s77, s44, 0x1000
  buffer_load_dwordx4 v[136:139], v1, s[24:27], s77 offen offset:0 nt
  s_waitcnt vmcnt(5)
  s_add_u32 s77, s44, 0x1000
  buffer_load_dwordx4 v[140:143], v1, s[24:27], s77 offen offset:1024 nt
  v_mfma_f32_16x16x32_bf16 v[152:155], v[88:91], v[24:27], 0
  v_mfma_f32_16x16x32_bf16 v[156:159], v[88:91], v[28:31], 0
  v_mfma_f32_16x16x32_bf16 v[160:163], v[92:95], v[24:27], 0
  v_mfma_f32_16x16x32_bf16 v[164:167], v[92:95], v[28:31], 0
  v_mfma_f32_16x16x32_bf16 v[168:171], v[96:99], v[24:27], 0
  v_mfma_f32_16x16x32_bf16 v[172:175], v[96:99], v[28:31], 0
  v_mfma_f32_16x16x32_bf16 v[176:179], v[100:103], v[24:27], 0
  v_mfma_f32_16x16x32_bf16 v[180:183], v[100:103], v[28:31], 0
  v_mfma_f32_16x16x32_bf16 v[184:187], v[104:107], v[24:27], 0
  v_mfma_f32_16x16x32_bf16 v[188:191], v[104:107], v[28:31], 0
  v_mfma_f32_16x16x32_bf16 v[192:195], v[108:111], v[24:27], 0
  v_mfma_f32_16x16x32_bf16 v[196:199], v[108:111], v[28:31], 0
  v_mfma_f32_16x16x32_bf16 v[200:203], v[112:115], v[24:27], 0
  v_mfma_f32_16x16x32_bf16 v[204:207], v[112:115], v[28:31], 0
  v_mfma_f32_16x16x32_bf16 v[208:211], v[116:119], v[24:27], 0
  v_mfma_f32_16x16x32_bf16 v[212:215], v[116:119], v[28:31], 0
  s_waitcnt vmcnt(5)
  s_add_u32 s77, s44, 0x1000
  buffer_load_dwordx4 v[144:147], v1, s[24:27], s77 offen offset:2048 nt
  s_nop 3
  v_add_f32 v153, v153, v159
  v_add_f32 v152, v152, v158
  v_add_f32 v161, v161, v167
  v_add_f32 v160, v160, v166
  v_add_f32 v169, v169, v175
  v_add_f32 v168, v168, v174
  v_add_f32 v177, v177, v183
  v_add_f32 v176, v176, v182
  v_add_f32 v185, v185, v191
  v_add_f32 v184, v184, v190
  v_add_f32 v193, v193, v199
  v_add_f32 v192, v192, v198
  v_add_f32 v201, v201, v207
  v_add_f32 v200, v200, v206
  v_add_f32 v209, v209, v215
  v_add_f32 v208, v208, v214
  v_add_f32_dpp v8, v153, v152 row_ror:8 row_mask:0xf bank_mask:0xf
  v_add_f32_dpp v9, v161, v160 row_ror:8 row_mask:0xf bank_mask:0xf
  v_add_f32_dpp v10, v169, v168 row_ror:8 row_mask:0xf bank_mask:0xf
  v_add_f32_dpp v11, v177, v176 row_ror:8 row_mask:0xf bank_mask:0xf
  v_add_f32_dpp v12, v185, v184 row_ror:8 row_mask:0xf bank_mask:0xf
  v_add_f32_dpp v13, v193, v192 row_ror:8 row_mask:0xf bank_mask:0xf
  v_add_f32_dpp v14, v201, v200 row_ror:8 row_mask:0xf bank_mask:0xf
  v_add_f32_dpp v15, v209, v208 row_ror:8 row_mask:0xf bank_mask:0xf
  v_max3_f32 v7, v8, v9, v10
  v_max3_f32 v7, v7, v11, v12
  v_max3_f32 v7, v7, v13, v14
  v_max_f32 v7, v7, v15
  v_mov_b32 v20, v7
  s_nop 1
  v_permlane16_swap_b32 v7, v20
  s_nop 1
  v_max_f32 v7, v7, v20
  v_mov_b32 v20, v7
  s_nop 1
  v_permlane32_swap_b32 v7, v20
  s_nop 1
  v_max_f32 v7, v7, v20
  v_mul_f32 v7, s52, v7
  v_max_f32 v7, v7, v5
  v_sub_f32 v21, v5, v7
  v_exp_f32 v21, v21
  v_mov_b32 v5, v7
  s_waitcnt vmcnt(5)
  s_add_u32 s77, s44, 0x1000
  buffer_load_dwordx4 v[148:151], v1, s[24:27], s77 offen offset:3072 nt
  v_fma_f32 v8, v8, s52, -v5
  v_fma_f32 v9, v9, s52, -v5
  v_fma_f32 v10, v10, s52, -v5
  v_fma_f32 v11, v11, s52, -v5
  v_fma_f32 v12, v12, s52, -v5
  v_fma_f32 v13, v13, s52, -v5
  v_fma_f32 v14, v14, s52, -v5
  v_fma_f32 v15, v15, s52, -v5
  v_exp_f32 v8, v8
  v_exp_f32 v9, v9
  v_exp_f32 v10, v10
  v_exp_f32 v11, v11
  v_exp_f32 v12, v12
  v_exp_f32 v13, v13
  v_exp_f32 v14, v14
  v_exp_f32 v15, v15
  s_nop 0
  v_add_f32 v22, v8, v9
  v_add_f32 v23, v10, v11
  v_add_f32 v7, v12, v13
  v_add_f32 v20, v14, v15
  v_add_f32 v22, v22, v23
  v_add_f32 v7, v7, v20
  v_add_f32 v22, v22, v7
  v_fma_f32 v6, v6, v21, v22
  v_cvt_pk_bf16_f32 v16, v8, v9
  v_cvt_pk_bf16_f32 v17, v10, v11
  v_cvt_pk_bf16_f32 v18, v12, v13
  v_cvt_pk_bf16_f32 v19, v14, v15
  s_mov_b64 exec, s[56:57]
  ds_write_b128 v244, v[16:19] offset:5760
  ds_write_b32 v245, v21 offset:5760
  s_mov_b64 exec, -1
  s_mov_b32 s54, 0x20000
L_nonp:
  v_readfirstlane_b32 s55, v255
  s_cmp_lg_u32 s55, 0
  s_cbranch_scc1 L_nond
  s_sub_u32 s54, s54, 1
  s_cmp_eq_u32 s54, 0
  s_cbranch_scc1 L_nond
  buffer_load_dword v255, off, s[80:83], 0 sc1
  s_waitcnt vmcnt(0)
  s_branch L_nonp
L_nond:
  s_mul_i32 s3, s55, 0x9e3779b1
  v_mov_b32 v254, s3
  s_and_b32 s48, s2, 7
  s_lshl_b32 s95, s48, 7
  s_lshr_b32 s48, s2, 3
  s_lshl_b32 s48, s48, 2
  s_add_u32 s95, s95, s48
  s_add_u32 s95, s95, 0x310000
  s_getreg_b32 s5, hwreg(HW_REG_XCC_ID)
  s_and_b32 s5, s5, 15
  s_lshl_b32 s5, s5, 1
  s_waitcnt vmcnt(5)
  buffer_load_dwordx4 v[88:91], v1, s[24:27], s45 offen offset:0 nt
  v_mfma_f32_16x16x32_bf16 v[152:155], a[160:163], v[24:27], 0
  v_mfma_f32_16x16x32_bf16 v[156:159], a[160:163], v[28:31], 0
  v_mfma_f32_16x16x32_bf16 v[160:163], a[164:167], v[24:27], 0
  v_mfma_f32_16x16x32_bf16 v[164:167], a[164:167], v[28:31], 0
  v_mfma_f32_16x16x32_bf16 v[168:171], a[168:171], v[24:27], 0
  v_mfma_f32_16x16x32_bf16 v[172:175], a[168:171], v[28:31], 0
  v_mfma_f32_16x16x32_bf16 v[176:179], a[172:175], v[24:27], 0
  v_mfma_f32_16x16x32_bf16 v[180:183], a[172:175], v[28:31], 0
  v_mfma_f32_16x16x32_bf16 v[184:187], a[176:179], v[24:27], 0
  v_mfma_f32_16x16x32_bf16 v[188:191], a[176:179], v[28:31], 0
  v_mfma_f32_16x16x32_bf16 v[192:195], a[180:183], v[24:27], 0
  v_mfma_f32_16x16x32_bf16 v[196:199], a[180:183], v[28:31], 0
  v_mfma_f32_16x16x32_bf16 v[200:203], a[184:187], v[24:27], 0
  v_mfma_f32_16x16x32_bf16 v[204:207], a[184:187], v[28:31], 0
  v_mfma_f32_16x16x32_bf16 v[208:211], a[188:191], v[24:27], 0
  v_mfma_f32_16x16x32_bf16 v[212:215], a[188:191], v[28:31], 0
  s_waitcnt vmcnt(5)
  buffer_load_dwordx4 v[92:95], v1, s[24:27], s45 offen offset:1024 nt
  s_nop 3
  v_add_f32 v153, v153, v159
  v_add_f32 v152, v152, v158
  v_add_f32 v161, v161, v167
  v_add_f32 v160, v160, v166
  v_add_f32 v169, v169, v175
  v_add_f32 v168, v168, v174
  v_add_f32 v177, v177, v183
  v_add_f32 v176, v176, v182
  v_add_f32 v185, v185, v191
  v_add_f32 v184, v184, v190
  v_add_f32 v193, v193, v199
  v_add_f32 v192, v192, v198
  v_add_f32 v201, v201, v207
  v_add_f32 v200, v200, v206
  v_add_f32 v209, v209, v215
  v_add_f32 v208, v208, v214
  v_add_f32_dpp v8, v153, v152 row_ror:8 row_mask:0xf bank_mask:0xf
  v_add_f32_dpp v9, v161, v160 row_ror:8 row_mask:0xf bank_mask:0xf
  v_add_f32_dpp v10, v169, v168 row_ror:8 row_mask:0xf bank_mask:0xf
  v_add_f32_dpp v11, v177, v176 row_ror:8 row_mask:0xf bank_mask:0xf
  v_add_f32_dpp v12, v185, v184 row_ror:8 row_mask:0xf bank_mask:0xf
  v_add_f32_dpp v13, v193, v192 row_ror:8 row_mask:0xf bank_mask:0xf
  v_add_f32_dpp v14, v201, v200 row_ror:8 row_mask:0xf bank_mask:0xf
  v_add_f32_dpp v15, v209, v208 row_ror:8 row_mask:0xf bank_mask:0xf
  v_max3_f32 v7, v8, v9, v10
  v_max3_f32 v7, v7, v11, v12
  v_max3_f32 v7, v7, v13, v14
  v_max_f32 v7, v7, v15
  v_mov_b32 v20, v7
  s_nop 1
  v_permlane16_swap_b32 v7, v20
  s_nop 1
  v_max_f32 v7, v7, v20
  v_mov_b32 v20, v7
  s_nop 1
  v_permlane32_swap_b32 v7, v20
  s_nop 1
  v_max_f32 v7, v7, v20
  v_mul_f32 v7, s52, v7
  v_max_f32 v7, v7, v5
  v_sub_f32 v21, v5, v7
  v_exp_f32 v21, v21
  v_mov_b32 v5, v7
  s_waitcnt vmcnt(5)
  buffer_load_dwordx4 v[96:99], v1, s[24:27], s45 offen offset:2048 nt
  v_fma_f32 v8, v8, s52, -v5
  v_fma_f32 v9, v9, s52, -v5
  v_fma_f32 v10, v10, s52, -v5
  v_fma_f32 v11, v11, s52, -v5
  v_fma_f32 v12, v12, s52, -v5
  v_fma_f32 v13, v13, s52, -v5
  v_fma_f32 v14, v14, s52, -v5
  v_fma_f32 v15, v15, s52, -v5
  v_exp_f32 v8, v8
  v_exp_f32 v9, v9
  v_exp_f32 v10, v10
  v_exp_f32 v11, v11
  v_exp_f32 v12, v12
  v_exp_f32 v13, v13
  v_exp_f32 v14, v14
  v_exp_f32 v15, v15
  s_nop 0
  v_add_f32 v22, v8, v9
  v_add_f32 v23, v10, v11
  v_add_f32 v7, v12, v13
  v_add_f32 v20, v14, v15
  v_add_f32 v22, v22, v23
  v_add_f32 v7, v7, v20
  v_add_f32 v22, v22, v7
  v_fma_f32 v6, v6, v21, v22
  v_cvt_pk_bf16_f32 v16, v8, v9
  v_cvt_pk_bf16_f32 v17, v10, v11
  v_cvt_pk_bf16_f32 v18, v12, v13
  v_cvt_pk_bf16_f32 v19, v14, v15
  s_mov_b64 exec, s[56:57]
  ds_write_b128 v244, v[16:19] offset:6400
  ds_write_b32 v245, v21 offset:6400
  s_mov_b64 exec, -1
  s_waitcnt vmcnt(5)
  buffer_load_dwordx4 v[100:103], v1, s[24:27], s45 offen offset:3072 nt
  s_waitcnt vmcnt(5)
  s_add_u32 s77, s45, 0x1000
  buffer_load_dwordx4 v[104:107], v1, s[24:27], s77 offen offset:0 nt
  s_waitcnt vmcnt(5)
  s_add_u32 s77, s45, 0x1000
  buffer_load_dwordx4 v[108:111], v1, s[24:27], s77 offen offset:1024 nt
  v_mfma_f32_16x16x32_bf16 v[152:155], v[120:123], v[24:27], 0
  v_mfma_f32_16x16x32_bf16 v[156:159], v[120:123], v[28:31], 0
  v_mfma_f32_16x16x32_bf16 v[160:163], v[124:127], v[24:27], 0
  v_mfma_f32_16x16x32_bf16 v[164:167], v[124:127], v[28:31], 0
  v_mfma_f32_16x16x32_bf16 v[168:171], v[128:131], v[24:27], 0
  v_mfma_f32_16x16x32_bf16 v[172:175], v[128:131], v[28:31], 0
  v_mfma_f32_16x16x32_bf16 v[176:179], v[132:135], v[24:27], 0
  v_mfma_f32_16x16x32_bf16 v[180:183], v[132:135], v[28:31], 0
  v_mfma_f32_16x16x32_bf16 v[184:187], v[136:139], v[24:27], 0
  v_mfma_f32_16x16x32_bf16 v[188:191], v[136:139], v[28:31], 0
  v_mfma_f32_16x16x32_bf16 v[192:195], v[140:143], v[24:27], 0
  v_mfma_f32_16x16x32_bf16 v[196:199], v[140:143], v[28:31], 0
  v_mfma_f32_16x16x32_bf16 v[200:203], v[144:147], v[24:27], 0
  v_mfma_f32_16x16x32_bf16 v[204:207], v[144:147], v[28:31], 0
  v_mfma_f32_16x16x32_bf16 v[208:211], v[148:151], v[24:27], 0
  v_mfma_f32_16x16x32_bf16 v[212:215], v[148:151], v[28:31], 0
  s_waitcnt vmcnt(5)
  s_add_u32 s77, s45, 0x1000
  buffer_load_dwordx4 v[112:115], v1, s[24:27], s77 offen offset:2048 nt
  s_nop 3
  v_add_f32 v153, v153, v159
  v_add_f32 v152, v152, v158
  v_add_f32 v161, v161, v167
  v_add_f32 v160, v160, v166
  v_add_f32 v169, v169, v175
  v_add_f32 v168, v168, v174
  v_add_f32 v177, v177, v183
  v_add_f32 v176, v176, v182
  v_add_f32 v185, v185, v191
  v_add_f32 v184, v184, v190
  v_add_f32 v193, v193, v199
  v_add_f32 v192, v192, v198
  v_add_f32 v201, v201, v207
  v_add_f32 v200, v200, v206
  v_add_f32 v209, v209, v215
  v_add_f32 v208, v208, v214
  v_add_f32_dpp v8, v153, v152 row_ror:8 row_mask:0xf bank_mask:0xf
  v_add_f32_dpp v9, v161, v160 row_ror:8 row_mask:0xf bank_mask:0xf
  v_add_f32_dpp v10, v169, v168 row_ror:8 row_mask:0xf bank_mask:0xf
  v_add_f32_dpp v11, v177, v176 row_ror:8 row_mask:0xf bank_mask:0xf
  v_add_f32_dpp v12, v185, v184 row_ror:8 row_mask:0xf bank_mask:0xf
  v_add_f32_dpp v13, v193, v192 row_ror:8 row_mask:0xf bank_mask:0xf
  v_add_f32_dpp v14, v201, v200 row_ror:8 row_mask:0xf bank_mask:0xf
  v_add_f32_dpp v15, v209, v208 row_ror:8 row_mask:0xf bank_mask:0xf
  v_max3_f32 v7, v8, v9, v10
  v_max3_f32 v7, v7, v11, v12
  v_max3_f32 v7, v7, v13, v14
  v_max_f32 v7, v7, v15
  v_mov_b32 v20, v7
  s_nop 1
  v_permlane16_swap_b32 v7, v20
  s_nop 1
  v_max_f32 v7, v7, v20
  v_mov_b32 v20, v7
  s_nop 1
  v_permlane32_swap_b32 v7, v20
  s_nop 1
  v_max_f32 v7, v7, v20
  v_mul_f32 v7, s52, v7
  v_max_f32 v7, v7, v5
  v_sub_f32 v21, v5, v7
  v_exp_f32 v21, v21
  v_mov_b32 v5, v7
  s_waitcnt vmcnt(5)
  s_add_u32 s77, s45, 0x1000
  buffer_load_dwordx4 v[116:119], v1, s[24:27], s77 offen offset:3072 nt
  v_fma_f32 v8, v8, s52, -v5
  v_fma_f32 v9, v9, s52, -v5
  v_fma_f32 v10, v10, s52, -v5
  v_fma_f32 v11, v11, s52, -v5
  v_fma_f32 v12, v12, s52, -v5
  v_fma_f32 v13, v13, s52, -v5
  v_fma_f32 v14, v14, s52, -v5
  v_fma_f32 v15, v15, s52, -v5
  v_exp_f32 v8, v8
  v_exp_f32 v9, v9
  v_exp_f32 v10, v10
  v_exp_f32 v11, v11
  v_exp_f32 v12, v12
  v_exp_f32 v13, v13
  v_exp_f32 v14, v14
  v_exp_f32 v15, v15
  s_nop 0
  v_add_f32 v22, v8, v9
  v_add_f32 v23, v10, v11
  v_add_f32 v7, v12, v13
  v_add_f32 v20, v14, v15
  v_add_f32 v22, v22, v23
  v_add_f32 v7, v7, v20
  v_add_f32 v22, v22, v7
  v_fma_f32 v6, v6, v21, v22
  v_cvt_pk_bf16_f32 v16, v8, v9
  v_cvt_pk_bf16_f32 v17, v10, v11
  v_cvt_pk_bf16_f32 v18, v12, v13
  v_cvt_pk_bf16_f32 v19, v14, v15
  s_mov_b64 exec, s[56:57]
  ds_write_b128 v244, v[16:19] offset:7040
  ds_write_b32 v245, v21 offset:7040
  s_mov_b64 exec, -1
  s_or_b32 s44, s45, 0x17f00
  s_add_u32 s44, s44, 0x100
  s_and_b32 s44, s44, 0x68000
  s_or_b32 s44, s44, s78
  s_or_b32 s44, s44, 0x4000
  s_waitcnt vmcnt(5)
  buffer_load_dwordx4 v[120:123], v1, s[24:27], s44 offen offset:0 nt
  s_or_b32 s45, s44, 0x17f00
  s_add_u32 s45, s45, 0x100
  s_and_b32 s45, s45, 0x68000
  s_or_b32 s45, s45, s78
  v_mfma_f32_16x16x32_bf16 v[152:155], a[192:195], v[24:27], 0
  v_mfma_f32_16x16x32_bf16 v[156:159], a[192:195], v[28:31], 0
  v_mfma_f32_16x16x32_bf16 v[160:163], a[196:199], v[24:27], 0
  v_mfma_f32_16x16x32_bf16 v[164:167], a[196:199], v[28:31], 0
  v_mfma_f32_16x16x32_bf16 v[168:171], a[200:203], v[24:27], 0
  v_mfma_f32_16x16x32_bf16 v[172:175], a[200:203], v[28:31], 0
  v_mfma_f32_16x16x32_bf16 v[176:179], a[204:207], v[24:27], 0
  v_mfma_f32_16x16x32_bf16 v[180:183], a[204:207], v[28:31], 0
  v_mfma_f32_16x16x32_bf16 v[184:187], a[208:211], v[24:27], 0
  v_mfma_f32_16x16x32_bf16 v[188:191], a[208:211], v[28:31], 0
  v_mfma_f32_16x16x32_bf16 v[192:195], a[212:215], v[24:27], 0
  v_mfma_f32_16x16x32_bf16 v[196:199], a[212:215], v[28:31], 0
  v_mfma_f32_16x16x32_bf16 v[200:203], a[216:219], v[24:27], 0
  v_mfma_f32_16x16x32_bf16 v[204:207], a[216:219], v[28:31], 0
  v_mfma_f32_16x16x32_bf16 v[208:211], a[220:223], v[24:27], 0
  v_mfma_f32_16x16x32_bf16 v[212:215], a[220:223], v[28:31], 0
  s_waitcnt vmcnt(5)
  buffer_load_dwordx4 v[124:127], v1, s[24:27], s44 offen offset:1024 nt
  s_nop 3
  v_add_f32 v153, v153, v159
  v_add_f32 v152, v152, v158
  v_add_f32 v161, v161, v167
  v_add_f32 v160, v160, v166
  v_add_f32 v169, v169, v175
  v_add_f32 v168, v168, v174
  v_add_f32 v177, v177, v183
  v_add_f32 v176, v176, v182
  v_add_f32 v185, v185, v191
  v_add_f32 v184, v184, v190
  v_add_f32 v193, v193, v199
  v_add_f32 v192, v192, v198
  v_add_f32 v201, v201, v207
  v_add_f32 v200, v200, v206
  v_add_f32 v209, v209, v215
  v_add_f32 v208, v208, v214
  v_add_f32_dpp v8, v153, v152 row_ror:8 row_mask:0xf bank_mask:0xf
  v_add_f32_dpp v9, v161, v160 row_ror:8 row_mask:0xf bank_mask:0xf
  v_add_f32_dpp v10, v169, v168 row_ror:8 row_mask:0xf bank_mask:0xf
  v_add_f32_dpp v11, v177, v176 row_ror:8 row_mask:0xf bank_mask:0xf
  v_add_f32_dpp v12, v185, v184 row_ror:8 row_mask:0xf bank_mask:0xf
  v_add_f32_dpp v13, v193, v192 row_ror:8 row_mask:0xf bank_mask:0xf
  v_add_f32_dpp v14, v201, v200 row_ror:8 row_mask:0xf bank_mask:0xf
  v_add_f32_dpp v15, v209, v208 row_ror:8 row_mask:0xf bank_mask:0xf
  v_max3_f32 v7, v8, v9, v10
  v_max3_f32 v7, v7, v11, v12
  v_max3_f32 v7, v7, v13, v14
  v_max_f32 v7, v7, v15
  v_mov_b32 v20, v7
  s_nop 1
  v_permlane16_swap_b32 v7, v20
  s_nop 1
  v_max_f32 v7, v7, v20
  v_mov_b32 v20, v7
  s_nop 1
  v_permlane32_swap_b32 v7, v20
  s_nop 1
  v_max_f32 v7, v7, v20
  v_mul_f32 v7, s52, v7
  v_max_f32 v7, v7, v5
  v_sub_f32 v21, v5, v7
  v_exp_f32 v21, v21
  v_mov_b32 v5, v7
  s_waitcnt vmcnt(5)
  buffer_load_dwordx4 v[128:131], v1, s[24:27], s44 offen offset:2048 nt
  v_fma_f32 v8, v8, s52, -v5
  v_fma_f32 v9, v9, s52, -v5
  v_fma_f32 v10, v10, s52, -v5
  v_fma_f32 v11, v11, s52, -v5
  v_fma_f32 v12, v12, s52, -v5
  v_fma_f32 v13, v13, s52, -v5
  v_fma_f32 v14, v14, s52, -v5
  v_fma_f32 v15, v15, s52, -v5
  v_exp_f32 v8, v8
  v_exp_f32 v9, v9
  v_exp_f32 v10, v10
  v_exp_f32 v11, v11
  v_exp_f32 v12, v12
  v_exp_f32 v13, v13
  v_exp_f32 v14, v14
  v_exp_f32 v15, v15
  s_nop 0
  v_add_f32 v22, v8, v9
  v_add_f32 v23, v10, v11
  v_add_f32 v7, v12, v13
  v_add_f32 v20, v14, v15
  v_add_f32 v22, v22, v23
  v_add_f32 v7, v7, v20
  v_add_f32 v22, v22, v7
  v_fma_f32 v6, v6, v21, v22
  v_cvt_pk_bf16_f32 v16, v8, v9
  v_cvt_pk_bf16_f32 v17, v10, v11
  v_cvt_pk_bf16_f32 v18, v12, v13
  v_cvt_pk_bf16_f32 v19, v14, v15
  s_mov_b64 exec, s[56:57]
  ds_write_b128 v244, v[16:19] offset:7680
  ds_write_b32 v245, v21 offset:7680
  s_mov_b64 exec, -1
  s_waitcnt vmcnt(5)
  buffer_load_dwordx4 v[132:135], v1, s[24:27], s44 offen offset:3072 nt
  s_waitcnt vmcnt(5)
  s_add_u32 s77, s44, 0x1000
  buffer_load_dwordx4 v[136:139], v1, s[24:27], s77 offen offset:0 nt
  s_waitcnt vmcnt(5)
  s_add_u32 s77, s44, 0x1000
  buffer_load_dwordx4 v[140:143], v1, s[24:27], s77 offen offset:1024 nt
  v_mfma_f32_16x16x32_bf16 v[152:155], v[88:91], v[24:27], 0
  v_mfma_f32_16x16x32_bf16 v[156:159], v[88:91], v[28:31], 0
  v_mfma_f32_16x16x32_bf16 v[160:163], v[92:95], v[24:27], 0
  v_mfma_f32_16x16x32_bf16 v[164:167], v[92:95], v[28:31], 0
  v_mfma_f32_16x16x32_bf16 v[168:171], v[96:99], v[24:27], 0
  v_mfma_f32_16x16x32_bf16 v[172:175], v[96:99], v[28:31], 0
  v_mfma_f32_16x16x32_bf16 v[176:179], v[100:103], v[24:27], 0
  v_mfma_f32_16x16x32_bf16 v[180:183], v[100:103], v[28:31], 0
  v_mfma_f32_16x16x32_bf16 v[184:187], v[104:107], v[24:27], 0
  v_mfma_f32_16x16x32_bf16 v[188:191], v[104:107], v[28:31], 0
  v_mfma_f32_16x16x32_bf16 v[192:195], v[108:111], v[24:27], 0
  v_mfma_f32_16x16x32_bf16 v[196:199], v[108:111], v[28:31], 0
  v_mfma_f32_16x16x32_bf16 v[200:203], v[112:115], v[24:27], 0
  v_mfma_f32_16x16x32_bf16 v[204:207], v[112:115], v[28:31], 0
  v_mfma_f32_16x16x32_bf16 v[208:211], v[116:119], v[24:27], 0
  v_mfma_f32_16x16x32_bf16 v[212:215], v[116:119], v[28:31], 0
  s_waitcnt vmcnt(5)
  s_add_u32 s77, s44, 0x1000
  buffer_load_dwordx4 v[144:147], v1, s[24:27], s77 offen offset:2048 nt
  s_nop 3
  v_add_f32 v153, v153, v159
  v_add_f32 v152, v152, v158
  v_add_f32 v161, v161, v167
  v_add_f32 v160, v160, v166
  v_add_f32 v169, v169, v175
  v_add_f32 v168, v168, v174
  v_add_f32 v177, v177, v183
  v_add_f32 v176, v176, v182
  v_add_f32 v185, v185, v191
  v_add_f32 v184, v184, v190
  v_add_f32 v193, v193, v199
  v_add_f32 v192, v192, v198
  v_add_f32 v201, v201, v207
  v_add_f32 v200, v200, v206
  v_add_f32 v209, v209, v215
  v_add_f32 v208, v208, v214
  v_add_f32_dpp v8, v153, v152 row_ror:8 row_mask:0xf bank_mask:0xf
  v_add_f32_dpp v9, v161, v160 row_ror:8 row_mask:0xf bank_mask:0xf
  v_add_f32_dpp v10, v169, v168 row_ror:8 row_mask:0xf bank_mask:0xf
  v_add_f32_dpp v11, v177, v176 row_ror:8 row_mask:0xf bank_mask:0xf
  v_add_f32_dpp v12, v185, v184 row_ror:8 row_mask:0xf bank_mask:0xf
  v_add_f32_dpp v13, v193, v192 row_ror:8 row_mask:0xf bank_mask:0xf
  v_add_f32_dpp v14, v201, v200 row_ror:8 row_mask:0xf bank_mask:0xf
  v_add_f32_dpp v15, v209, v208 row_ror:8 row_mask:0xf bank_mask:0xf
  v_max3_f32 v7, v8, v9, v10
  v_max3_f32 v7, v7, v11, v12
  v_max3_f32 v7, v7, v13, v14
  v_max_f32 v7, v7, v15
  v_mov_b32 v20, v7
  s_nop 1
  v_permlane16_swap_b32 v7, v20
  s_nop 1
  v_max_f32 v7, v7, v20
  v_mov_b32 v20, v7
  s_nop 1
  v_permlane32_swap_b32 v7, v20
  s_nop 1
  v_max_f32 v7, v7, v20
  v_mul_f32 v7, s52, v7
  v_max_f32 v7, v7, v5
  v_sub_f32 v21, v5, v7
  v_exp_f32 v21, v21
  v_mov_b32 v5, v7
  s_waitcnt vmcnt(5)
  s_add_u32 s77, s44, 0x1000
  buffer_load_dwordx4 v[148:151], v1, s[24:27], s77 offen offset:3072 nt
  v_fma_f32 v8, v8, s52, -v5
  v_fma_f32 v9, v9, s52, -v5
  v_fma_f32 v10, v10, s52, -v5
  v_fma_f32 v11, v11, s52, -v5
  v_fma_f32 v12, v12, s52, -v5
  v_fma_f32 v13, v13, s52, -v5
  v_fma_f32 v14, v14, s52, -v5
  v_fma_f32 v15, v15, s52, -v5
  v_exp_f32 v8, v8
  v_exp_f32 v9, v9
  v_exp_f32 v10, v10
  v_exp_f32 v11, v11
  v_exp_f32 v12, v12
  v_exp_f32 v13, v13
  v_exp_f32 v14, v14
  v_exp_f32 v15, v15
  s_nop 0
  v_add_f32 v22, v8, v9
  v_add_f32 v23, v10, v11
  v_add_f32 v7, v12, v13
  v_add_f32 v20, v14, v15
  v_add_f32 v22, v22, v23
  v_add_f32 v7, v7, v20
  v_add_f32 v22, v22, v7
  v_fma_f32 v6, v6, v21, v22
  v_cvt_pk_bf16_f32 v16, v8, v9
  v_cvt_pk_bf16_f32 v17, v10, v11
  v_cvt_pk_bf16_f32 v18, v12, v13
  v_cvt_pk_bf16_f32 v19, v14, v15
  s_mov_b64 exec, s[56:57]
  ds_write_b128 v244, v[16:19] offset:8320
  ds_write_b32 v245, v21 offset:8320
  s_mov_b64 exec, -1
  s_waitcnt vmcnt(5)
  buffer_load_dwordx4 v[88:91], v3, s[28:31], s45 offen offset:0 nt
  v_mfma_f32_16x16x32_bf16 v[152:155], a[224:227], v[24:27], 0
  v_mfma_f32_16x16x32_bf16 v[156:159], a[224:227], v[28:31], 0
  v_mfma_f32_16x16x32_bf16 v[160:163], a[228:231], v[24:27], 0
  v_mfma_f32_16x16x32_bf16 v[164:167], a[228:231], v[28:31], 0
  v_mfma_f32_16x16x32_bf16 v[168:171], a[232:235], v[24:27], 0
  v_mfma_f32_16x16x32_bf16 v[172:175], a[232:235], v[28:31], 0
  v_mfma_f32_16x16x32_bf16 v[176:179], a[236:239], v[24:27], 0
  v_mfma_f32_16x16x32_bf16 v[180:183], a[236:239], v[28:31], 0
  v_mfma_f32_16x16x32_bf16 v[184:187], a[240:243], v[24:27], 0
  v_mfma_f32_16x16x32_bf16 v[188:191], a[240:243], v[28:31], 0
  v_mfma_f32_16x16x32_bf16 v[192:195], a[244:247], v[24:27], 0
  v_mfma_f32_16x16x32_bf16 v[196:199], a[244:247], v[28:31], 0
  v_mfma_f32_16x16x32_bf16 v[200:203], a[248:251], v[24:27], 0
  v_mfma_f32_16x16x32_bf16 v[204:207], a[248:251], v[28:31], 0
  v_mfma_f32_16x16x32_bf16 v[208:211], a[252:255], v[24:27], 0
  v_mfma_f32_16x16x32_bf16 v[212:215], a[252:255], v[28:31], 0
  s_waitcnt vmcnt(5)
  buffer_load_dwordx4 v[92:95], v3, s[28:31], s45 offen offset:1024 nt
  s_nop 3
  v_add_f32 v153, v153, v159
  v_add_f32 v152, v152, v158
  v_add_f32 v161, v161, v167
  v_add_f32 v160, v160, v166
  v_add_f32 v169, v169, v175
  v_add_f32 v168, v168, v174
  v_add_f32 v177, v177, v183
  v_add_f32 v176, v176, v182
  v_add_f32 v185, v185, v191
  v_add_f32 v184, v184, v190
  v_add_f32 v193, v193, v199
  v_add_f32 v192, v192, v198
  v_add_f32 v201, v201, v207
  v_add_f32 v200, v200, v206
  v_add_f32 v209, v209, v215
  v_add_f32 v208, v208, v214
  v_add_f32_dpp v8, v153, v152 row_ror:8 row_mask:0xf bank_mask:0xf
  v_add_f32_dpp v9, v161, v160 row_ror:8 row_mask:0xf bank_mask:0xf
  v_add_f32_dpp v10, v169, v168 row_ror:8 row_mask:0xf bank_mask:0xf
  v_add_f32_dpp v11, v177, v176 row_ror:8 row_mask:0xf bank_mask:0xf
  v_add_f32_dpp v12, v185, v184 row_ror:8 row_mask:0xf bank_mask:0xf
  v_add_f32_dpp v13, v193, v192 row_ror:8 row_mask:0xf bank_mask:0xf
  v_add_f32_dpp v14, v201, v200 row_ror:8 row_mask:0xf bank_mask:0xf
  v_add_f32_dpp v15, v209, v208 row_ror:8 row_mask:0xf bank_mask:0xf
  v_max3_f32 v7, v8, v9, v10
  v_max3_f32 v7, v7, v11, v12
  v_max3_f32 v7, v7, v13, v14
  v_max_f32 v7, v7, v15
  v_mov_b32 v20, v7
  s_nop 1
  v_permlane16_swap_b32 v7, v20
  s_nop 1
  v_max_f32 v7, v7, v20
  v_mov_b32 v20, v7
  s_nop 1
  v_permlane32_swap_b32 v7, v20
  s_nop 1
  v_max_f32 v7, v7, v20
  v_mul_f32 v7, s52, v7
  v_max_f32 v7, v7, v5
  v_sub_f32 v21, v5, v7
  v_exp_f32 v21, v21
  v_mov_b32 v5, v7
  s_waitcnt vmcnt(5)
  buffer_load_dwordx4 v[96:99], v3, s[28:31], s45 offen offset:2048 nt
  v_fma_f32 v8, v8, s52, -v5
  v_fma_f32 v9, v9, s52, -v5
  v_fma_f32 v10, v10, s52, -v5
  v_fma_f32 v11, v11, s52, -v5
  v_fma_f32 v12, v12, s52, -v5
  v_fma_f32 v13, v13, s52, -v5
  v_fma_f32 v14, v14, s52, -v5
  v_fma_f32 v15, v15, s52, -v5
  v_exp_f32 v8, v8
  v_exp_f32 v9, v9
  v_exp_f32 v10, v10
  v_exp_f32 v11, v11
  v_exp_f32 v12, v12
  v_exp_f32 v13, v13
  v_exp_f32 v14, v14
  v_exp_f32 v15, v15
  s_nop 0
  v_add_f32 v22, v8, v9
  v_add_f32 v23, v10, v11
  v_add_f32 v7, v12, v13
  v_add_f32 v20, v14, v15
  v_add_f32 v22, v22, v23
  v_add_f32 v7, v7, v20
  v_add_f32 v22, v22, v7
  v_fma_f32 v6, v6, v21, v22
  v_cvt_pk_bf16_f32 v16, v8, v9
  v_cvt_pk_bf16_f32 v17, v10, v11
  v_cvt_pk_bf16_f32 v18, v12, v13
  v_cvt_pk_bf16_f32 v19, v14, v15
  s_mov_b64 exec, s[56:57]
  ds_write_b128 v244, v[16:19] offset:8960
  ds_write_b32 v245, v21 offset:8960
  s_mov_b64 exec, -1
  s_waitcnt vmcnt(5)
  buffer_load_dwordx4 v[100:103], v3, s[28:31], s45 offen offset:3072 nt
  s_waitcnt vmcnt(5)
  s_add_u32 s77, s45, 0x1000
  buffer_load_dwordx4 v[104:107], v3, s[28:31], s77 offen offset:0 nt
  s_waitcnt vmcnt(5)
  s_add_u32 s77, s45, 0x1000
  buffer_load_dwordx4 v[108:111], v3, s[28:31], s77 offen offset:1024 nt
  v_mfma_f32_16x16x32_bf16 v[152:155], v[120:123], v[24:27], 0
  v_mfma_f32_16x16x32_bf16 v[156:159], v[120:123], v[28:31], 0
  v_mfma_f32_16x16x32_bf16 v[160:163], v[124:127], v[24:27], 0
  v_mfma_f32_16x16x32_bf16 v[164:167], v[124:127], v[28:31], 0
  v_mfma_f32_16x16x32_bf16 v[168:171], v[128:131], v[24:27], 0
  v_mfma_f32_16x16x32_bf16 v[172:175], v[128:131], v[28:31], 0
  v_mfma_f32_16x16x32_bf16 v[176:179], v[132:135], v[24:27], 0
  v_mfma_f32_16x16x32_bf16 v[180:183], v[132:135], v[28:31], 0
  v_mfma_f32_16x16x32_bf16 v[184:187], v[136:139], v[24:27], 0
  v_mfma_f32_16x16x32_bf16 v[188:191], v[136:139], v[28:31], 0
  v_mfma_f32_16x16x32_bf16 v[192:195], v[140:143], v[24:27], 0
  v_mfma_f32_16x16x32_bf16 v[196:199], v[140:143], v[28:31], 0
  v_mfma_f32_16x16x32_bf16 v[200:203], v[144:147], v[24:27], 0
  v_mfma_f32_16x16x32_bf16 v[204:207], v[144:147], v[28:31], 0
  v_mfma_f32_16x16x32_bf16 v[208:211], v[148:151], v[24:27], 0
  v_mfma_f32_16x16x32_bf16 v[212:215], v[148:151], v[28:31], 0
  s_waitcnt vmcnt(5)
  s_add_u32 s77, s45, 0x1000
  buffer_load_dwordx4 v[112:115], v3, s[28:31], s77 offen offset:2048 nt
  s_nop 3
  v_add_f32 v153, v153, v159
  v_add_f32 v152, v152, v158
  v_add_f32 v161, v161, v167
  v_add_f32 v160, v160, v166
  v_add_f32 v169, v169, v175
  v_add_f32 v168, v168, v174
  v_add_f32 v177, v177, v183
  v_add_f32 v176, v176, v182
  v_add_f32 v185, v185, v191
  v_add_f32 v184, v184, v190
  v_add_f32 v193, v193, v199
  v_add_f32 v192, v192, v198
  v_add_f32 v201, v201, v207
  v_add_f32 v200, v200, v206
  v_add_f32 v209, v209, v215
  v_add_f32 v208, v208, v214
  v_add_f32_dpp v8, v153, v152 row_ror:8 row_mask:0xf bank_mask:0xf
  v_add_f32_dpp v9, v161, v160 row_ror:8 row_mask:0xf bank_mask:0xf
  v_add_f32_dpp v10, v169, v168 row_ror:8 row_mask:0xf bank_mask:0xf
  v_add_f32_dpp v11, v177, v176 row_ror:8 row_mask:0xf bank_mask:0xf
  v_add_f32_dpp v12, v185, v184 row_ror:8 row_mask:0xf bank_mask:0xf
  v_add_f32_dpp v13, v193, v192 row_ror:8 row_mask:0xf bank_mask:0xf
  v_add_f32_dpp v14, v201, v200 row_ror:8 row_mask:0xf bank_mask:0xf
  v_add_f32_dpp v15, v209, v208 row_ror:8 row_mask:0xf bank_mask:0xf
  v_max3_f32 v7, v8, v9, v10
  v_max3_f32 v7, v7, v11, v12
  v_max3_f32 v7, v7, v13, v14
  v_max_f32 v7, v7, v15
  v_mov_b32 v20, v7
  s_nop 1
  v_permlane16_swap_b32 v7, v20
  s_nop 1
  v_max_f32 v7, v7, v20
  v_mov_b32 v20, v7
  s_nop 1
  v_permlane32_swap_b32 v7, v20
  s_nop 1
  v_max_f32 v7, v7, v20
  v_mul_f32 v7, s52, v7
  v_max_f32 v7, v7, v5
  v_sub_f32 v21, v5, v7
  v_exp_f32 v21, v21
  v_mov_b32 v5, v7
  s_waitcnt vmcnt(5)
  s_add_u32 s77, s45, 0x1000
  buffer_load_dwordx4 v[116:119], v3, s[28:31], s77 offen offset:3072 nt
  v_fma_f32 v8, v8, s52, -v5
  v_fma_f32 v9, v9, s52, -v5
  v_fma_f32 v10, v10, s52, -v5
  v_fma_f32 v11, v11, s52, -v5
  v_fma_f32 v12, v12, s52, -v5
  v_fma_f32 v13, v13, s52, -v5
  v_fma_f32 v14, v14, s52, -v5
  v_fma_f32 v15, v15, s52, -v5
  v_exp_f32 v8, v8
  v_exp_f32 v9, v9
  v_exp_f32 v10, v10
  v_exp_f32 v11, v11
  v_exp_f32 v12, v12
  v_exp_f32 v13, v13
  v_exp_f32 v14, v14
  v_exp_f32 v15, v15
  s_nop 0
  v_add_f32 v22, v8, v9
  v_add_f32 v23, v10, v11
  v_add_f32 v7, v12, v13
  v_add_f32 v20, v14, v15
  v_add_f32 v22, v22, v23
  v_add_f32 v7, v7, v20
  v_add_f32 v22, v22, v7
  v_fma_f32 v6, v6, v21, v22
  v_cvt_pk_bf16_f32 v16, v8, v9
  v_cvt_pk_bf16_f32 v17, v10, v11
  v_cvt_pk_bf16_f32 v18, v12, v13
  v_cvt_pk_bf16_f32 v19, v14, v15
  s_mov_b64 exec, s[56:57]
  ds_write_b128 v244, v[16:19] offset:9600
  ds_write_b32 v245, v21 offset:9600
  s_mov_b64 exec, -1
  s_or_b32 s44, s45, 0x4000
  s_mov_b32 s46, 8
  s_mov_b64 s[24:25], s[16:17]
  v_mov_b32 v246, v3
  s_mov_b32 s87, 0
  s_mov_b32 s81, 0
  s_mov_b32 s9, 0
  s_mov_b32 s83, 0
  s_mov_b32 s32, s18
  s_mov_b32 s33, s19
  s_cmp_eq_u32 s40, 1
  s_cselect_b32 s34, 0x1c00000, 0
  s_mov_b32 s8, 0x336600
  s_bfe_u32 s48, s2, 0x20004
  s_lshl_b32 s48, s48, 2
  s_or_b32 s7, s48, s40
  s_mov_b32 s12, s18
  s_mov_b32 s13, s19
  s_bfe_u32 s48, s2, 0x20003
  s_mul_i32 s48, s48, 9
  s_lshr_b32 s49, s2, 3
  s_sub_u32 s48, s48, s49
  s_sub_u32 s49, s40, 2
  s_or_b32 s48, s48, s49
  s_cselect_b32 s14, 0, 0x1c00000
  s_mov_b32 s15, 0x00020000
  s_lshl_b32 s7, s41, 7
  s_add_u32 s7, s7, 0x2200
  v_and_b32 v227, 31, v0
  v_lshlrev_b32 v227, 7, v227
  s_mov_b32 s80, 0
  s_mov_b32 s10, 0
  s_mov_b32 s11, 0
L_loop:
  s_memrealtime s[100:101]
  ds_read_b64 v[250:251], v248 offset:24
  s_waitcnt lgkmcnt(0)
  v_readfirstlane_b32 s81, v251
  v_readfirstlane_b32 s83, v250
  s_sub_u32 s82, s100, s55
  s_mul_i32 s48, s81, s46
  s_add_u32 s83, s83, s48
  s_add_u32 s83, s83, s10
  s_sub_i32 s87, s82, s83
  s_cmp_eq_u32 s81, 0
  s_cselect_b32 s87, 0, s87
  s_bitcmp1_b32 s46, 3
  s_cbranch_scc1 L_vdisp
  s_cmp_lt_i32 s87, -80
  s_cbranch_scc1 L_b8
  s_cmp_lt_i32 s87, -40
  s_cbranch_scc1 L_b5
  s_cmp_gt_i32 s87, 40
  s_cbranch_scc1 L_b9
  s_cmp_gt_i32 s87, 0
  s_cbranch_scc1 L_b7
L_b6:
  s_waitcnt vmcnt(5)
  buffer_load_dwordx4 v[120:123], v1, s[28:31], s44 offen offset:0 nt
  s_sub_u32 s48, s100, s10
  v_mov_b32 v226, s48
  s_add_u32 s48, s8, s7
  s_mov_b32 exec_hi, 0
  buffer_load_dword v253, v227, s[32:35], s8 offen sc1
  s_mov_b32 exec_lo, 1
  buffer_store_dword v226, off, s[12:15], s48 sc1
  s_mov_b64 exec, -1
  s_add_u32 s8, s8, 0x1100
  s_mov_b32 s47, 6
  s_branch L_snip
L_ret6:
  s_or_b32 s45, s44, 0x17f00
  s_add_u32 s45, s45, 0x100
  s_and_b32 s45, s45, 0x68000
  s_or_b32 s45, s45, s78
  s_waitcnt vmcnt(9)
  buffer_load_dwordx4 v[124:127], v1, s[28:31], s44 offen offset:1024 nt
  s_waitcnt vmcnt(9)
  buffer_load_dwordx4 v[128:131], v1, s[28:31], s44 offen offset:2048 nt
  s_waitcnt vmcnt(9)
  buffer_load_dwordx4 v[132:135], v1, s[28:31], s44 offen offset:3072 nt
  s_waitcnt vmcnt(9)
  s_add_u32 s77, s44, 0x1000
  buffer_load_dwordx4 v[136:139], v1, s[28:31], s77 offen offset:0 nt
  s_waitcnt vmcnt(9)
  s_add_u32 s77, s44, 0x1000
  buffer_load_dwordx4 v[140:143], v1, s[28:31], s77 offen offset:1024 nt
  v_mfma_f32_16x16x32_bf16 v[152:155], v[88:91], v[24:27], 0
  v_mfma_f32_16x16x32_bf16 v[156:159], v[88:91], v[28:31], 0
  v_mfma_f32_16x16x32_bf16 v[160:163], v[92:95], v[24:27], 0
  v_mfma_f32_16x16x32_bf16 v[164:167], v[92:95], v[28:31], 0
  v_mfma_f32_16x16x32_bf16 v[168:171], v[96:99], v[24:27], 0
  v_mfma_f32_16x16x32_bf16 v[172:175], v[96:99], v[28:31], 0
  v_mfma_f32_16x16x32_bf16 v[176:179], v[100:103], v[24:27], 0
  v_mfma_f32_16x16x32_bf16 v[180:183], v[100:103], v[28:31], 0
  v_mfma_f32_16x16x32_bf16 v[184:187], v[104:107], v[24:27], 0
  v_mfma_f32_16x16x32_bf16 v[188:191], v[104:107], v[28:31], 0
  v_mfma_f32_16x16x32_bf16 v[192:195], v[108:111], v[24:27], 0
  v_mfma_f32_16x16x32_bf16 v[196:199], v[108:111], v[28:31], 0
  v_mfma_f32_16x16x32_bf16 v[200:203], v[112:115], v[24:27], 0
  v_mfma_f32_16x16x32_bf16 v[204:207], v[112:115], v[28:31], 0
  v_mfma_f32_16x16x32_bf16 v[208:211], v[116:119], v[24:27], 0
  v_mfma_f32_16x16x32_bf16 v[212:215], v[116:119], v[28:31], 0
  s_waitcnt vmcnt(9)
  s_add_u32 s77, s44, 0x1000
  buffer_load_dwordx4 v[144:147], v1, s[28:31], s77 offen offset:2048 nt
  s_nop 3
  v_add_f32 v153, v153, v159
  v_add_f32 v152, v152, v158
  v_add_f32 v161, v161, v167
  v_add_f32 v160, v160, v166
  v_add_f32 v169, v169, v175
  v_add_f32 v168, v168, v174
  v_add_f32 v177, v177, v183
  v_add_f32 v176, v176, v182
  v_add_f32 v185, v185, v191
  v_add_f32 v184, v184, v190
  v_add_f32 v193, v193, v199
  v_add_f32 v192, v192, v198
  v_add_f32 v201, v201, v207
  v_add_f32 v200, v200, v206
  v_add_f32 v209, v209, v215
  v_add_f32 v208, v208, v214
  v_add_f32_dpp v8, v153, v152 row_ror:8 row_mask:0xf bank_mask:0xf
  v_add_f32_dpp v9, v161, v160 row_ror:8 row_mask:0xf bank_mask:0xf
  v_add_f32_dpp v10, v169, v168 row_ror:8 row_mask:0xf bank_mask:0xf
  v_add_f32_dpp v11, v177, v176 row_ror:8 row_mask:0xf bank_mask:0xf
  v_add_f32_dpp v12, v185, v184 row_ror:8 row_mask:0xf bank_mask:0xf
  v_add_f32_dpp v13, v193, v192 row_ror:8 row_mask:0xf bank_mask:0xf
  v_add_f32_dpp v14, v201, v200 row_ror:8 row_mask:0xf bank_mask:0xf
  v_add_f32_dpp v15, v209, v208 row_ror:8 row_mask:0xf bank_mask:0xf
  v_max3_f32 v7, v8, v9, v10
  v_max3_f32 v7, v7, v11, v12
  v_max3_f32 v7, v7, v13, v14
  v_max_f32 v7, v7, v15
  v_mov_b32 v20, v7
  s_nop 1
  v_permlane16_swap_b32 v7, v20
  s_nop 1
  v_max_f32 v7, v7, v20
  v_mov_b32 v20, v7
  s_nop 1
  v_permlane32_swap_b32 v7, v20
  s_nop 1
  v_max_f32 v7, v7, v20
  v_mul_f32 v7, s52, v7
  v_max_f32 v7, v7, v5
  v_sub_f32 v21, v5, v7
  v_exp_f32 v21, v21
  v_mov_b32 v5, v7
  s_waitcnt vmcnt(5)
  s_add_u32 s77, s44, 0x1000
  buffer_load_dwordx4 v[148:151], v1, s[28:31], s77 offen offset:3072 nt
  v_fma_f32 v8, v8, s52, -v5
  v_fma_f32 v9, v9, s52, -v5
  v_fma_f32 v10, v10, s52, -v5
  v_fma_f32 v11, v11, s52, -v5
  v_fma_f32 v12, v12, s52, -v5
  v_fma_f32 v13, v13, s52, -v5
  v_fma_f32 v14, v14, s52, -v5
  v_fma_f32 v15, v15, s52, -v5
  v_exp_f32 v8, v8
  v_exp_f32 v9, v9
  v_exp_f32 v10, v10
  v_exp_f32 v11, v11
  v_exp_f32 v12, v12
  v_exp_f32 v13, v13
  v_exp_f32 v14, v14
  v_exp_f32 v15, v15
  s_nop 0
  v_add_f32 v22, v8, v9
  v_add_f32 v23, v10, v11
  v_add_f32 v7, v12, v13
  v_add_f32 v20, v14, v15
  v_add_f32 v22, v22, v23
  v_add_f32 v7, v7, v20
  v_add_f32 v22, v22, v7
  v_fma_f32 v6, v6, v21, v22
  v_cvt_pk_bf16_f32 v16, v8, v9
  v_cvt_pk_bf16_f32 v17, v10, v11
  v_cvt_pk_bf16_f32 v18, v12, v13
  v_cvt_pk_bf16_f32 v19, v14, v15
  s_mov_b64 exec, s[56:57]
  ds_write_b128 v244, v[16:19] offset:0
  ds_write_b32 v245, v21 offset:0
  s_mov_b64 exec, -1
  s_waitcnt vmcnt(5)
  buffer_load_dwordx4 v[88:91], v246, s[24:27], s45 offen offset:0 nt
  s_waitcnt vmcnt(5)
  buffer_load_dwordx4 v[92:95], v246, s[24:27], s45 offen offset:1024 nt
  s_cmp_lg_u32 s40, 1
  s_cbranch_scc1 L_hk6
  v_subrev_u32 v253, s55, v253
  v_cmp_ge_u32 vcc, s82, v253
  v_min_u32 v253, s82, v253
  s_bcnt1_i32_b32 s49, vcc_lo
  v_mov_b32 v250, v253
  s_nop 1
  v_add_u32_dpp v253, v253, v253 row_shr:1 row_mask:0xf bank_mask:0xf bound_ctrl:0
  v_max_u32_dpp v250, v250, v250 row_shr:1 row_mask:0xf bank_mask:0xf bound_ctrl:0
  s_nop 0
  v_add_u32_dpp v253, v253, v253 row_shr:2 row_mask:0xf bank_mask:0xf bound_ctrl:0
  v_max_u32_dpp v250, v250, v250 row_shr:2 row_mask:0xf bank_mask:0xf bound_ctrl:0
  s_nop 0
  v_add_u32_dpp v253, v253, v253 row_shr:4 row_mask:0xf bank_mask:0xf bound_ctrl:0
  v_max_u32_dpp v250, v250, v250 row_shr:4 row_mask:0xf bank_mask:0xf bound_ctrl:0
  s_nop 0
  v_add_u32_dpp v253, v253, v253 row_shr:8 row_mask:0xf bank_mask:0xf bound_ctrl:0
  v_max_u32_dpp v250, v250, v250 row_shr:8 row_mask:0xf bank_mask:0xf bound_ctrl:0
  s_cmp_ge_u32 s49, 8
  s_cselect_b32 s9, s9, 0
  s_cbranch_scc0 L_hk6
  v_readlane_b32 s48, v253, 15
  v_readlane_b32 s49, v253, 31
  s_add_u32 s48, s48, s49
  s_lshr_b32 s48, s48, 5
  v_readlane_b32 s87, v250, 15
  v_readlane_b32 s49, v250, 31
  s_max_u32 s87, s87, s49
  s_sub_u32 s87, s87, s48
  s_sub_i32 s87, s87, 110
  s_max_i32 s87, s87, 0
  s_lshr_b32 s87, s87, 0
  s_min_u32 s87, s87, 60
  s_cmp_ge_u32 s46, 14
  s_cselect_b32 s87, s87, 0
  s_sub_u32 s49, s48, s9
  s_min_u32 s49, s49, 280
  s_max_u32 s49, s49, 200
  s_sub_i32 s49, s49, s81
  s_ashr_i32 s49, s49, 2
  s_cmp_eq_u32 s9, 0
  s_cselect_b32 s49, 0, s49
  s_add_u32 s49, s49, s81
  s_cmp_eq_u32 s81, 0
  s_cselect_b32 s49, 226, s49
  s_mov_b32 s9, s48
  v_mov_b32 v251, s49
  s_sub_u32 s80, s46, 2
  s_mul_i32 s49, s49, s80
  s_sub_u32 s48, s48, s49
  s_add_u32 s48, s48, s87
  v_mov_b32 v250, s48
  s_mov_b64 exec, 1
  ds_write_b64 v248, v[250:251] offset:24
  s_mov_b64 exec, -1
L_hk6:
  s_waitcnt vmcnt(5)
  buffer_load_dwordx4 v[96:99], v246, s[24:27], s45 offen offset:2048 nt
  s_waitcnt vmcnt(5)
  buffer_load_dwordx4 v[100:103], v246, s[24:27], s45 offen offset:3072 nt
  s_waitcnt vmcnt(5)
  s_add_u32 s77, s45, 0x1000
  buffer_load_dwordx4 v[104:107], v246, s[24:27], s77 offen offset:0 nt
  s_waitcnt vmcnt(5)
  s_add_u32 s77, s45, 0x1000
  buffer_load_dwordx4 v[108:111], v246, s[24:27], s77 offen offset:1024 nt
  v_mfma_f32_16x16x32_bf16 v[152:155], v[120:123], v[24:27], 0
  v_mfma_f32_16x16x32_bf16 v[156:159], v[120:123], v[28:31], 0
  v_mfma_f32_16x16x32_bf16 v[160:163], v[124:127], v[24:27], 0
  v_mfma_f32_16x16x32_bf16 v[164:167], v[124:127], v[28:31], 0
  v_mfma_f32_16x16x32_bf16 v[168:171], v[128:131], v[24:27], 0
  v_mfma_f32_16x16x32_bf16 v[172:175], v[128:131], v[28:31], 0
  v_mfma_f32_16x16x32_bf16 v[176:179], v[132:135], v[24:27], 0
  v_mfma_f32_16x16x32_bf16 v[180:183], v[132:135], v[28:31], 0
  v_mfma_f32_16x16x32_bf16 v[184:187], v[136:139], v[24:27], 0
  v_mfma_f32_16x16x32_bf16 v[188:191], v[136:139], v[28:31], 0
  v_mfma_f32_16x16x32_bf16 v[192:195], v[140:143], v[24:27], 0
  v_mfma_f32_16x16x32_bf16 v[196:199], v[140:143], v[28:31], 0
  v_mfma_f32_16x16x32_bf16 v[200:203], v[144:147], v[24:27], 0
  v_mfma_f32_16x16x32_bf16 v[204:207], v[144:147], v[28:31], 0
  v_mfma_f32_16x16x32_bf16 v[208:211], v[148:151], v[24:27], 0
  v_mfma_f32_16x16x32_bf16 v[212:215], v[148:151], v[28:31], 0
  s_waitcnt vmcnt(5)
  s_add_u32 s77, s45, 0x1000
  buffer_load_dwordx4 v[112:115], v246, s[24:27], s77 offen offset:2048 nt
  s_nop 3
  v_add_f32 v153, v153, v159
  v_add_f32 v152, v152, v158
  v_add_f32 v161, v161, v167
  v_add_f32 v160, v160, v166
  v_add_f32 v169, v169, v175
  v_add_f32 v168, v168, v174
  v_add_f32 v177, v177, v183
  v_add_f32 v176, v176, v182
  v_add_f32 v185, v185, v191
  v_add_f32 v184, v184, v190
  v_add_f32 v193, v193, v199
  v_add_f32 v192, v192, v198
  v_add_f32 v201, v201, v207
  v_add_f32 v200, v200, v206
  v_add_f32 v209, v209, v215
  v_add_f32 v208, v208, v214
  v_add_f32_dpp v8, v153, v152 row_ror:8 row_mask:0xf bank_mask:0xf
  v_add_f32_dpp v9, v161, v160 row_ror:8 row_mask:0xf bank_mask:0xf
  v_add_f32_dpp v10, v169, v168 row_ror:8 row_mask:0xf bank_mask:0xf
  v_add_f32_dpp v11, v177, v176 row_ror:8 row_mask:0xf bank_mask:0xf
  v_add_f32_dpp v12, v185, v184 row_ror:8 row_mask:0xf bank_mask:0xf
  v_add_f32_dpp v13, v193, v192 row_ror:8 row_mask:0xf bank_mask:0xf
  v_add_f32_dpp v14, v201, v200 row_ror:8 row_mask:0xf bank_mask:0xf
  v_add_f32_dpp v15, v209, v208 row_ror:8 row_mask:0xf bank_mask:0xf
  v_max3_f32 v7, v8, v9, v10
  v_max3_f32 v7, v7, v11, v12
  v_max3_f32 v7, v7, v13, v14
  v_max_f32 v7, v7, v15
  v_mov_b32 v20, v7
  s_nop 1
  v_permlane16_swap_b32 v7, v20
  s_nop 1
  v_max_f32 v7, v7, v20
  v_mov_b32 v20, v7
  s_nop 1
  v_permlane32_swap_b32 v7, v20
  s_nop 1
  v_max_f32 v7, v7, v20
  v_mul_f32 v7, s52, v7
  v_max_f32 v7, v7, v5
  v_sub_f32 v21, v5, v7
  v_exp_f32 v21, v21
  v_mov_b32 v5, v7
  s_waitcnt vmcnt(5)
  s_add_u32 s77, s45, 0x1000
  buffer_load_dwordx4 v[116:119], v246, s[24:27], s77 offen offset:3072 nt
  v_fma_f32 v8, v8, s52, -v5
  v_fma_f32 v9, v9, s52, -v5
  v_fma_f32 v10, v10, s52, -v5
  v_fma_f32 v11, v11, s52, -v5
  v_fma_f32 v12, v12, s52, -v5
  v_fma_f32 v13, v13, s52, -v5
  v_fma_f32 v14, v14, s52, -v5
  v_fma_f32 v15, v15, s52, -v5
  v_exp_f32 v8, v8
  v_exp_f32 v9, v9
  v_exp_f32 v10, v10
  v_exp_f32 v11, v11
  v_exp_f32 v12, v12
  v_exp_f32 v13, v13
  v_exp_f32 v14, v14
  v_exp_f32 v15, v15
  s_nop 0
  v_add_f32 v22, v8, v9
  v_add_f32 v23, v10, v11
  v_add_f32 v7, v12, v13
  v_add_f32 v20, v14, v15
  v_add_f32 v22, v22, v23
  v_add_f32 v7, v7, v20
  v_add_f32 v22, v22, v7
  v_fma_f32 v6, v6, v21, v22
  v_cvt_pk_bf16_f32 v16, v8, v9
  v_cvt_pk_bf16_f32 v17, v10, v11
  v_cvt_pk_bf16_f32 v18, v12, v13
  v_cvt_pk_bf16_f32 v19, v14, v15
  s_mov_b64 exec, s[56:57]
  ds_write_b128 v244, v[16:19] offset:640
  ds_write_b32 v245, v21 offset:640
  s_mov_b64 exec, -1
  s_or_b32 s44, s45, 0x4000
  s_mov_b64 s[28:29], s[24:25]
  s_and_b32 s48, s46, 7
  s_cmp_eq_u32 s48, 7
  s_cselect_b32 s48, -7, 1
  s_mulk_i32 s48, 1280
  v_add_u32 v244, s48, v244
  v_add_u32 v245, s48, v245
  s_add_u32 s10, s10, s11
  s_mov_b32 s11, 0
  s_add_u32 s46, s46, 1
  s_branch L_loop
L_b5:
  s_waitcnt vmcnt(4)
  buffer_load_dwordx4 v[120:123], v1, s[28:31], s44 offen offset:0 nt
  s_sub_u32 s48, s100, s10
  v_mov_b32 v226, s48
  s_add_u32 s48, s8, s7
  s_mov_b32 exec_hi, 0
  buffer_load_dword v253, v227, s[32:35], s8 offen sc1
  s_mov_b32 exec_lo, 1
  buffer_store_dword v226, off, s[12:15], s48 sc1
  s_mov_b64 exec, -1
  s_add_u32 s8, s8, 0x1100
  s_mov_b32 s47, 5
  s_branch L_snip
L_ret5:
  s_or_b32 s45, s44, 0x17f00
  s_add_u32 s45, s45, 0x100
  s_and_b32 s45, s45, 0x68000
  s_or_b32 s45, s45, s78
  s_waitcnt vmcnt(8)
  buffer_load_dwordx4 v[124:127], v1, s[28:31], s44 offen offset:1024 nt
  s_waitcnt vmcnt(8)
  buffer_load_dwordx4 v[128:131], v1, s[28:31], s44 offen offset:2048 nt
  s_waitcnt vmcnt(8)
  buffer_load_dwordx4 v[132:135], v1, s[28:31], s44 offen offset:3072 nt
  s_waitcnt vmcnt(8)
  s_add_u32 s77, s44, 0x1000
  buffer_load_dwordx4 v[136:139], v1, s[28:31], s77 offen offset:0 nt
  v_mfma_f32_16x16x32_bf16 v[152:155], v[88:91], v[24:27], 0
  v_mfma_f32_16x16x32_bf16 v[156:159], v[88:91], v[28:31], 0
  v_mfma_f32_16x16x32_bf16 v[160:163], v[92:95], v[24:27], 0
  v_mfma_f32_16x16x32_bf16 v[164:167], v[92:95], v[28:31], 0
  v_mfma_f32_16x16x32_bf16 v[168:171], v[96:99], v[24:27], 0
  v_mfma_f32_16x16x32_bf16 v[172:175], v[96:99], v[28:31], 0
  v_mfma_f32_16x16x32_bf16 v[176:179], v[100:103], v[24:27], 0
  v_mfma_f32_16x16x32_bf16 v[180:183], v[100:103], v[28:31], 0
  v_mfma_f32_16x16x32_bf16 v[184:187], v[104:107], v[24:27], 0
  v_mfma_f32_16x16x32_bf16 v[188:191], v[104:107], v[28:31], 0
  v_mfma_f32_16x16x32_bf16 v[192:195], v[108:111], v[24:27], 0
  v_mfma_f32_16x16x32_bf16 v[196:199], v[108:111], v[28:31], 0
  v_mfma_f32_16x16x32_bf16 v[200:203], v[112:115], v[24:27], 0
  v_mfma_f32_16x16x32_bf16 v[204:207], v[112:115], v[28:31], 0
  v_mfma_f32_16x16x32_bf16 v[208:211], v[116:119], v[24:27], 0
  v_mfma_f32_16x16x32_bf16 v[212:215], v[116:119], v[28:31], 0
  s_waitcnt vmcnt(8)
  s_add_u32 s77, s44, 0x1000
  buffer_load_dwordx4 v[140:143], v1, s[28:31], s77 offen offset:1024 nt
  s_nop 3
  v_add_f32 v153, v153, v159
  v_add_f32 v152, v152, v158
  v_add_f32 v161, v161, v167
  v_add_f32 v160, v160, v166
  v_add_f32 v169, v169, v175
  v_add_f32 v168, v168, v174
  v_add_f32 v177, v177, v183
  v_add_f32 v176, v176, v182
  v_add_f32 v185, v185, v191
  v_add_f32 v184, v184, v190
  v_add_f32 v193, v193, v199
  v_add_f32 v192, v192, v198
  v_add_f32 v201, v201, v207
  v_add_f32 v200, v200, v206
  v_add_f32 v209, v209, v215
  v_add_f32 v208, v208, v214
  v_add_f32_dpp v8, v153, v152 row_ror:8 row_mask:0xf bank_mask:0xf
  v_add_f32_dpp v9, v161, v160 row_ror:8 row_mask:0xf bank_mask:0xf
  v_add_f32_dpp v10, v169, v168 row_ror:8 row_mask:0xf bank_mask:0xf
  v_add_f32_dpp v11, v177, v176 row_ror:8 row_mask:0xf bank_mask:0xf
  v_add_f32_dpp v12, v185, v184 row_ror:8 row_mask:0xf bank_mask:0xf
  v_add_f32_dpp v13, v193, v192 row_ror:8 row_mask:0xf bank_mask:0xf
  v_add_f32_dpp v14, v201, v200 row_ror:8 row_mask:0xf bank_mask:0xf
  v_add_f32_dpp v15, v209, v208 row_ror:8 row_mask:0xf bank_mask:0xf
  v_max3_f32 v7, v8, v9, v10
  v_max3_f32 v7, v7, v11, v12
  v_max3_f32 v7, v7, v13, v14
  v_max_f32 v7, v7, v15
  v_mov_b32 v20, v7
  s_nop 1
  v_permlane16_swap_b32 v7, v20
  s_nop 1
  v_max_f32 v7, v7, v20
  v_mov_b32 v20, v7
  s_nop 1
  v_permlane32_swap_b32 v7, v20
  s_nop 1
  v_max_f32 v7, v7, v20
  v_mul_f32 v7, s52, v7
  v_max_f32 v7, v7, v5
  v_sub_f32 v21, v5, v7
  v_exp_f32 v21, v21
  v_mov_b32 v5, v7
  s_waitcnt vmcnt(4)
  s_add_u32 s77, s44, 0x1000
  buffer_load_dwordx4 v[144:147], v1, s[28:31], s77 offen offset:2048 nt
  v_fma_f32 v8, v8, s52, -v5
  v_fma_f32 v9, v9, s52, -v5
  v_fma_f32 v10, v10, s52, -v5
  v_fma_f32 v11, v11, s52, -v5
  v_fma_f32 v12, v12, s52, -v5
  v_fma_f32 v13, v13, s52, -v5
  v_fma_f32 v14, v14, s52, -v5
  v_fma_f32 v15, v15, s52, -v5
  v_exp_f32 v8, v8
  v_exp_f32 v9, v9
  v_exp_f32 v10, v10
  v_exp_f32 v11, v11
  v_exp_f32 v12, v12
  v_exp_f32 v13, v13
  v_exp_f32 v14, v14
  v_exp_f32 v15, v15
  s_nop 0
  v_add_f32 v22, v8, v9
  v_add_f32 v23, v10, v11
  v_add_f32 v7, v12, v13
  v_add_f32 v20, v14, v15
  v_add_f32 v22, v22, v23
  v_add_f32 v7, v7, v20
  v_add_f32 v22, v22, v7
  v_fma_f32 v6, v6, v21, v22
  v_cvt_pk_bf16_f32 v16, v8, v9
  v_cvt_pk_bf16_f32 v17, v10, v11
  v_cvt_pk_bf16_f32 v18, v12, v13
  v_cvt_pk_bf16_f32 v19, v14, v15
  s_mov_b64 exec, s[56:57]
  ds_write_b128 v244, v[16:19] offset:0
  ds_write_b32 v245, v21 offset:0
  s_mov_b64 exec, -1
  s_waitcnt vmcnt(4)
  s_add_u32 s77, s44, 0x1000
  buffer_load_dwordx4 v[148:151], v1, s[28:31], s77 offen offset:3072 nt
  s_waitcnt vmcnt(4)
  buffer_load_dwordx4 v[88:91], v246, s[24:27], s45 offen offset:0 nt
  s_waitcnt vmcnt(4)
  buffer_load_dwordx4 v[92:95], v246, s[24:27], s45 offen offset:1024 nt
  s_cmp_lg_u32 s40, 1
  s_cbranch_scc1 L_hk5
  v_subrev_u32 v253, s55, v253
  v_cmp_ge_u32 vcc, s82, v253
  v_min_u32 v253, s82, v253
  s_bcnt1_i32_b32 s49, vcc_lo
  v_mov_b32 v250, v253
  s_nop 1
  v_add_u32_dpp v253, v253, v253 row_shr:1 row_mask:0xf bank_mask:0xf bound_ctrl:0
  v_max_u32_dpp v250, v250, v250 row_shr:1 row_mask:0xf bank_mask:0xf bound_ctrl:0
  s_nop 0
  v_add_u32_dpp v253, v253, v253 row_shr:2 row_mask:0xf bank_mask:0xf bound_ctrl:0
  v_max_u32_dpp v250, v250, v250 row_shr:2 row_mask:0xf bank_mask:0xf bound_ctrl:0
  s_nop 0
  v_add_u32_dpp v253, v253, v253 row_shr:4 row_mask:0xf bank_mask:0xf bound_ctrl:0
  v_max_u32_dpp v250, v250, v250 row_shr:4 row_mask:0xf bank_mask:0xf bound_ctrl:0
  s_nop 0
  v_add_u32_dpp v253, v253, v253 row_shr:8 row_mask:0xf bank_mask:0xf bound_ctrl:0
  v_max_u32_dpp v250, v250, v250 row_shr:8 row_mask:0xf bank_mask:0xf bound_ctrl:0
  s_cmp_ge_u32 s49, 8
  s_cselect_b32 s9, s9, 0
  s_cbranch_scc0 L_hk5
  v_readlane_b32 s48, v253, 15
  v_readlane_b32 s49, v253, 31
  s_add_u32 s48, s48, s49
  s_lshr_b32 s48, s48, 5
  v_readlane_b32 s87, v250, 15
  v_readlane_b32 s49, v250, 31
  s_max_u32 s87, s87, s49
  s_sub_u32 s87, s87, s48
  s_sub_i32 s87, s87, 110
  s_max_i32 s87, s87, 0
  s_lshr_b32 s87, s87, 0
  s_min_u32 s87, s87, 60
  s_cmp_ge_u32 s46, 14
  s_cselect_b32 s87, s87, 0
  s_sub_u32 s49, s48, s9
  s_min_u32 s49, s49, 280
  s_max_u32 s49, s49, 200
  s_sub_i32 s49, s49, s81
  s_ashr_i32 s49, s49, 2
  s_cmp_eq_u32 s9, 0
  s_cselect_b32 s49, 0, s49
  s_add_u32 s49, s49, s81
  s_cmp_eq_u32 s81, 0
  s_cselect_b32 s49, 226, s49
  s_mov_b32 s9, s48
  v_mov_b32 v251, s49
  s_sub_u32 s80, s46, 2
  s_mul_i32 s49, s49, s80
  s_sub_u32 s48, s48, s49
  s_add_u32 s48, s48, s87
  v_mov_b32 v250, s48
  s_mov_b64 exec, 1
  ds_write_b64 v248, v[250:251] offset:24
  s_mov_b64 exec, -1
L_hk5:
  s_waitcnt vmcnt(4)
  buffer_load_dwordx4 v[96:99], v246, s[24:27], s45 offen offset:2048 nt
  s_waitcnt vmcnt(4)
  buffer_load_dwordx4 v[100:103], v246, s[24:27], s45 offen offset:3072 nt
  s_waitcnt vmcnt(4)
  s_add_u32 s77, s45, 0x1000
  buffer_load_dwordx4 v[104:107], v246, s[24:27], s77 offen offset:0 nt
  v_mfma_f32_16x16x32_bf16 v[152:155], v[120:123], v[24:27], 0
  v_mfma_f32_16x16x32_bf16 v[156:159], v[120:123], v[28:31], 0
  v_mfma_f32_16x16x32_bf16 v[160:163], v[124:127], v[24:27], 0
  v_mfma_f32_16x16x32_bf16 v[164:167], v[124:127], v[28:31], 0
  v_mfma_f32_16x16x32_bf16 v[168:171], v[128:131], v[24:27], 0
  v_mfma_f32_16x16x32_bf16 v[172:175], v[128:131], v[28:31], 0
  v_mfma_f32_16x16x32_bf16 v[176:179], v[132:135], v[24:27], 0
  v_mfma_f32_16x16x32_bf16 v[180:183], v[132:135], v[28:31], 0
  v_mfma_f32_16x16x32_bf16 v[184:187], v[136:139], v[24:27], 0
  v_mfma_f32_16x16x32_bf16 v[188:191], v[136:139], v[28:31], 0
  v_mfma_f32_16x16x32_bf16 v[192:195], v[140:143], v[24:27], 0
  v_mfma_f32_16x16x32_bf16 v[196:199], v[140:143], v[28:31], 0
  v_mfma_f32_16x16x32_bf16 v[200:203], v[144:147], v[24:27], 0
  v_mfma_f32_16x16x32_bf16 v[204:207], v[144:147], v[28:31], 0
  v_mfma_f32_16x16x32_bf16 v[208:211], v[148:151], v[24:27], 0
  v_mfma_f32_16x16x32_bf16 v[212:215], v[148:151], v[28:31], 0
  s_waitcnt vmcnt(4)
  s_add_u32 s77, s45, 0x1000
  buffer_load_dwordx4 v[108:111], v246, s[24:27], s77 offen offset:1024 nt
  s_nop 3
  v_add_f32 v153, v153, v159
  v_add_f32 v152, v152, v158
  v_add_f32 v161, v161, v167
  v_add_f32 v160, v160, v166
  v_add_f32 v169, v169, v175
  v_add_f32 v168, v168, v174
  v_add_f32 v177, v177, v183
  v_add_f32 v176, v176, v182
  v_add_f32 v185, v185, v191
  v_add_f32 v184, v184, v190
  v_add_f32 v193, v193, v199
  v_add_f32 v192, v192, v198
  v_add_f32 v201, v201, v207
  v_add_f32 v200, v200, v206
  v_add_f32 v209, v209, v215
  v_add_f32 v208, v208, v214
  v_add_f32_dpp v8, v153, v152 row_ror:8 row_mask:0xf bank_mask:0xf
  v_add_f32_dpp v9, v161, v160 row_ror:8 row_mask:0xf bank_mask:0xf
  v_add_f32_dpp v10, v169, v168 row_ror:8 row_mask:0xf bank_mask:0xf
  v_add_f32_dpp v11, v177, v176 row_ror:8 row_mask:0xf bank_mask:0xf
  v_add_f32_dpp v12, v185, v184 row_ror:8 row_mask:0xf bank_mask:0xf
  v_add_f32_dpp v13, v193, v192 row_ror:8 row_mask:0xf bank_mask:0xf
  v_add_f32_dpp v14, v201, v200 row_ror:8 row_mask:0xf bank_mask:0xf
  v_add_f32_dpp v15, v209, v208 row_ror:8 row_mask:0xf bank_mask:0xf
  v_max3_f32 v7, v8, v9, v10
  v_max3_f32 v7, v7, v11, v12
  v_max3_f32 v7, v7, v13, v14
  v_max_f32 v7, v7, v15
  v_mov_b32 v20, v7
  s_nop 1
  v_permlane16_swap_b32 v7, v20
  s_nop 1
  v_max_f32 v7, v7, v20
  v_mov_b32 v20, v7
  s_nop 1
  v_permlane32_swap_b32 v7, v20
  s_nop 1
  v_max_f32 v7, v7, v20
  v_mul_f32 v7, s52, v7
  v_max_f32 v7, v7, v5
  v_sub_f32 v21, v5, v7
  v_exp_f32 v21, v21
  v_mov_b32 v5, v7
  s_waitcnt vmcnt(4)
  s_add_u32 s77, s45, 0x1000
  buffer_load_dwordx4 v[112:115], v246, s[24:27], s77 offen offset:2048 nt
  v_fma_f32 v8, v8, s52, -v5
  v_fma_f32 v9, v9, s52, -v5
  v_fma_f32 v10, v10, s52, -v5
  v_fma_f32 v11, v11, s52, -v5
  v_fma_f32 v12, v12, s52, -v5
  v_fma_f32 v13, v13, s52, -v5
  v_fma_f32 v14, v14, s52, -v5
  v_fma_f32 v15, v15, s52, -v5
  v_exp_f32 v8, v8
  v_exp_f32 v9, v9
  v_exp_f32 v10, v10
  v_exp_f32 v11, v11
  v_exp_f32 v12, v12
  v_exp_f32 v13, v13
  v_exp_f32 v14, v14
  v_exp_f32 v15, v15
  s_nop 0
  v_add_f32 v22, v8, v9
  v_add_f32 v23, v10, v11
  v_add_f32 v7, v12, v13
  v_add_f32 v20, v14, v15
  v_add_f32 v22, v22, v23
  v_add_f32 v7, v7, v20
  v_add_f32 v22, v22, v7
  v_fma_f32 v6, v6, v21, v22
  v_cvt_pk_bf16_f32 v16, v8, v9
  v_cvt_pk_bf16_f32 v17, v10, v11
  v_cvt_pk_bf16_f32 v18, v12, v13
  v_cvt_pk_bf16_f32 v19, v14, v15
  s_mov_b64 exec, s[56:57]
  ds_write_b128 v244, v[16:19] offset:640
  ds_write_b32 v245, v21 offset:640
  s_mov_b64 exec, -1
  s_waitcnt vmcnt(4)
  s_add_u32 s77, s45, 0x1000
  buffer_load_dwordx4 v[116:119], v246, s[24:27], s77 offen offset:3072 nt
  s_or_b32 s44, s45, 0x4000
  s_mov_b64 s[28:29], s[24:25]
  s_and_b32 s48, s46, 7
  s_cmp_eq_u32 s48, 7
  s_cselect_b32 s48, -7, 1
  s_mulk_i32 s48, 1280
  v_add_u32 v244, s48, v244
  v_add_u32 v245, s48, v245
  s_add_u32 s10, s10, s11
  s_mov_b32 s11, 0
  s_add_u32 s46, s46, 1
  s_branch L_loop
L_b8:
  s_waitcnt vmcnt(3)
  buffer_load_dwordx4 v[120:123], v1, s[28:31], s44 offen offset:0 nt
  s_sub_u32 s48, s100, s10
  v_mov_b32 v226, s48
  s_add_u32 s48, s8, s7
  s_mov_b32 exec_hi, 0
  buffer_load_dword v253, v227, s[32:35], s8 offen sc1
  s_mov_b32 exec_lo, 1
  buffer_store_dword v226, off, s[12:15], s48 sc1
  s_mov_b64 exec, -1
  s_add_u32 s8, s8, 0x1100
  s_mov_b32 s47, 8
  s_branch L_snip
L_ret8:
  s_or_b32 s45, s44, 0x17f00
  s_add_u32 s45, s45, 0x100
  s_and_b32 s45, s45, 0x68000
  s_or_b32 s45, s45, s78
  s_waitcnt vmcnt(7)
  buffer_load_dwordx4 v[124:127], v1, s[28:31], s44 offen offset:1024 nt
  s_waitcnt vmcnt(7)
  buffer_load_dwordx4 v[128:131], v1, s[28:31], s44 offen offset:2048 nt
  s_waitcnt vmcnt(7)
  buffer_load_dwordx4 v[132:135], v1, s[28:31], s44 offen offset:3072 nt
  v_mfma_f32_16x16x32_bf16 v[152:155], v[88:91], v[24:27], 0
  v_mfma_f32_16x16x32_bf16 v[156:159], v[88:91], v[28:31], 0
  v_mfma_f32_16x16x32_bf16 v[160:163], v[92:95], v[24:27], 0
  v_mfma_f32_16x16x32_bf16 v[164:167], v[92:95], v[28:31], 0
  v_mfma_f32_16x16x32_bf16 v[168:171], v[96:99], v[24:27], 0
  v_mfma_f32_16x16x32_bf16 v[172:175], v[96:99], v[28:31], 0
  v_mfma_f32_16x16x32_bf16 v[176:179], v[100:103], v[24:27], 0
  v_mfma_f32_16x16x32_bf16 v[180:183], v[100:103], v[28:31], 0
  v_mfma_f32_16x16x32_bf16 v[184:187], v[104:107], v[24:27], 0
  v_mfma_f32_16x16x32_bf16 v[188:191], v[104:107], v[28:31], 0
  v_mfma_f32_16x16x32_bf16 v[192:195], v[108:111], v[24:27], 0
  v_mfma_f32_16x16x32_bf16 v[196:199], v[108:111], v[28:31], 0
  v_mfma_f32_16x16x32_bf16 v[200:203], v[112:115], v[24:27], 0
  v_mfma_f32_16x16x32_bf16 v[204:207], v[112:115], v[28:31], 0
  v_mfma_f32_16x16x32_bf16 v[208:211], v[116:119], v[24:27], 0
  v_mfma_f32_16x16x32_bf16 v[212:215], v[116:119], v[28:31], 0
  s_waitcnt vmcnt(7)
  s_add_u32 s77, s44, 0x1000
  buffer_load_dwordx4 v[136:139], v1, s[28:31], s77 offen offset:0 nt
  s_nop 3
  v_add_f32 v153, v153, v159
  v_add_f32 v152, v152, v158
  v_add_f32 v161, v161, v167
  v_add_f32 v160, v160, v166
  v_add_f32 v169, v169, v175
  v_add_f32 v168, v168, v174
  v_add_f32 v177, v177, v183
  v_add_f32 v176, v176, v182
  v_add_f32 v185, v185, v191
  v_add_f32 v184, v184, v190
  v_add_f32 v193, v193, v199
  v_add_f32 v192, v192, v198
  v_add_f32 v201, v201, v207
  v_add_f32 v200, v200, v206
  v_add_f32 v209, v209, v215
  v_add_f32 v208, v208, v214
  v_add_f32_dpp v8, v153, v152 row_ror:8 row_mask:0xf bank_mask:0xf
  v_add_f32_dpp v9, v161, v160 row_ror:8 row_mask:0xf bank_mask:0xf
  v_add_f32_dpp v10, v169, v168 row_ror:8 row_mask:0xf bank_mask:0xf
  v_add_f32_dpp v11, v177, v176 row_ror:8 row_mask:0xf bank_mask:0xf
  v_add_f32_dpp v12, v185, v184 row_ror:8 row_mask:0xf bank_mask:0xf
  v_add_f32_dpp v13, v193, v192 row_ror:8 row_mask:0xf bank_mask:0xf
  v_add_f32_dpp v14, v201, v200 row_ror:8 row_mask:0xf bank_mask:0xf
  v_add_f32_dpp v15, v209, v208 row_ror:8 row_mask:0xf bank_mask:0xf
  v_max3_f32 v7, v8, v9, v10
  v_max3_f32 v7, v7, v11, v12
  v_max3_f32 v7, v7, v13, v14
  v_max_f32 v7, v7, v15
  v_mov_b32 v20, v7
  s_nop 1
  v_permlane16_swap_b32 v7, v20
  s_nop 1
  v_max_f32 v7, v7, v20
  v_mov_b32 v20, v7
  s_nop 1
  v_permlane32_swap_b32 v7, v20
  s_nop 1
  v_max_f32 v7, v7, v20
  v_mul_f32 v7, s52, v7
  v_max_f32 v7, v7, v5
  v_sub_f32 v21, v5, v7
  v_exp_f32 v21, v21
  v_mov_b32 v5, v7
  s_waitcnt vmcnt(3)
  s_add_u32 s77, s44, 0x1000
  buffer_load_dwordx4 v[140:143], v1, s[28:31], s77 offen offset:1024 nt
  v_fma_f32 v8, v8, s52, -v5
  v_fma_f32 v9, v9, s52, -v5
  v_fma_f32 v10, v10, s52, -v5
  v_fma_f32 v11, v11, s52, -v5
  v_fma_f32 v12, v12, s52, -v5
  v_fma_f32 v13, v13, s52, -v5
  v_fma_f32 v14, v14, s52, -v5
  v_fma_f32 v15, v15, s52, -v5
  v_exp_f32 v8, v8
  v_exp_f32 v9, v9
  v_exp_f32 v10, v10
  v_exp_f32 v11, v11
  v_exp_f32 v12, v12
  v_exp_f32 v13, v13
  v_exp_f32 v14, v14
  v_exp_f32 v15, v15
  s_nop 0
  v_add_f32 v22, v8, v9
  v_add_f32 v23, v10, v11
  v_add_f32 v7, v12, v13
  v_add_f32 v20, v14, v15
  v_add_f32 v22, v22, v23
  v_add_f32 v7, v7, v20
  v_add_f32 v22, v22, v7
  v_fma_f32 v6, v6, v21, v22
  v_cvt_pk_bf16_f32 v16, v8, v9
  v_cvt_pk_bf16_f32 v17, v10, v11
  v_cvt_pk_bf16_f32 v18, v12, v13
  v_cvt_pk_bf16_f32 v19, v14, v15
  s_mov_b64 exec, s[56:57]
  ds_write_b128 v244, v[16:19] offset:0
  ds_write_b32 v245, v21 offset:0
  s_mov_b64 exec, -1
  s_waitcnt vmcnt(3)
  s_add_u32 s77, s44, 0x1000
  buffer_load_dwordx4 v[144:147], v1, s[28:31], s77 offen offset:2048 nt
  s_waitcnt vmcnt(3)
  s_add_u32 s77, s44, 0x1000
  buffer_load_dwordx4 v[148:151], v1, s[28:31], s77 offen offset:3072 nt
  s_waitcnt vmcnt(3)
  buffer_load_dwordx4 v[88:91], v246, s[24:27], s45 offen offset:0 nt
  s_waitcnt vmcnt(3)
  buffer_load_dwordx4 v[92:95], v246, s[24:27], s45 offen offset:1024 nt
  s_cmp_lg_u32 s40, 1
  s_cbranch_scc1 L_hk8
  v_subrev_u32 v253, s55, v253
  v_cmp_ge_u32 vcc, s82, v253
  v_min_u32 v253, s82, v253
  s_bcnt1_i32_b32 s49, vcc_lo
  v_mov_b32 v250, v253
  s_nop 1
  v_add_u32_dpp v253, v253, v253 row_shr:1 row_mask:0xf bank_mask:0xf bound_ctrl:0
  v_max_u32_dpp v250, v250, v250 row_shr:1 row_mask:0xf bank_mask:0xf bound_ctrl:0
  s_nop 0
  v_add_u32_dpp v253, v253, v253 row_shr:2 row_mask:0xf bank_mask:0xf bound_ctrl:0
  v_max_u32_dpp v250, v250, v250 row_shr:2 row_mask:0xf bank_mask:0xf bound_ctrl:0
  s_nop 0
  v_add_u32_dpp v253, v253, v253 row_shr:4 row_mask:0xf bank_mask:0xf bound_ctrl:0
  v_max_u32_dpp v250, v250, v250 row_shr:4 row_mask:0xf bank_mask:0xf bound_ctrl:0
  s_nop 0
  v_add_u32_dpp v253, v253, v253 row_shr:8 row_mask:0xf bank_mask:0xf bound_ctrl:0
  v_max_u32_dpp v250, v250, v250 row_shr:8 row_mask:0xf bank_mask:0xf bound_ctrl:0
  s_cmp_ge_u32 s49, 8
  s_cselect_b32 s9, s9, 0
  s_cbranch_scc0 L_hk8
  v_readlane_b32 s48, v253, 15
  v_readlane_b32 s49, v253, 31
  s_add_u32 s48, s48, s49
  s_lshr_b32 s48, s48, 5
  v_readlane_b32 s87, v250, 15
  v_readlane_b32 s49, v250, 31
  s_max_u32 s87, s87, s49
  s_sub_u32 s87, s87, s48
  s_sub_i32 s87, s87, 110
  s_max_i32 s87, s87, 0
  s_lshr_b32 s87, s87, 0
  s_min_u32 s87, s87, 60
  s_cmp_ge_u32 s46, 14
  s_cselect_b32 s87, s87, 0
  s_sub_u32 s49, s48, s9
  s_min_u32 s49, s49, 280
  s_max_u32 s49, s49, 200
  s_sub_i32 s49, s49, s81
  s_ashr_i32 s49, s49, 2
  s_cmp_eq_u32 s9, 0
  s_cselect_b32 s49, 0, s49
  s_add_u32 s49, s49, s81
  s_cmp_eq_u32 s81, 0
  s_cselect_b32 s49, 226, s49
  s_mov_b32 s9, s48
  v_mov_b32 v251, s49
  s_sub_u32 s80, s46, 2
  s_mul_i32 s49, s49, s80
  s_sub_u32 s48, s48, s49
  s_add_u32 s48, s48, s87
  v_mov_b32 v250, s48
  s_mov_b64 exec, 1
  ds_write_b64 v248, v[250:251] offset:24
  s_mov_b64 exec, -1
L_hk8:
  s_waitcnt vmcnt(3)
  buffer_load_dwordx4 v[96:99], v246, s[24:27], s45 offen offset:2048 nt
  s_waitcnt vmcnt(3)
  buffer_load_dwordx4 v[100:103], v246, s[24:27], s45 offen offset:3072 nt
  v_mfma_f32_16x16x32_bf16 v[152:155], v[120:123], v[24:27], 0
  v_mfma_f32_16x16x32_bf16 v[156:159], v[120:123], v[28:31], 0
  v_mfma_f32_16x16x32_bf16 v[160:163], v[124:127], v[24:27], 0
  v_mfma_f32_16x16x32_bf16 v[164:167], v[124:127], v[28:31], 0
  v_mfma_f32_16x16x32_bf16 v[168:171], v[128:131], v[24:27], 0
  v_mfma_f32_16x16x32_bf16 v[172:175], v[128:131], v[28:31], 0
  v_mfma_f32_16x16x32_bf16 v[176:179], v[132:135], v[24:27], 0
  v_mfma_f32_16x16x32_bf16 v[180:183], v[132:135], v[28:31], 0
  v_mfma_f32_16x16x32_bf16 v[184:187], v[136:139], v[24:27], 0
  v_mfma_f32_16x16x32_bf16 v[188:191], v[136:139], v[28:31], 0
  v_mfma_f32_16x16x32_bf16 v[192:195], v[140:143], v[24:27], 0
  v_mfma_f32_16x16x32_bf16 v[196:199], v[140:143], v[28:31], 0
  v_mfma_f32_16x16x32_bf16 v[200:203], v[144:147], v[24:27], 0
  v_mfma_f32_16x16x32_bf16 v[204:207], v[144:147], v[28:31], 0
  v_mfma_f32_16x16x32_bf16 v[208:211], v[148:151], v[24:27], 0
  v_mfma_f32_16x16x32_bf16 v[212:215], v[148:151], v[28:31], 0
  s_waitcnt vmcnt(3)
  s_add_u32 s77, s45, 0x1000
  buffer_load_dwordx4 v[104:107], v246, s[24:27], s77 offen offset:0 nt
  s_nop 3
  v_add_f32 v153, v153, v159
  v_add_f32 v152, v152, v158
  v_add_f32 v161, v161, v167
  v_add_f32 v160, v160, v166
  v_add_f32 v169, v169, v175
  v_add_f32 v168, v168, v174
  v_add_f32 v177, v177, v183
  v_add_f32 v176, v176, v182
  v_add_f32 v185, v185, v191
  v_add_f32 v184, v184, v190
  v_add_f32 v193, v193, v199
  v_add_f32 v192, v192, v198
  v_add_f32 v201, v201, v207
  v_add_f32 v200, v200, v206
  v_add_f32 v209, v209, v215
  v_add_f32 v208, v208, v214
  v_add_f32_dpp v8, v153, v152 row_ror:8 row_mask:0xf bank_mask:0xf
  v_add_f32_dpp v9, v161, v160 row_ror:8 row_mask:0xf bank_mask:0xf
  v_add_f32_dpp v10, v169, v168 row_ror:8 row_mask:0xf bank_mask:0xf
  v_add_f32_dpp v11, v177, v176 row_ror:8 row_mask:0xf bank_mask:0xf
  v_add_f32_dpp v12, v185, v184 row_ror:8 row_mask:0xf bank_mask:0xf
  v_add_f32_dpp v13, v193, v192 row_ror:8 row_mask:0xf bank_mask:0xf
  v_add_f32_dpp v14, v201, v200 row_ror:8 row_mask:0xf bank_mask:0xf
  v_add_f32_dpp v15, v209, v208 row_ror:8 row_mask:0xf bank_mask:0xf
  v_max3_f32 v7, v8, v9, v10
  v_max3_f32 v7, v7, v11, v12
  v_max3_f32 v7, v7, v13, v14
  v_max_f32 v7, v7, v15
  v_mov_b32 v20, v7
  s_nop 1
  v_permlane16_swap_b32 v7, v20
  s_nop 1
  v_max_f32 v7, v7, v20
  v_mov_b32 v20, v7
  s_nop 1
  v_permlane32_swap_b32 v7, v20
  s_nop 1
  v_max_f32 v7, v7, v20
  v_mul_f32 v7, s52, v7
  v_max_f32 v7, v7, v5
  v_sub_f32 v21, v5, v7
  v_exp_f32 v21, v21
  v_mov_b32 v5, v7
  s_waitcnt vmcnt(3)
  s_add_u32 s77, s45, 0x1000
  buffer_load_dwordx4 v[108:111], v246, s[24:27], s77 offen offset:1024 nt
  v_fma_f32 v8, v8, s52, -v5
  v_fma_f32 v9, v9, s52, -v5
  v_fma_f32 v10, v10, s52, -v5
  v_fma_f32 v11, v11, s52, -v5
  v_fma_f32 v12, v12, s52, -v5
  v_fma_f32 v13, v13, s52, -v5
  v_fma_f32 v14, v14, s52, -v5
  v_fma_f32 v15, v15, s52, -v5
  v_exp_f32 v8, v8
  v_exp_f32 v9, v9
  v_exp_f32 v10, v10
  v_exp_f32 v11, v11
  v_exp_f32 v12, v12
  v_exp_f32 v13, v13
  v_exp_f32 v14, v14
  v_exp_f32 v15, v15
  s_nop 0
  v_add_f32 v22, v8, v9
  v_add_f32 v23, v10, v11
  v_add_f32 v7, v12, v13
  v_add_f32 v20, v14, v15
  v_add_f32 v22, v22, v23
  v_add_f32 v7, v7, v20
  v_add_f32 v22, v22, v7
  v_fma_f32 v6, v6, v21, v22
  v_cvt_pk_bf16_f32 v16, v8, v9
  v_cvt_pk_bf16_f32 v17, v10, v11
  v_cvt_pk_bf16_f32 v18, v12, v13
  v_cvt_pk_bf16_f32 v19, v14, v15
  s_mov_b64 exec, s[56:57]
  ds_write_b128 v244, v[16:19] offset:640
  ds_write_b32 v245, v21 offset:640
  s_mov_b64 exec, -1
  s_waitcnt vmcnt(3)
  s_add_u32 s77, s45, 0x1000
  buffer_load_dwordx4 v[112:115], v246, s[24:27], s77 offen offset:2048 nt
  s_waitcnt vmcnt(3)
  s_add_u32 s77, s45, 0x1000
  buffer_load_dwordx4 v[116:119], v246, s[24:27], s77 offen offset:3072 nt
  s_or_b32 s44, s45, 0x4000
  s_mov_b64 s[28:29], s[24:25]
  s_and_b32 s48, s46, 7
  s_cmp_eq_u32 s48, 7
  s_cselect_b32 s48, -7, 1
  s_mulk_i32 s48, 1280
  v_add_u32 v244, s48, v244
  v_add_u32 v245, s48, v245
  s_add_u32 s10, s10, s11
  s_mov_b32 s11, 0
  s_add_u32 s46, s46, 1
  s_branch L_loop
L_b9:
  s_waitcnt vmcnt(7)
  buffer_load_dwordx4 v[120:123], v1, s[28:31], s44 offen offset:0 nt
  s_sub_u32 s48, s100, s10
  v_mov_b32 v226, s48
  s_add_u32 s48, s8, s7
  s_mov_b32 exec_hi, 0
  buffer_load_dword v253, v227, s[32:35], s8 offen sc1
  s_mov_b32 exec_lo, 1
  buffer_store_dword v226, off, s[12:15], s48 sc1
  s_mov_b64 exec, -1
  s_add_u32 s8, s8, 0x1100
  s_mov_b32 s47, 9
  s_branch L_snip
L_ret9:
  s_or_b32 s45, s44, 0x17f00
  s_add_u32 s45, s45, 0x100
  s_and_b32 s45, s45, 0x68000
  s_or_b32 s45, s45, s78
  s_waitcnt vmcnt(11)
  buffer_load_dwordx4 v[124:127], v1, s[28:31], s44 offen offset:1024 nt
  s_waitcnt vmcnt(11)
  buffer_load_dwordx4 v[128:131], v1, s[28:31], s44 offen offset:2048 nt
  s_waitcnt vmcnt(11)
  buffer_load_dwordx4 v[132:135], v1, s[28:31], s44 offen offset:3072 nt
  s_waitcnt vmcnt(11)
  s_add_u32 s77, s44, 0x1000
  buffer_load_dwordx4 v[136:139], v1, s[28:31], s77 offen offset:0 nt
  s_waitcnt vmcnt(11)
  s_add_u32 s77, s44, 0x1000
  buffer_load_dwordx4 v[140:143], v1, s[28:31], s77 offen offset:1024 nt
  s_waitcnt vmcnt(11)
  s_add_u32 s77, s44, 0x1000
  buffer_load_dwordx4 v[144:147], v1, s[28:31], s77 offen offset:2048 nt
  s_waitcnt vmcnt(11)
  s_add_u32 s77, s44, 0x1000
  buffer_load_dwordx4 v[148:151], v1, s[28:31], s77 offen offset:3072 nt
  v_mfma_f32_16x16x32_bf16 v[152:155], v[88:91], v[24:27], 0
  v_mfma_f32_16x16x32_bf16 v[156:159], v[88:91], v[28:31], 0
  v_mfma_f32_16x16x32_bf16 v[160:163], v[92:95], v[24:27], 0
  v_mfma_f32_16x16x32_bf16 v[164:167], v[92:95], v[28:31], 0
  v_mfma_f32_16x16x32_bf16 v[168:171], v[96:99], v[24:27], 0
  v_mfma_f32_16x16x32_bf16 v[172:175], v[96:99], v[28:31], 0
  v_mfma_f32_16x16x32_bf16 v[176:179], v[100:103], v[24:27], 0
  v_mfma_f32_16x16x32_bf16 v[180:183], v[100:103], v[28:31], 0
  v_mfma_f32_16x16x32_bf16 v[184:187], v[104:107], v[24:27], 0
  v_mfma_f32_16x16x32_bf16 v[188:191], v[104:107], v[28:31], 0
  v_mfma_f32_16x16x32_bf16 v[192:195], v[108:111], v[24:27], 0
  v_mfma_f32_16x16x32_bf16 v[196:199], v[108:111], v[28:31], 0
  v_mfma_f32_16x16x32_bf16 v[200:203], v[112:115], v[24:27], 0
  v_mfma_f32_16x16x32_bf16 v[204:207], v[112:115], v[28:31], 0
  v_mfma_f32_16x16x32_bf16 v[208:211], v[116:119], v[24:27], 0
  v_mfma_f32_16x16x32_bf16 v[212:215], v[116:119], v[28:31], 0
  s_waitcnt vmcnt(11)
  buffer_load_dwordx4 v[88:91], v246, s[24:27], s45 offen offset:0 nt
  s_nop 3
  v_add_f32 v153, v153, v159
  v_add_f32 v152, v152, v158
  v_add_f32 v161, v161, v167
  v_add_f32 v160, v160, v166
  v_add_f32 v169, v169, v175
  v_add_f32 v168, v168, v174
  v_add_f32 v177, v177, v183
  v_add_f32 v176, v176, v182
  v_add_f32 v185, v185, v191
  v_add_f32 v184, v184, v190
  v_add_f32 v193, v193, v199
  v_add_f32 v192, v192, v198
  v_add_f32 v201, v201, v207
  v_add_f32 v200, v200, v206
  v_add_f32 v209, v209, v215
  v_add_f32 v208, v208, v214
  v_add_f32_dpp v8, v153, v152 row_ror:8 row_mask:0xf bank_mask:0xf
  v_add_f32_dpp v9, v161, v160 row_ror:8 row_mask:0xf bank_mask:0xf
  v_add_f32_dpp v10, v169, v168 row_ror:8 row_mask:0xf bank_mask:0xf
  v_add_f32_dpp v11, v177, v176 row_ror:8 row_mask:0xf bank_mask:0xf
  v_add_f32_dpp v12, v185, v184 row_ror:8 row_mask:0xf bank_mask:0xf
  v_add_f32_dpp v13, v193, v192 row_ror:8 row_mask:0xf bank_mask:0xf
  v_add_f32_dpp v14, v201, v200 row_ror:8 row_mask:0xf bank_mask:0xf
  v_add_f32_dpp v15, v209, v208 row_ror:8 row_mask:0xf bank_mask:0xf
  v_max3_f32 v7, v8, v9, v10
  v_max3_f32 v7, v7, v11, v12
  v_max3_f32 v7, v7, v13, v14
  v_max_f32 v7, v7, v15
  v_mov_b32 v20, v7
  s_nop 1
  v_permlane16_swap_b32 v7, v20
  s_nop 1
  v_max_f32 v7, v7, v20
  v_mov_b32 v20, v7
  s_nop 1
  v_permlane32_swap_b32 v7, v20
  s_nop 1
  v_max_f32 v7, v7, v20
  v_mul_f32 v7, s52, v7
  v_max_f32 v7, v7, v5
  v_sub_f32 v21, v5, v7
  v_exp_f32 v21, v21
  v_mov_b32 v5, v7
  s_waitcnt vmcnt(7)
  buffer_load_dwordx4 v[92:95], v246, s[24:27], s45 offen offset:1024 nt
  v_fma_f32 v8, v8, s52, -v5
  v_fma_f32 v9, v9, s52, -v5
  v_fma_f32 v10, v10, s52, -v5
  v_fma_f32 v11, v11, s52, -v5
  v_fma_f32 v12, v12, s52, -v5
  v_fma_f32 v13, v13, s52, -v5
  v_fma_f32 v14, v14, s52, -v5
  v_fma_f32 v15, v15, s52, -v5
  v_exp_f32 v8, v8
  v_exp_f32 v9, v9
  v_exp_f32 v10, v10
  v_exp_f32 v11, v11
  v_exp_f32 v12, v12
  v_exp_f32 v13, v13
  v_exp_f32 v14, v14
  v_exp_f32 v15, v15
  s_nop 0
  v_add_f32 v22, v8, v9
  v_add_f32 v23, v10, v11
  v_add_f32 v7, v12, v13
  v_add_f32 v20, v14, v15
  v_add_f32 v22, v22, v23
  v_add_f32 v7, v7, v20
  v_add_f32 v22, v22, v7
  v_fma_f32 v6, v6, v21, v22
  v_cvt_pk_bf16_f32 v16, v8, v9
  v_cvt_pk_bf16_f32 v17, v10, v11
  v_cvt_pk_bf16_f32 v18, v12, v13
  v_cvt_pk_bf16_f32 v19, v14, v15
  s_mov_b64 exec, s[56:57]
  ds_write_b128 v244, v[16:19] offset:0
  ds_write_b32 v245, v21 offset:0
  s_mov_b64 exec, -1
  s_cmp_lg_u32 s40, 1
  s_cbranch_scc1 L_hk9
  v_subrev_u32 v253, s55, v253
  v_cmp_ge_u32 vcc, s82, v253
  v_min_u32 v253, s82, v253
  s_bcnt1_i32_b32 s49, vcc_lo
  v_mov_b32 v250, v253
  s_nop 1
  v_add_u32_dpp v253, v253, v253 row_shr:1 row_mask:0xf bank_mask:0xf bound_ctrl:0
  v_max_u32_dpp v250, v250, v250 row_shr:1 row_mask:0xf bank_mask:0xf bound_ctrl:0
  s_nop 0
  v_add_u32_dpp v253, v253, v253 row_shr:2 row_mask:0xf bank_mask:0xf bound_ctrl:0
  v_max_u32_dpp v250, v250, v250 row_shr:2 row_mask:0xf bank_mask:0xf bound_ctrl:0
  s_nop 0
  v_add_u32_dpp v253, v253, v253 row_shr:4 row_mask:0xf bank_mask:0xf bound_ctrl:0
  v_max_u32_dpp v250, v250, v250 row_shr:4 row_mask:0xf bank_mask:0xf bound_ctrl:0
  s_nop 0
  v_add_u32_dpp v253, v253, v253 row_shr:8 row_mask:0xf bank_mask:0xf bound_ctrl:0
  v_max_u32_dpp v250, v250, v250 row_shr:8 row_mask:0xf bank_mask:0xf bound_ctrl:0
  s_cmp_ge_u32 s49, 8
  s_cselect_b32 s9, s9, 0
  s_cbranch_scc0 L_hk9
  v_readlane_b32 s48, v253, 15
  v_readlane_b32 s49, v253, 31
  s_add_u32 s48, s48, s49
  s_lshr_b32 s48, s48, 5
  v_readlane_b32 s87, v250, 15
  v_readlane_b32 s49, v250, 31
  s_max_u32 s87, s87, s49
  s_sub_u32 s87, s87, s48
  s_sub_i32 s87, s87, 110
  s_max_i32 s87, s87, 0
  s_lshr_b32 s87, s87, 0
  s_min_u32 s87, s87, 60
  s_cmp_ge_u32 s46, 14
  s_cselect_b32 s87, s87, 0
  s_sub_u32 s49, s48, s9
  s_min_u32 s49, s49, 280
  s_max_u32 s49, s49, 200
  s_sub_i32 s49, s49, s81
  s_ashr_i32 s49, s49, 2
  s_cmp_eq_u32 s9, 0
  s_cselect_b32 s49, 0, s49
  s_add_u32 s49, s49, s81
  s_cmp_eq_u32 s81, 0
  s_cselect_b32 s49, 226, s49
  s_mov_b32 s9, s48
  v_mov_b32 v251, s49
  s_sub_u32 s80, s46, 2
  s_mul_i32 s49, s49, s80
  s_sub_u32 s48, s48, s49
  s_add_u32 s48, s48, s87
  v_mov_b32 v250, s48
  s_mov_b64 exec, 1
  ds_write_b64 v248, v[250:251] offset:24
  s_mov_b64 exec, -1
L_hk9:
  s_waitcnt vmcnt(7)
  buffer_load_dwordx4 v[96:99], v246, s[24:27], s45 offen offset:2048 nt
  s_waitcnt vmcnt(7)
  buffer_load_dwordx4 v[100:103], v246, s[24:27], s45 offen offset:3072 nt
  s_waitcnt vmcnt(7)
  s_add_u32 s77, s45, 0x1000
  buffer_load_dwordx4 v[104:107], v246, s[24:27], s77 offen offset:0 nt
  s_waitcnt vmcnt(7)
  s_add_u32 s77, s45, 0x1000
  buffer_load_dwordx4 v[108:111], v246, s[24:27], s77 offen offset:1024 nt
  s_waitcnt vmcnt(7)
  s_add_u32 s77, s45, 0x1000
  buffer_load_dwordx4 v[112:115], v246, s[24:27], s77 offen offset:2048 nt
  s_waitcnt vmcnt(7)
  s_add_u32 s77, s45, 0x1000
  buffer_load_dwordx4 v[116:119], v246, s[24:27], s77 offen offset:3072 nt
  v_mfma_f32_16x16x32_bf16 v[152:155], v[120:123], v[24:27], 0
  v_mfma_f32_16x16x32_bf16 v[156:159], v[120:123], v[28:31], 0
  v_mfma_f32_16x16x32_bf16 v[160:163], v[124:127], v[24:27], 0
  v_mfma_f32_16x16x32_bf16 v[164:167], v[124:127], v[28:31], 0
  v_mfma_f32_16x16x32_bf16 v[168:171], v[128:131], v[24:27], 0
  v_mfma_f32_16x16x32_bf16 v[172:175], v[128:131], v[28:31], 0
  v_mfma_f32_16x16x32_bf16 v[176:179], v[132:135], v[24:27], 0
  v_mfma_f32_16x16x32_bf16 v[180:183], v[132:135], v[28:31], 0
  v_mfma_f32_16x16x32_bf16 v[184:187], v[136:139], v[24:27], 0
  v_mfma_f32_16x16x32_bf16 v[188:191], v[136:139], v[28:31], 0
  v_mfma_f32_16x16x32_bf16 v[192:195], v[140:143], v[24:27], 0
  v_mfma_f32_16x16x32_bf16 v[196:199], v[140:143], v[28:31], 0
  v_mfma_f32_16x16x32_bf16 v[200:203], v[144:147], v[24:27], 0
  v_mfma_f32_16x16x32_bf16 v[204:207], v[144:147], v[28:31], 0
  v_mfma_f32_16x16x32_bf16 v[208:211], v[148:151], v[24:27], 0
  v_mfma_f32_16x16x32_bf16 v[212:215], v[148:151], v[28:31], 0
  s_nop 3
  v_add_f32 v153, v153, v159
  v_add_f32 v152, v152, v158
  v_add_f32 v161, v161, v167
  v_add_f32 v160, v160, v166
  v_add_f32 v169, v169, v175
  v_add_f32 v168, v168, v174
  v_add_f32 v177, v177, v183
  v_add_f32 v176, v176, v182
  v_add_f32 v185, v185, v191
  v_add_f32 v184, v184, v190
  v_add_f32 v193, v193, v199
  v_add_f32 v192, v192, v198
  v_add_f32 v201, v201, v207
  v_add_f32 v200, v200, v206
  v_add_f32 v209, v209, v215
  v_add_f32 v208, v208, v214
  v_add_f32_dpp v8, v153, v152 row_ror:8 row_mask:0xf bank_mask:0xf
  v_add_f32_dpp v9, v161, v160 row_ror:8 row_mask:0xf bank_mask:0xf
  v_add_f32_dpp v10, v169, v168 row_ror:8 row_mask:0xf bank_mask:0xf
  v_add_f32_dpp v11, v177, v176 row_ror:8 row_mask:0xf bank_mask:0xf
  v_add_f32_dpp v12, v185, v184 row_ror:8 row_mask:0xf bank_mask:0xf
  v_add_f32_dpp v13, v193, v192 row_ror:8 row_mask:0xf bank_mask:0xf
  v_add_f32_dpp v14, v201, v200 row_ror:8 row_mask:0xf bank_mask:0xf
  v_add_f32_dpp v15, v209, v208 row_ror:8 row_mask:0xf bank_mask:0xf
  v_max3_f32 v7, v8, v9, v10
  v_max3_f32 v7, v7, v11, v12
  v_max3_f32 v7, v7, v13, v14
  v_max_f32 v7, v7, v15
  v_mov_b32 v20, v7
  s_nop 1
  v_permlane16_swap_b32 v7, v20
  s_nop 1
  v_max_f32 v7, v7, v20
  v_mov_b32 v20, v7
  s_nop 1
  v_permlane32_swap_b32 v7, v20
  s_nop 1
  v_max_f32 v7, v7, v20
  v_mul_f32 v7, s52, v7
  v_max_f32 v7, v7, v5
  v_sub_f32 v21, v5, v7
  v_exp_f32 v21, v21
  v_mov_b32 v5, v7
  v_fma_f32 v8, v8, s52, -v5
  v_fma_f32 v9, v9, s52, -v5
  v_fma_f32 v10, v10, s52, -v5
  v_fma_f32 v11, v11, s52, -v5
  v_fma_f32 v12, v12, s52, -v5
  v_fma_f32 v13, v13, s52, -v5
  v_fma_f32 v14, v14, s52, -v5
  v_fma_f32 v15, v15, s52, -v5
  v_exp_f32 v8, v8
  v_exp_f32 v9, v9
  v_exp_f32 v10, v10
  v_exp_f32 v11, v11
  v_exp_f32 v12, v12
  v_exp_f32 v13, v13
  v_exp_f32 v14, v14
  v_exp_f32 v15, v15
  s_nop 0
  v_add_f32 v22, v8, v9
  v_add_f32 v23, v10, v11
  v_add_f32 v7, v12, v13
  v_add_f32 v20, v14, v15
  v_add_f32 v22, v22, v23
  v_add_f32 v7, v7, v20
  v_add_f32 v22, v22, v7
  v_fma_f32 v6, v6, v21, v22
  v_cvt_pk_bf16_f32 v16, v8, v9
  v_cvt_pk_bf16_f32 v17, v10, v11
  v_cvt_pk_bf16_f32 v18, v12, v13
  v_cvt_pk_bf16_f32 v19, v14, v15
  s_mov_b64 exec, s[56:57]
  ds_write_b128 v244, v[16:19] offset:640
  ds_write_b32 v245, v21 offset:640
  s_mov_b64 exec, -1
  s_or_b32 s44, s45, 0x4000
  s_mov_b64 s[28:29], s[24:25]
  s_and_b32 s48, s46, 7
  s_cmp_eq_u32 s48, 7
  s_cselect_b32 s48, -7, 1
  s_mulk_i32 s48, 1280
  v_add_u32 v244, s48, v244
  v_add_u32 v245, s48, v245
  s_add_u32 s10, s10, s11
  s_mov_b32 s11, 0
  s_add_u32 s46, s46, 1
  s_branch L_loop
L_b7:
  s_waitcnt vmcnt(6)
  buffer_load_dwordx4 v[120:123], v1, s[28:31], s44 offen offset:0 nt
  s_sub_u32 s48, s100, s10
  v_mov_b32 v226, s48
  s_add_u32 s48, s8, s7
  s_mov_b32 exec_hi, 0
  buffer_load_dword v253, v227, s[32:35], s8 offen sc1
  s_mov_b32 exec_lo, 1
  buffer_store_dword v226, off, s[12:15], s48 sc1
  s_mov_b64 exec, -1
  s_add_u32 s8, s8, 0x1100
  s_mov_b32 s47, 7
  s_branch L_snip
L_ret7:
  s_or_b32 s45, s44, 0x17f00
  s_add_u32 s45, s45, 0x100
  s_and_b32 s45, s45, 0x68000
  s_or_b32 s45, s45, s78
  s_waitcnt vmcnt(10)
  buffer_load_dwordx4 v[124:127], v1, s[28:31], s44 offen offset:1024 nt
  s_waitcnt vmcnt(10)
  buffer_load_dwordx4 v[128:131], v1, s[28:31], s44 offen offset:2048 nt
  s_waitcnt vmcnt(10)
  buffer_load_dwordx4 v[132:135], v1, s[28:31], s44 offen offset:3072 nt
  s_waitcnt vmcnt(10)
  s_add_u32 s77, s44, 0x1000
  buffer_load_dwordx4 v[136:139], v1, s[28:31], s77 offen offset:0 nt
  s_waitcnt vmcnt(10)
  s_add_u32 s77, s44, 0x1000
  buffer_load_dwordx4 v[140:143], v1, s[28:31], s77 offen offset:1024 nt
  s_waitcnt vmcnt(10)
  s_add_u32 s77, s44, 0x1000
  buffer_load_dwordx4 v[144:147], v1, s[28:31], s77 offen offset:2048 nt
  v_mfma_f32_16x16x32_bf16 v[152:155], v[88:91], v[24:27], 0
  v_mfma_f32_16x16x32_bf16 v[156:159], v[88:91], v[28:31], 0
  v_mfma_f32_16x16x32_bf16 v[160:163], v[92:95], v[24:27], 0
  v_mfma_f32_16x16x32_bf16 v[164:167], v[92:95], v[28:31], 0
  v_mfma_f32_16x16x32_bf16 v[168:171], v[96:99], v[24:27], 0
  v_mfma_f32_16x16x32_bf16 v[172:175], v[96:99], v[28:31], 0
  v_mfma_f32_16x16x32_bf16 v[176:179], v[100:103], v[24:27], 0
  v_mfma_f32_16x16x32_bf16 v[180:183], v[100:103], v[28:31], 0
  v_mfma_f32_16x16x32_bf16 v[184:187], v[104:107], v[24:27], 0
  v_mfma_f32_16x16x32_bf16 v[188:191], v[104:107], v[28:31], 0
  v_mfma_f32_16x16x32_bf16 v[192:195], v[108:111], v[24:27], 0
  v_mfma_f32_16x16x32_bf16 v[196:199], v[108:111], v[28:31], 0
  v_mfma_f32_16x16x32_bf16 v[200:203], v[112:115], v[24:27], 0
  v_mfma_f32_16x16x32_bf16 v[204:207], v[112:115], v[28:31], 0
  v_mfma_f32_16x16x32_bf16 v[208:211], v[116:119], v[24:27], 0
  v_mfma_f32_16x16x32_bf16 v[212:215], v[116:119], v[28:31], 0
  s_waitcnt vmcnt(10)
  s_add_u32 s77, s44, 0x1000
  buffer_load_dwordx4 v[148:151], v1, s[28:31], s77 offen offset:3072 nt
  s_nop 3
  v_add_f32 v153, v153, v159
  v_add_f32 v152, v152, v158
  v_add_f32 v161, v161, v167
  v_add_f32 v160, v160, v166
  v_add_f32 v169, v169, v175
  v_add_f32 v168, v168, v174
  v_add_f32 v177, v177, v183
  v_add_f32 v176, v176, v182
  v_add_f32 v185, v185, v191
  v_add_f32 v184, v184, v190
  v_add_f32 v193, v193, v199
  v_add_f32 v192, v192, v198
  v_add_f32 v201, v201, v207
  v_add_f32 v200, v200, v206
  v_add_f32 v209, v209, v215
  v_add_f32 v208, v208, v214
  v_add_f32_dpp v8, v153, v152 row_ror:8 row_mask:0xf bank_mask:0xf
  v_add_f32_dpp v9, v161, v160 row_ror:8 row_mask:0xf bank_mask:0xf
  v_add_f32_dpp v10, v169, v168 row_ror:8 row_mask:0xf bank_mask:0xf
  v_add_f32_dpp v11, v177, v176 row_ror:8 row_mask:0xf bank_mask:0xf
  v_add_f32_dpp v12, v185, v184 row_ror:8 row_mask:0xf bank_mask:0xf
  v_add_f32_dpp v13, v193, v192 row_ror:8 row_mask:0xf bank_mask:0xf
  v_add_f32_dpp v14, v201, v200 row_ror:8 row_mask:0xf bank_mask:0xf
  v_add_f32_dpp v15, v209, v208 row_ror:8 row_mask:0xf bank_mask:0xf
  v_max3_f32 v7, v8, v9, v10
  v_max3_f32 v7, v7, v11, v12
  v_max3_f32 v7, v7, v13, v14
  v_max_f32 v7, v7, v15
  v_mov_b32 v20, v7
  s_nop 1
  v_permlane16_swap_b32 v7, v20
  s_nop 1
  v_max_f32 v7, v7, v20
  v_mov_b32 v20, v7
  s_nop 1
  v_permlane32_swap_b32 v7, v20
  s_nop 1
  v_max_f32 v7, v7, v20
  v_mul_f32 v7, s52, v7
  v_max_f32 v7, v7, v5
  v_sub_f32 v21, v5, v7
  v_exp_f32 v21, v21
  v_mov_b32 v5, v7
  s_waitcnt vmcnt(6)
  buffer_load_dwordx4 v[88:91], v246, s[24:27], s45 offen offset:0 nt
  v_fma_f32 v8, v8, s52, -v5
  v_fma_f32 v9, v9, s52, -v5
  v_fma_f32 v10, v10, s52, -v5
  v_fma_f32 v11, v11, s52, -v5
  v_fma_f32 v12, v12, s52, -v5
  v_fma_f32 v13, v13, s52, -v5
  v_fma_f32 v14, v14, s52, -v5
  v_fma_f32 v15, v15, s52, -v5
  v_exp_f32 v8, v8
  v_exp_f32 v9, v9
  v_exp_f32 v10, v10
  v_exp_f32 v11, v11
  v_exp_f32 v12, v12
  v_exp_f32 v13, v13
  v_exp_f32 v14, v14
  v_exp_f32 v15, v15
  s_nop 0
  v_add_f32 v22, v8, v9
  v_add_f32 v23, v10, v11
  v_add_f32 v7, v12, v13
  v_add_f32 v20, v14, v15
  v_add_f32 v22, v22, v23
  v_add_f32 v7, v7, v20
  v_add_f32 v22, v22, v7
  v_fma_f32 v6, v6, v21, v22
  v_cvt_pk_bf16_f32 v16, v8, v9
  v_cvt_pk_bf16_f32 v17, v10, v11
  v_cvt_pk_bf16_f32 v18, v12, v13
  v_cvt_pk_bf16_f32 v19, v14, v15
  s_mov_b64 exec, s[56:57]
  ds_write_b128 v244, v[16:19] offset:0
  ds_write_b32 v245, v21 offset:0
  s_mov_b64 exec, -1
  s_waitcnt vmcnt(6)
  buffer_load_dwordx4 v[92:95], v246, s[24:27], s45 offen offset:1024 nt
  s_cmp_lg_u32 s40, 1
  s_cbranch_scc1 L_hk7
  v_subrev_u32 v253, s55, v253
  v_cmp_ge_u32 vcc, s82, v253
  v_min_u32 v253, s82, v253
  s_bcnt1_i32_b32 s49, vcc_lo
  v_mov_b32 v250, v253
  s_nop 1
  v_add_u32_dpp v253, v253, v253 row_shr:1 row_mask:0xf bank_mask:0xf bound_ctrl:0
  v_max_u32_dpp v250, v250, v250 row_shr:1 row_mask:0xf bank_mask:0xf bound_ctrl:0
  s_nop 0
  v_add_u32_dpp v253, v253, v253 row_shr:2 row_mask:0xf bank_mask:0xf bound_ctrl:0
  v_max_u32_dpp v250, v250, v250 row_shr:2 row_mask:0xf bank_mask:0xf bound_ctrl:0
  s_nop 0
  v_add_u32_dpp v253, v253, v253 row_shr:4 row_mask:0xf bank_mask:0xf bound_ctrl:0
  v_max_u32_dpp v250, v250, v250 row_shr:4 row_mask:0xf bank_mask:0xf bound_ctrl:0
  s_nop 0
  v_add_u32_dpp v253, v253, v253 row_shr:8 row_mask:0xf bank_mask:0xf bound_ctrl:0
  v_max_u32_dpp v250, v250, v250 row_shr:8 row_mask:0xf bank_mask:0xf bound_ctrl:0
  s_cmp_ge_u32 s49, 8
  s_cselect_b32 s9, s9, 0
  s_cbranch_scc0 L_hk7
  v_readlane_b32 s48, v253, 15
  v_readlane_b32 s49, v253, 31
  s_add_u32 s48, s48, s49
  s_lshr_b32 s48, s48, 5
  v_readlane_b32 s87, v250, 15
  v_readlane_b32 s49, v250, 31
  s_max_u32 s87, s87, s49
  s_sub_u32 s87, s87, s48
  s_sub_i32 s87, s87, 110
  s_max_i32 s87, s87, 0
  s_lshr_b32 s87, s87, 0
  s_min_u32 s87, s87, 60
  s_cmp_ge_u32 s46, 14
  s_cselect_b32 s87, s87, 0
  s_sub_u32 s49, s48, s9
  s_min_u32 s49, s49, 280
  s_max_u32 s49, s49, 200
  s_sub_i32 s49, s49, s81
  s_ashr_i32 s49, s49, 2
  s_cmp_eq_u32 s9, 0
  s_cselect_b32 s49, 0, s49
  s_add_u32 s49, s49, s81
  s_cmp_eq_u32 s81, 0
  s_cselect_b32 s49, 226, s49
  s_mov_b32 s9, s48
  v_mov_b32 v251, s49
  s_sub_u32 s80, s46, 2
  s_mul_i32 s49, s49, s80
  s_sub_u32 s48, s48, s49
  s_add_u32 s48, s48, s87
  v_mov_b32 v250, s48
  s_mov_b64 exec, 1
  ds_write_b64 v248, v[250:251] offset:24
  s_mov_b64 exec, -1
L_hk7:
  s_waitcnt vmcnt(6)
  buffer_load_dwordx4 v[96:99], v246, s[24:27], s45 offen offset:2048 nt
  s_waitcnt vmcnt(6)
  buffer_load_dwordx4 v[100:103], v246, s[24:27], s45 offen offset:3072 nt
  s_waitcnt vmcnt(6)
  s_add_u32 s77, s45, 0x1000
  buffer_load_dwordx4 v[104:107], v246, s[24:27], s77 offen offset:0 nt
  s_waitcnt vmcnt(6)
  s_add_u32 s77, s45, 0x1000
  buffer_load_dwordx4 v[108:111], v246, s[24:27], s77 offen offset:1024 nt
  s_waitcnt vmcnt(6)
  s_add_u32 s77, s45, 0x1000
  buffer_load_dwordx4 v[112:115], v246, s[24:27], s77 offen offset:2048 nt
  v_mfma_f32_16x16x32_bf16 v[152:155], v[120:123], v[24:27], 0
  v_mfma_f32_16x16x32_bf16 v[156:159], v[120:123], v[28:31], 0
  v_mfma_f32_16x16x32_bf16 v[160:163], v[124:127], v[24:27], 0
  v_mfma_f32_16x16x32_bf16 v[164:167], v[124:127], v[28:31], 0
  v_mfma_f32_16x16x32_bf16 v[168:171], v[128:131], v[24:27], 0
  v_mfma_f32_16x16x32_bf16 v[172:175], v[128:131], v[28:31], 0
  v_mfma_f32_16x16x32_bf16 v[176:179], v[132:135], v[24:27], 0
  v_mfma_f32_16x16x32_bf16 v[180:183], v[132:135], v[28:31], 0
  v_mfma_f32_16x16x32_bf16 v[184:187], v[136:139], v[24:27], 0
  v_mfma_f32_16x16x32_bf16 v[188:191], v[136:139], v[28:31], 0
  v_mfma_f32_16x16x32_bf16 v[192:195], v[140:143], v[24:27], 0
  v_mfma_f32_16x16x32_bf16 v[196:199], v[140:143], v[28:31], 0
  v_mfma_f32_16x16x32_bf16 v[200:203], v[144:147], v[24:27], 0
  v_mfma_f32_16x16x32_bf16 v[204:207], v[144:147], v[28:31], 0
  v_mfma_f32_16x16x32_bf16 v[208:211], v[148:151], v[24:27], 0
  v_mfma_f32_16x16x32_bf16 v[212:215], v[148:151], v[28:31], 0
  s_waitcnt vmcnt(6)
  s_add_u32 s77, s45, 0x1000
  buffer_load_dwordx4 v[116:119], v246, s[24:27], s77 offen offset:3072 nt
  s_nop 3
  v_add_f32 v153, v153, v159
  v_add_f32 v152, v152, v158
  v_add_f32 v161, v161, v167
  v_add_f32 v160, v160, v166
  v_add_f32 v169, v169, v175
  v_add_f32 v168, v168, v174
  v_add_f32 v177, v177, v183
  v_add_f32 v176, v176, v182
  v_add_f32 v185, v185, v191
  v_add_f32 v184, v184, v190
  v_add_f32 v193, v193, v199
  v_add_f32 v192, v192, v198
  v_add_f32 v201, v201, v207
  v_add_f32 v200, v200, v206
  v_add_f32 v209, v209, v215
  v_add_f32 v208, v208, v214
  v_add_f32_dpp v8, v153, v152 row_ror:8 row_mask:0xf bank_mask:0xf
  v_add_f32_dpp v9, v161, v160 row_ror:8 row_mask:0xf bank_mask:0xf
  v_add_f32_dpp v10, v169, v168 row_ror:8 row_mask:0xf bank_mask:0xf
  v_add_f32_dpp v11, v177, v176 row_ror:8 row_mask:0xf bank_mask:0xf
  v_add_f32_dpp v12, v185, v184 row_ror:8 row_mask:0xf bank_mask:0xf
  v_add_f32_dpp v13, v193, v192 row_ror:8 row_mask:0xf bank_mask:0xf
  v_add_f32_dpp v14, v201, v200 row_ror:8 row_mask:0xf bank_mask:0xf
  v_add_f32_dpp v15, v209, v208 row_ror:8 row_mask:0xf bank_mask:0xf
  v_max3_f32 v7, v8, v9, v10
  v_max3_f32 v7, v7, v11, v12
  v_max3_f32 v7, v7, v13, v14
  v_max_f32 v7, v7, v15
  v_mov_b32 v20, v7
  s_nop 1
  v_permlane16_swap_b32 v7, v20
  s_nop 1
  v_max_f32 v7, v7, v20
  v_mov_b32 v20, v7
  s_nop 1
  v_permlane32_swap_b32 v7, v20
  s_nop 1
  v_max_f32 v7, v7, v20
  v_mul_f32 v7, s52, v7
  v_max_f32 v7, v7, v5
  v_sub_f32 v21, v5, v7
  v_exp_f32 v21, v21
  v_mov_b32 v5, v7
  v_fma_f32 v8, v8, s52, -v5
  v_fma_f32 v9, v9, s52, -v5
  v_fma_f32 v10, v10, s52, -v5
  v_fma_f32 v11, v11, s52, -v5
  v_fma_f32 v12, v12, s52, -v5
  v_fma_f32 v13, v13, s52, -v5
  v_fma_f32 v14, v14, s52, -v5
  v_fma_f32 v15, v15, s52, -v5
  v_exp_f32 v8, v8
  v_exp_f32 v9, v9
  v_exp_f32 v10, v10
  v_exp_f32 v11, v11
  v_exp_f32 v12, v12
  v_exp_f32 v13, v13
  v_exp_f32 v14, v14
  v_exp_f32 v15, v15
  s_nop 0
  v_add_f32 v22, v8, v9
  v_add_f32 v23, v10, v11
  v_add_f32 v7, v12, v13
  v_add_f32 v20, v14, v15
  v_add_f32 v22, v22, v23
  v_add_f32 v7, v7, v20
  v_add_f32 v22, v22, v7
  v_fma_f32 v6, v6, v21, v22
  v_cvt_pk_bf16_f32 v16, v8, v9
  v_cvt_pk_bf16_f32 v17, v10, v11
  v_cvt_pk_bf16_f32 v18, v12, v13
  v_cvt_pk_bf16_f32 v19, v14, v15
  s_mov_b64 exec, s[56:57]
  ds_write_b128 v244, v[16:19] offset:640
  ds_write_b32 v245, v21 offset:640
  s_mov_b64 exec, -1
  s_or_b32 s44, s45, 0x4000
  s_mov_b64 s[28:29], s[24:25]
  s_and_b32 s48, s46, 7
  s_cmp_eq_u32 s48, 7
  s_cselect_b32 s48, -7, 1
  s_mulk_i32 s48, 1280
  v_add_u32 v244, s48, v244
  v_add_u32 v245, s48, v245
  s_add_u32 s10, s10, s11
  s_mov_b32 s11, 0
  s_add_u32 s46, s46, 1
  s_branch L_loop
L_vdisp:
  s_cmp_lt_i32 s87, -80
  s_cbranch_scc1 L_b3
  s_cmp_lt_i32 s87, -40
  s_cbranch_scc1 L_b0
  s_cmp_gt_i32 s87, 40
  s_cbranch_scc1 L_b4
  s_cmp_gt_i32 s87, 0
  s_cbranch_scc1 L_b2
L_b1:
  s_waitcnt vmcnt(5)
  buffer_load_dwordx4 v[120:123], v3, s[28:31], s44 offen offset:0 nt
  s_sub_u32 s48, s100, s10
  v_mov_b32 v226, s48
  s_add_u32 s48, s8, s7
  s_mov_b32 exec_hi, 0
  buffer_load_dword v253, v227, s[32:35], s8 offen sc1
  s_mov_b32 exec_lo, 1
  buffer_store_dword v226, off, s[12:15], s48 sc1
  s_mov_b64 exec, -1
  s_add_u32 s8, s8, 0x1100
  s_mov_b32 s47, 1
  s_branch L_snip
L_ret1:
  s_or_b32 s45, s44, 0x17f00
  s_add_u32 s45, s45, 0x100
  s_and_b32 s45, s45, 0x68000
  s_or_b32 s45, s45, s78
  ds_read_b32 v21, v245
  ds_read_b128 v[16:19], v244
  ds_read_b32 v22, v245 offset:640
  ds_read_b128 v[8:11], v244 offset:640
  s_waitcnt vmcnt(9)
  buffer_load_dwordx4 v[124:127], v3, s[28:31], s44 offen offset:1024 nt
  s_waitcnt lgkmcnt(0)
  s_nop 7
  v_mul_f32 v40, v21, v40
  v_mul_f32 v41, v21, v41
  v_mul_f32 v42, v21, v42
  v_mul_f32 v43, v21, v43
  v_mul_f32 v44, v21, v44
  v_mul_f32 v45, v21, v45
  v_mul_f32 v46, v21, v46
  v_mul_f32 v47, v21, v47
  v_mul_f32 v48, v21, v48
  v_mul_f32 v49, v21, v49
  v_mul_f32 v50, v21, v50
  v_mul_f32 v51, v21, v51
  v_mul_f32 v52, v21, v52
  v_mul_f32 v53, v21, v53
  v_mul_f32 v54, v21, v54
  v_mul_f32 v55, v21, v55
  v_mul_f32 v56, v21, v56
  v_mul_f32 v57, v21, v57
  v_mul_f32 v58, v21, v58
  v_mul_f32 v59, v21, v59
  v_mul_f32 v60, v21, v60
  v_mul_f32 v61, v21, v61
  v_mul_f32 v62, v21, v62
  v_mul_f32 v63, v21, v63
  v_mul_f32 v64, v21, v64
  v_mul_f32 v65, v21, v65
  v_mul_f32 v66, v21, v66
  v_mul_f32 v67, v21, v67
  v_mul_f32 v68, v21, v68
  v_mul_f32 v69, v21, v69
  v_mul_f32 v70, v21, v70
  v_mul_f32 v71, v21, v71
  s_waitcnt vmcnt(9)
  buffer_load_dwordx4 v[128:131], v3, s[28:31], s44 offen offset:2048 nt
  s_waitcnt vmcnt(9)
  buffer_load_dwordx4 v[132:135], v3, s[28:31], s44 offen offset:3072 nt
  s_waitcnt vmcnt(9)
  s_add_u32 s77, s44, 0x1000
  buffer_load_dwordx4 v[136:139], v3, s[28:31], s77 offen offset:0 nt
  s_waitcnt vmcnt(9)
  s_add_u32 s77, s44, 0x1000
  buffer_load_dwordx4 v[140:143], v3, s[28:31], s77 offen offset:1024 nt
  v_perm_b32 v72, v92, v88, s50
  v_perm_b32 v73, v100, v96, s50
  v_perm_b32 v74, v108, v104, s50
  v_perm_b32 v75, v116, v112, s50
  v_perm_b32 v76, v92, v88, s51
  v_perm_b32 v77, v100, v96, s51
  v_perm_b32 v78, v108, v104, s51
  v_perm_b32 v79, v116, v112, s51
  s_nop 1
  v_mfma_f32_16x16x32_bf16 v[40:43], v[72:75], v[16:19], v[40:43]
  v_mfma_f32_16x16x32_bf16 v[44:47], v[76:79], v[16:19], v[44:47]
  s_waitcnt vmcnt(9)
  s_add_u32 s77, s44, 0x1000
  buffer_load_dwordx4 v[144:147], v3, s[28:31], s77 offen offset:2048 nt
  v_perm_b32 v72, v93, v89, s50
  v_perm_b32 v73, v101, v97, s50
  v_perm_b32 v74, v109, v105, s50
  v_perm_b32 v75, v117, v113, s50
  v_perm_b32 v76, v93, v89, s51
  v_perm_b32 v77, v101, v97, s51
  v_perm_b32 v78, v109, v105, s51
  v_perm_b32 v79, v117, v113, s51
  s_nop 1
  v_mfma_f32_16x16x32_bf16 v[48:51], v[72:75], v[16:19], v[48:51]
  v_mfma_f32_16x16x32_bf16 v[52:55], v[76:79], v[16:19], v[52:55]
  s_waitcnt vmcnt(5)
  s_add_u32 s77, s44, 0x1000
  buffer_load_dwordx4 v[148:151], v3, s[28:31], s77 offen offset:3072 nt
  v_perm_b32 v72, v94, v90, s50
  v_perm_b32 v73, v102, v98, s50
  v_perm_b32 v74, v110, v106, s50
  v_perm_b32 v75, v118, v114, s50
  v_perm_b32 v76, v94, v90, s51
  v_perm_b32 v77, v102, v98, s51
  v_perm_b32 v78, v110, v106, s51
  v_perm_b32 v79, v118, v114, s51
  s_nop 1
  v_mfma_f32_16x16x32_bf16 v[56:59], v[72:75], v[16:19], v[56:59]
  v_mfma_f32_16x16x32_bf16 v[60:63], v[76:79], v[16:19], v[60:63]
  v_perm_b32 v72, v95, v91, s50
  v_perm_b32 v73, v103, v99, s50
  v_perm_b32 v74, v111, v107, s50
  v_perm_b32 v75, v119, v115, s50
  v_perm_b32 v76, v95, v91, s51
  v_perm_b32 v77, v103, v99, s51
  v_perm_b32 v78, v111, v107, s51
  v_perm_b32 v79, v119, v115, s51
  s_nop 1
  v_mfma_f32_16x16x32_bf16 v[64:67], v[72:75], v[16:19], v[64:67]
  v_mfma_f32_16x16x32_bf16 v[68:71], v[76:79], v[16:19], v[68:71]
  s_waitcnt vmcnt(5)
  buffer_load_dwordx4 v[88:91], v246, s[24:27], s45 offen offset:0 nt
  s_waitcnt vmcnt(5)
  buffer_load_dwordx4 v[92:95], v246, s[24:27], s45 offen offset:1024 nt
  s_nop 7
  v_mul_f32 v40, v22, v40
  v_mul_f32 v41, v22, v41
  v_mul_f32 v42, v22, v42
  v_mul_f32 v43, v22, v43
  v_mul_f32 v44, v22, v44
  v_mul_f32 v45, v22, v45
  v_mul_f32 v46, v22, v46
  v_mul_f32 v47, v22, v47
  v_mul_f32 v48, v22, v48
  v_mul_f32 v49, v22, v49
  v_mul_f32 v50, v22, v50
  v_mul_f32 v51, v22, v51
  v_mul_f32 v52, v22, v52
  v_mul_f32 v53, v22, v53
  v_mul_f32 v54, v22, v54
  v_mul_f32 v55, v22, v55
  v_mul_f32 v56, v22, v56
  v_mul_f32 v57, v22, v57
  v_mul_f32 v58, v22, v58
  v_mul_f32 v59, v22, v59
  v_mul_f32 v60, v22, v60
  v_mul_f32 v61, v22, v61
  v_mul_f32 v62, v22, v62
  v_mul_f32 v63, v22, v63
  v_mul_f32 v64, v22, v64
  v_mul_f32 v65, v22, v65
  v_mul_f32 v66, v22, v66
  v_mul_f32 v67, v22, v67
  v_mul_f32 v68, v22, v68
  v_mul_f32 v69, v22, v69
  v_mul_f32 v70, v22, v70
  v_mul_f32 v71, v22, v71
  s_cmp_lg_u32 s40, 1
  s_cbranch_scc1 L_hk1
  v_subrev_u32 v253, s55, v253
  v_cmp_ge_u32 vcc, s82, v253
  v_min_u32 v253, s82, v253
  s_bcnt1_i32_b32 s49, vcc_lo
  v_mov_b32 v250, v253
  s_nop 1
  v_add_u32_dpp v253, v253, v253 row_shr:1 row_mask:0xf bank_mask:0xf bound_ctrl:0
  v_max_u32_dpp v250, v250, v250 row_shr:1 row_mask:0xf bank_mask:0xf bound_ctrl:0
  s_nop 0
  v_add_u32_dpp v253, v253, v253 row_shr:2 row_mask:0xf bank_mask:0xf bound_ctrl:0
  v_max_u32_dpp v250, v250, v250 row_shr:2 row_mask:0xf bank_mask:0xf bound_ctrl:0
  s_nop 0
  v_add_u32_dpp v253, v253, v253 row_shr:4 row_mask:0xf bank_mask:0xf bound_ctrl:0
  v_max_u32_dpp v250, v250, v250 row_shr:4 row_mask:0xf bank_mask:0xf bound_ctrl:0
  s_nop 0
  v_add_u32_dpp v253, v253, v253 row_shr:8 row_mask:0xf bank_mask:0xf bound_ctrl:0
  v_max_u32_dpp v250, v250, v250 row_shr:8 row_mask:0xf bank_mask:0xf bound_ctrl:0
  s_cmp_ge_u32 s49, 8
  s_cselect_b32 s9, s9, 0
  s_cbranch_scc0 L_hk1
  v_readlane_b32 s48, v253, 15
  v_readlane_b32 s49, v253, 31
  s_add_u32 s48, s48, s49
  s_lshr_b32 s48, s48, 5
  v_readlane_b32 s87, v250, 15
  v_readlane_b32 s49, v250, 31
  s_max_u32 s87, s87, s49
  s_sub_u32 s87, s87, s48
  s_sub_i32 s87, s87, 110
  s_max_i32 s87, s87, 0
  s_lshr_b32 s87, s87, 0
  s_min_u32 s87, s87, 60
  s_cmp_ge_u32 s46, 14
  s_cselect_b32 s87, s87, 0
  s_sub_u32 s49, s48, s9
  s_min_u32 s49, s49, 280
  s_max_u32 s49, s49, 200
  s_sub_i32 s49, s49, s81
  s_ashr_i32 s49, s49, 2
  s_cmp_eq_u32 s9, 0
  s_cselect_b32 s49, 0, s49
  s_add_u32 s49, s49, s81
  s_cmp_eq_u32 s81, 0
  s_cselect_b32 s49, 226, s49
  s_mov_b32 s9, s48
  v_mov_b32 v251, s49
  s_sub_u32 s80, s46, 2
  s_mul_i32 s49, s49, s80
  s_sub_u32 s48, s48, s49
  s_add_u32 s48, s48, s87
  v_mov_b32 v250, s48
  s_mov_b64 exec, 1
  ds_write_b64 v248, v[250:251] offset:24
  s_mov_b64 exec, -1
L_hk1:
  s_waitcnt vmcnt(5)
  buffer_load_dwordx4 v[96:99], v246, s[24:27], s45 offen offset:2048 nt
  s_waitcnt vmcnt(5)
  buffer_load_dwordx4 v[100:103], v246, s[24:27], s45 offen offset:3072 nt
  s_waitcnt vmcnt(5)
  s_add_u32 s77, s45, 0x1000
  buffer_load_dwordx4 v[104:107], v246, s[24:27], s77 offen offset:0 nt
  s_waitcnt vmcnt(5)
  s_add_u32 s77, s45, 0x1000
  buffer_load_dwordx4 v[108:111], v246, s[24:27], s77 offen offset:1024 nt
  v_perm_b32 v72, v124, v120, s50
  v_perm_b32 v73, v132, v128, s50
  v_perm_b32 v74, v140, v136, s50
  v_perm_b32 v75, v148, v144, s50
  v_perm_b32 v76, v124, v120, s51
  v_perm_b32 v77, v132, v128, s51
  v_perm_b32 v78, v140, v136, s51
  v_perm_b32 v79, v148, v144, s51
  s_nop 1
  v_mfma_f32_16x16x32_bf16 v[40:43], v[72:75], v[8:11], v[40:43]
  v_mfma_f32_16x16x32_bf16 v[44:47], v[76:79], v[8:11], v[44:47]
  s_waitcnt vmcnt(5)
  s_add_u32 s77, s45, 0x1000
  buffer_load_dwordx4 v[112:115], v246, s[24:27], s77 offen offset:2048 nt
  v_perm_b32 v72, v125, v121, s50
  v_perm_b32 v73, v133, v129, s50
  v_perm_b32 v74, v141, v137, s50
  v_perm_b32 v75, v149, v145, s50
  v_perm_b32 v76, v125, v121, s51
  v_perm_b32 v77, v133, v129, s51
  v_perm_b32 v78, v141, v137, s51
  v_perm_b32 v79, v149, v145, s51
  s_nop 1
  v_mfma_f32_16x16x32_bf16 v[48:51], v[72:75], v[8:11], v[48:51]
  v_mfma_f32_16x16x32_bf16 v[52:55], v[76:79], v[8:11], v[52:55]
  s_waitcnt vmcnt(5)
  s_add_u32 s77, s45, 0x1000
  buffer_load_dwordx4 v[116:119], v246, s[24:27], s77 offen offset:3072 nt
  v_perm_b32 v72, v126, v122, s50
  v_perm_b32 v73, v134, v130, s50
  v_perm_b32 v74, v142, v138, s50
  v_perm_b32 v75, v150, v146, s50
  v_perm_b32 v76, v126, v122, s51
  v_perm_b32 v77, v134, v130, s51
  v_perm_b32 v78, v142, v138, s51
  v_perm_b32 v79, v150, v146, s51
  s_nop 1
  v_mfma_f32_16x16x32_bf16 v[56:59], v[72:75], v[8:11], v[56:59]
  v_mfma_f32_16x16x32_bf16 v[60:63], v[76:79], v[8:11], v[60:63]
  v_perm_b32 v72, v127, v123, s50
  v_perm_b32 v73, v135, v131, s50
  v_perm_b32 v74, v143, v139, s50
  v_perm_b32 v75, v151, v147, s50
  v_perm_b32 v76, v127, v123, s51
  v_perm_b32 v77, v135, v131, s51
  v_perm_b32 v78, v143, v139, s51
  v_perm_b32 v79, v151, v147, s51
  s_nop 1
  v_mfma_f32_16x16x32_bf16 v[64:67], v[72:75], v[8:11], v[64:67]
  v_mfma_f32_16x16x32_bf16 v[68:71], v[76:79], v[8:11], v[68:71]
  s_or_b32 s44, s45, 0x4000
  s_mov_b64 s[28:29], s[24:25]
  s_and_b32 s48, s46, 7
  s_cmp_eq_u32 s48, 7
  s_cselect_b32 s48, -7, 1
  s_mulk_i32 s48, 1280
  v_add_u32 v244, s48, v244
  v_add_u32 v245, s48, v245
  s_add_u32 s10, s10, s11
  s_mov_b32 s11, 0
  s_add_u32 s46, s46, 1
  s_cmp_lt_u32 s46, 31
  s_cbranch_scc1 L_loop
  s_branch L_last
L_b0:
  s_waitcnt vmcnt(4)
  buffer_load_dwordx4 v[120:123], v3, s[28:31], s44 offen offset:0 nt
  s_sub_u32 s48, s100, s10
  v_mov_b32 v226, s48
  s_add_u32 s48, s8, s7
  s_mov_b32 exec_hi, 0
  buffer_load_dword v253, v227, s[32:35], s8 offen sc1
  s_mov_b32 exec_lo, 1
  buffer_store_dword v226, off, s[12:15], s48 sc1
  s_mov_b64 exec, -1
  s_add_u32 s8, s8, 0x1100
  s_mov_b32 s47, 0
  s_branch L_snip
L_ret0:
  s_or_b32 s45, s44, 0x17f00
  s_add_u32 s45, s45, 0x100
  s_and_b32 s45, s45, 0x68000
  s_or_b32 s45, s45, s78
  ds_read_b32 v21, v245
  ds_read_b128 v[16:19], v244
  ds_read_b32 v22, v245 offset:640
  ds_read_b128 v[8:11], v244 offset:640
  s_waitcnt vmcnt(8)
  buffer_load_dwordx4 v[124:127], v3, s[28:31], s44 offen offset:1024 nt
  s_waitcnt lgkmcnt(0)
  s_nop 7
  v_mul_f32 v40, v21, v40
  v_mul_f32 v41, v21, v41
  v_mul_f32 v42, v21, v42
  v_mul_f32 v43, v21, v43
  v_mul_f32 v44, v21, v44
  v_mul_f32 v45, v21, v45
  v_mul_f32 v46, v21, v46
  v_mul_f32 v47, v21, v47
  v_mul_f32 v48, v21, v48
  v_mul_f32 v49, v21, v49
  v_mul_f32 v50, v21, v50
  v_mul_f32 v51, v21, v51
  v_mul_f32 v52, v21, v52
  v_mul_f32 v53, v21, v53
  v_mul_f32 v54, v21, v54
  v_mul_f32 v55, v21, v55
  v_mul_f32 v56, v21, v56
  v_mul_f32 v57, v21, v57
  v_mul_f32 v58, v21, v58
  v_mul_f32 v59, v21, v59
  v_mul_f32 v60, v21, v60
  v_mul_f32 v61, v21, v61
  v_mul_f32 v62, v21, v62
  v_mul_f32 v63, v21, v63
  v_mul_f32 v64, v21, v64
  v_mul_f32 v65, v21, v65
  v_mul_f32 v66, v21, v66
  v_mul_f32 v67, v21, v67
  v_mul_f32 v68, v21, v68
  v_mul_f32 v69, v21, v69
  v_mul_f32 v70, v21, v70
  v_mul_f32 v71, v21, v71
  s_waitcnt vmcnt(8)
  buffer_load_dwordx4 v[128:131], v3, s[28:31], s44 offen offset:2048 nt
  s_waitcnt vmcnt(8)
  buffer_load_dwordx4 v[132:135], v3, s[28:31], s44 offen offset:3072 nt
  s_waitcnt vmcnt(8)
  s_add_u32 s77, s44, 0x1000
  buffer_load_dwordx4 v[136:139], v3, s[28:31], s77 offen offset:0 nt
  v_perm_b32 v72, v92, v88, s50
  v_perm_b32 v73, v100, v96, s50
  v_perm_b32 v74, v108, v104, s50
  v_perm_b32 v75, v116, v112, s50
  v_perm_b32 v76, v92, v88, s51
  v_perm_b32 v77, v100, v96, s51
  v_perm_b32 v78, v108, v104, s51
  v_perm_b32 v79, v116, v112, s51
  s_nop 1
  v_mfma_f32_16x16x32_bf16 v[40:43], v[72:75], v[16:19], v[40:43]
  v_mfma_f32_16x16x32_bf16 v[44:47], v[76:79], v[16:19], v[44:47]
  s_waitcnt vmcnt(8)
  s_add_u32 s77, s44, 0x1000
  buffer_load_dwordx4 v[140:143], v3, s[28:31], s77 offen offset:1024 nt
  v_perm_b32 v72, v93, v89, s50
  v_perm_b32 v73, v101, v97, s50
  v_perm_b32 v74, v109, v105, s50
  v_perm_b32 v75, v117, v113, s50
  v_perm_b32 v76, v93, v89, s51
  v_perm_b32 v77, v101, v97, s51
  v_perm_b32 v78, v109, v105, s51
  v_perm_b32 v79, v117, v113, s51
  s_nop 1
  v_mfma_f32_16x16x32_bf16 v[48:51], v[72:75], v[16:19], v[48:51]
  v_mfma_f32_16x16x32_bf16 v[52:55], v[76:79], v[16:19], v[52:55]
  s_waitcnt vmcnt(4)
  s_add_u32 s77, s44, 0x1000
  buffer_load_dwordx4 v[144:147], v3, s[28:31], s77 offen offset:2048 nt
  v_perm_b32 v72, v94, v90, s50
  v_perm_b32 v73, v102, v98, s50
  v_perm_b32 v74, v110, v106, s50
  v_perm_b32 v75, v118, v114, s50
  v_perm_b32 v76, v94, v90, s51
  v_perm_b32 v77, v102, v98, s51
  v_perm_b32 v78, v110, v106, s51
  v_perm_b32 v79, v118, v114, s51
  s_nop 1
  v_mfma_f32_16x16x32_bf16 v[56:59], v[72:75], v[16:19], v[56:59]
  v_mfma_f32_16x16x32_bf16 v[60:63], v[76:79], v[16:19], v[60:63]
  s_waitcnt vmcnt(4)
  s_add_u32 s77, s44, 0x1000
  buffer_load_dwordx4 v[148:151], v3, s[28:31], s77 offen offset:3072 nt
  v_perm_b32 v72, v95, v91, s50
  v_perm_b32 v73, v103, v99, s50
  v_perm_b32 v74, v111, v107, s50
  v_perm_b32 v75, v119, v115, s50
  v_perm_b32 v76, v95, v91, s51
  v_perm_b32 v77, v103, v99, s51
  v_perm_b32 v78, v111, v107, s51
  v_perm_b32 v79, v119, v115, s51
  s_nop 1
  v_mfma_f32_16x16x32_bf16 v[64:67], v[72:75], v[16:19], v[64:67]
  v_mfma_f32_16x16x32_bf16 v[68:71], v[76:79], v[16:19], v[68:71]
  s_waitcnt vmcnt(4)
  buffer_load_dwordx4 v[88:91], v246, s[24:27], s45 offen offset:0 nt
  s_waitcnt vmcnt(4)
  buffer_load_dwordx4 v[92:95], v246, s[24:27], s45 offen offset:1024 nt
  s_nop 7
  v_mul_f32 v40, v22, v40
  v_mul_f32 v41, v22, v41
  v_mul_f32 v42, v22, v42
  v_mul_f32 v43, v22, v43
  v_mul_f32 v44, v22, v44
  v_mul_f32 v45, v22, v45
  v_mul_f32 v46, v22, v46
  v_mul_f32 v47, v22, v47
  v_mul_f32 v48, v22, v48
  v_mul_f32 v49, v22, v49
  v_mul_f32 v50, v22, v50
  v_mul_f32 v51, v22, v51
  v_mul_f32 v52, v22, v52
  v_mul_f32 v53, v22, v53
  v_mul_f32 v54, v22, v54
  v_mul_f32 v55, v22, v55
  v_mul_f32 v56, v22, v56
  v_mul_f32 v57, v22, v57
  v_mul_f32 v58, v22, v58
  v_mul_f32 v59, v22, v59
  v_mul_f32 v60, v22, v60
  v_mul_f32 v61, v22, v61
  v_mul_f32 v62, v22, v62
  v_mul_f32 v63, v22, v63
  v_mul_f32 v64, v22, v64
  v_mul_f32 v65, v22, v65
  v_mul_f32 v66, v22, v66
  v_mul_f32 v67, v22, v67
  v_mul_f32 v68, v22, v68
  v_mul_f32 v69, v22, v69
  v_mul_f32 v70, v22, v70
  v_mul_f32 v71, v22, v71
  s_cmp_lg_u32 s40, 1
  s_cbranch_scc1 L_hk0
  v_subrev_u32 v253, s55, v253
  v_cmp_ge_u32 vcc, s82, v253
  v_min_u32 v253, s82, v253
  s_bcnt1_i32_b32 s49, vcc_lo
  v_mov_b32 v250, v253
  s_nop 1
  v_add_u32_dpp v253, v253, v253 row_shr:1 row_mask:0xf bank_mask:0xf bound_ctrl:0
  v_max_u32_dpp v250, v250, v250 row_shr:1 row_mask:0xf bank_mask:0xf bound_ctrl:0
  s_nop 0
  v_add_u32_dpp v253, v253, v253 row_shr:2 row_mask:0xf bank_mask:0xf bound_ctrl:0
  v_max_u32_dpp v250, v250, v250 row_shr:2 row_mask:0xf bank_mask:0xf bound_ctrl:0
  s_nop 0
  v_add_u32_dpp v253, v253, v253 row_shr:4 row_mask:0xf bank_mask:0xf bound_ctrl:0
  v_max_u32_dpp v250, v250, v250 row_shr:4 row_mask:0xf bank_mask:0xf bound_ctrl:0
  s_nop 0
  v_add_u32_dpp v253, v253, v253 row_shr:8 row_mask:0xf bank_mask:0xf bound_ctrl:0
  v_max_u32_dpp v250, v250, v250 row_shr:8 row_mask:0xf bank_mask:0xf bound_ctrl:0
  s_cmp_ge_u32 s49, 8
  s_cselect_b32 s9, s9, 0
  s_cbranch_scc0 L_hk0
  v_readlane_b32 s48, v253, 15
  v_readlane_b32 s49, v253, 31
  s_add_u32 s48, s48, s49
  s_lshr_b32 s48, s48, 5
  v_readlane_b32 s87, v250, 15
  v_readlane_b32 s49, v250, 31
  s_max_u32 s87, s87, s49
  s_sub_u32 s87, s87, s48
  s_sub_i32 s87, s87, 110
  s_max_i32 s87, s87, 0
  s_lshr_b32 s87, s87, 0
  s_min_u32 s87, s87, 60
  s_cmp_ge_u32 s46, 14
  s_cselect_b32 s87, s87, 0
  s_sub_u32 s49, s48, s9
  s_min_u32 s49, s49, 280
  s_max_u32 s49, s49, 200
  s_sub_i32 s49, s49, s81
  s_ashr_i32 s49, s49, 2
  s_cmp_eq_u32 s9, 0
  s_cselect_b32 s49, 0, s49
  s_add_u32 s49, s49, s81
  s_cmp_eq_u32 s81, 0
  s_cselect_b32 s49, 226, s49
  s_mov_b32 s9, s48
  v_mov_b32 v251, s49
  s_sub_u32 s80, s46, 2
  s_mul_i32 s49, s49, s80
  s_sub_u32 s48, s48, s49
  s_add_u32 s48, s48, s87
  v_mov_b32 v250, s48
  s_mov_b64 exec, 1
  ds_write_b64 v248, v[250:251] offset:24
  s_mov_b64 exec, -1
L_hk0:
  s_waitcnt vmcnt(4)
  buffer_load_dwordx4 v[96:99], v246, s[24:27], s45 offen offset:2048 nt
  s_waitcnt vmcnt(4)
  buffer_load_dwordx4 v[100:103], v246, s[24:27], s45 offen offset:3072 nt
  s_waitcnt vmcnt(4)
  s_add_u32 s77, s45, 0x1000
  buffer_load_dwordx4 v[104:107], v246, s[24:27], s77 offen offset:0 nt
  v_perm_b32 v72, v124, v120, s50
  v_perm_b32 v73, v132, v128, s50
  v_perm_b32 v74, v140, v136, s50
  v_perm_b32 v75, v148, v144, s50
  v_perm_b32 v76, v124, v120, s51
  v_perm_b32 v77, v132, v128, s51
  v_perm_b32 v78, v140, v136, s51
  v_perm_b32 v79, v148, v144, s51
  s_nop 1
  v_mfma_f32_16x16x32_bf16 v[40:43], v[72:75], v[8:11], v[40:43]
  v_mfma_f32_16x16x32_bf16 v[44:47], v[76:79], v[8:11], v[44:47]
  s_waitcnt vmcnt(4)
  s_add_u32 s77, s45, 0x1000
  buffer_load_dwordx4 v[108:111], v246, s[24:27], s77 offen offset:1024 nt
  v_perm_b32 v72, v125, v121, s50
  v_perm_b32 v73, v133, v129, s50
  v_perm_b32 v74, v141, v137, s50
  v_perm_b32 v75, v149, v145, s50
  v_perm_b32 v76, v125, v121, s51
  v_perm_b32 v77, v133, v129, s51
  v_perm_b32 v78, v141, v137, s51
  v_perm_b32 v79, v149, v145, s51
  s_nop 1
  v_mfma_f32_16x16x32_bf16 v[48:51], v[72:75], v[8:11], v[48:51]
  v_mfma_f32_16x16x32_bf16 v[52:55], v[76:79], v[8:11], v[52:55]
  s_waitcnt vmcnt(4)
  s_add_u32 s77, s45, 0x1000
  buffer_load_dwordx4 v[112:115], v246, s[24:27], s77 offen offset:2048 nt
  v_perm_b32 v72, v126, v122, s50
  v_perm_b32 v73, v134, v130, s50
  v_perm_b32 v74, v142, v138, s50
  v_perm_b32 v75, v150, v146, s50
  v_perm_b32 v76, v126, v122, s51
  v_perm_b32 v77, v134, v130, s51
  v_perm_b32 v78, v142, v138, s51
  v_perm_b32 v79, v150, v146, s51
  s_nop 1
  v_mfma_f32_16x16x32_bf16 v[56:59], v[72:75], v[8:11], v[56:59]
  v_mfma_f32_16x16x32_bf16 v[60:63], v[76:79], v[8:11], v[60:63]
  s_waitcnt vmcnt(4)
  s_add_u32 s77, s45, 0x1000
  buffer_load_dwordx4 v[116:119], v246, s[24:27], s77 offen offset:3072 nt
  v_perm_b32 v72, v127, v123, s50
  v_perm_b32 v73, v135, v131, s50
  v_perm_b32 v74, v143, v139, s50
  v_perm_b32 v75, v151, v147, s50
  v_perm_b32 v76, v127, v123, s51
  v_perm_b32 v77, v135, v131, s51
  v_perm_b32 v78, v143, v139, s51
  v_perm_b32 v79, v151, v147, s51
  s_nop 1
  v_mfma_f32_16x16x32_bf16 v[64:67], v[72:75], v[8:11], v[64:67]
  v_mfma_f32_16x16x32_bf16 v[68:71], v[76:79], v[8:11], v[68:71]
  s_or_b32 s44, s45, 0x4000
  s_mov_b64 s[28:29], s[24:25]
  s_and_b32 s48, s46, 7
  s_cmp_eq_u32 s48, 7
  s_cselect_b32 s48, -7, 1
  s_mulk_i32 s48, 1280
  v_add_u32 v244, s48, v244
  v_add_u32 v245, s48, v245
  s_add_u32 s10, s10, s11
  s_mov_b32 s11, 0
  s_add_u32 s46, s46, 1
  s_cmp_lt_u32 s46, 31
  s_cbranch_scc1 L_loop
  s_branch L_last
L_b3:
  s_waitcnt vmcnt(3)
  buffer_load_dwordx4 v[120:123], v3, s[28:31], s44 offen offset:0 nt
  s_sub_u32 s48, s100, s10
  v_mov_b32 v226, s48
  s_add_u32 s48, s8, s7
  s_mov_b32 exec_hi, 0
  buffer_load_dword v253, v227, s[32:35], s8 offen sc1
  s_mov_b32 exec_lo, 1
  buffer_store_dword v226, off, s[12:15], s48 sc1
  s_mov_b64 exec, -1
  s_add_u32 s8, s8, 0x1100
  s_mov_b32 s47, 3
  s_branch L_snip
L_ret3:
  s_or_b32 s45, s44, 0x17f00
  s_add_u32 s45, s45, 0x100
  s_and_b32 s45, s45, 0x68000
  s_or_b32 s45, s45, s78
  ds_read_b32 v21, v245
  ds_read_b128 v[16:19], v244
  ds_read_b32 v22, v245 offset:640
  ds_read_b128 v[8:11], v244 offset:640
  s_waitcnt vmcnt(7)
  buffer_load_dwordx4 v[124:127], v3, s[28:31], s44 offen offset:1024 nt
  s_waitcnt lgkmcnt(0)
  s_nop 7
  v_mul_f32 v40, v21, v40
  v_mul_f32 v41, v21, v41
  v_mul_f32 v42, v21, v42
  v_mul_f32 v43, v21, v43
  v_mul_f32 v44, v21, v44
  v_mul_f32 v45, v21, v45
  v_mul_f32 v46, v21, v46
  v_mul_f32 v47, v21, v47
  v_mul_f32 v48, v21, v48
  v_mul_f32 v49, v21, v49
  v_mul_f32 v50, v21, v50
  v_mul_f32 v51, v21, v51
  v_mul_f32 v52, v21, v52
  v_mul_f32 v53, v21, v53
  v_mul_f32 v54, v21, v54
  v_mul_f32 v55, v21, v55
  v_mul_f32 v56, v21, v56
  v_mul_f32 v57, v21, v57
  v_mul_f32 v58, v21, v58
  v_mul_f32 v59, v21, v59
  v_mul_f32 v60, v21, v60
  v_mul_f32 v61, v21, v61
  v_mul_f32 v62, v21, v62
  v_mul_f32 v63, v21, v63
  v_mul_f32 v64, v21, v64
  v_mul_f32 v65, v21, v65
  v_mul_f32 v66, v21, v66
  v_mul_f32 v67, v21, v67
  v_mul_f32 v68, v21, v68
  v_mul_f32 v69, v21, v69
  v_mul_f32 v70, v21, v70
  v_mul_f32 v71, v21, v71
  s_waitcnt vmcnt(7)
  buffer_load_dwordx4 v[128:131], v3, s[28:31], s44 offen offset:2048 nt
  s_waitcnt vmcnt(7)
  buffer_load_dwordx4 v[132:135], v3, s[28:31], s44 offen offset:3072 nt
  v_perm_b32 v72, v92, v88, s50
  v_perm_b32 v73, v100, v96, s50
  v_perm_b32 v74, v108, v104, s50
  v_perm_b32 v75, v116, v112, s50
  v_perm_b32 v76, v92, v88, s51
  v_perm_b32 v77, v100, v96, s51
  v_perm_b32 v78, v108, v104, s51
  v_perm_b32 v79, v116, v112, s51
  s_nop 1
  v_mfma_f32_16x16x32_bf16 v[40:43], v[72:75], v[16:19], v[40:43]
  v_mfma_f32_16x16x32_bf16 v[44:47], v[76:79], v[16:19], v[44:47]
  s_waitcnt vmcnt(7)
  s_add_u32 s77, s44, 0x1000
  buffer_load_dwordx4 v[136:139], v3, s[28:31], s77 offen offset:0 nt
  v_perm_b32 v72, v93, v89, s50
  v_perm_b32 v73, v101, v97, s50
  v_perm_b32 v74, v109, v105, s50
  v_perm_b32 v75, v117, v113, s50
  v_perm_b32 v76, v93, v89, s51
  v_perm_b32 v77, v101, v97, s51
  v_perm_b32 v78, v109, v105, s51
  v_perm_b32 v79, v117, v113, s51
  s_nop 1
  v_mfma_f32_16x16x32_bf16 v[48:51], v[72:75], v[16:19], v[48:51]
  v_mfma_f32_16x16x32_bf16 v[52:55], v[76:79], v[16:19], v[52:55]
  s_waitcnt vmcnt(3)
  s_add_u32 s77, s44, 0x1000
  buffer_load_dwordx4 v[140:143], v3, s[28:31], s77 offen offset:1024 nt
  v_perm_b32 v72, v94, v90, s50
  v_perm_b32 v73, v102, v98, s50
  v_perm_b32 v74, v110, v106, s50
  v_perm_b32 v75, v118, v114, s50
  v_perm_b32 v76, v94, v90, s51
  v_perm_b32 v77, v102, v98, s51
  v_perm_b32 v78, v110, v106, s51
  v_perm_b32 v79, v118, v114, s51
  s_nop 1
  v_mfma_f32_16x16x32_bf16 v[56:59], v[72:75], v[16:19], v[56:59]
  v_mfma_f32_16x16x32_bf16 v[60:63], v[76:79], v[16:19], v[60:63]
  s_waitcnt vmcnt(3)
  s_add_u32 s77, s44, 0x1000
  buffer_load_dwordx4 v[144:147], v3, s[28:31], s77 offen offset:2048 nt
  v_perm_b32 v72, v95, v91, s50
  v_perm_b32 v73, v103, v99, s50
  v_perm_b32 v74, v111, v107, s50
  v_perm_b32 v75, v119, v115, s50
  v_perm_b32 v76, v95, v91, s51
  v_perm_b32 v77, v103, v99, s51
  v_perm_b32 v78, v111, v107, s51
  v_perm_b32 v79, v119, v115, s51
  s_nop 1
  v_mfma_f32_16x16x32_bf16 v[64:67], v[72:75], v[16:19], v[64:67]
  v_mfma_f32_16x16x32_bf16 v[68:71], v[76:79], v[16:19], v[68:71]
  s_waitcnt vmcnt(3)
  s_add_u32 s77, s44, 0x1000
  buffer_load_dwordx4 v[148:151], v3, s[28:31], s77 offen offset:3072 nt
  s_waitcnt vmcnt(3)
  buffer_load_dwordx4 v[88:91], v246, s[24:27], s45 offen offset:0 nt
  s_waitcnt vmcnt(3)
  buffer_load_dwordx4 v[92:95], v246, s[24:27], s45 offen offset:1024 nt
  s_nop 7
  v_mul_f32 v40, v22, v40
  v_mul_f32 v41, v22, v41
  v_mul_f32 v42, v22, v42
  v_mul_f32 v43, v22, v43
  v_mul_f32 v44, v22, v44
  v_mul_f32 v45, v22, v45
  v_mul_f32 v46, v22, v46
  v_mul_f32 v47, v22, v47
  v_mul_f32 v48, v22, v48
  v_mul_f32 v49, v22, v49
  v_mul_f32 v50, v22, v50
  v_mul_f32 v51, v22, v51
  v_mul_f32 v52, v22, v52
  v_mul_f32 v53, v22, v53
  v_mul_f32 v54, v22, v54
  v_mul_f32 v55, v22, v55
  v_mul_f32 v56, v22, v56
  v_mul_f32 v57, v22, v57
  v_mul_f32 v58, v22, v58
  v_mul_f32 v59, v22, v59
  v_mul_f32 v60, v22, v60
  v_mul_f32 v61, v22, v61
  v_mul_f32 v62, v22, v62
  v_mul_f32 v63, v22, v63
  v_mul_f32 v64, v22, v64
  v_mul_f32 v65, v22, v65
  v_mul_f32 v66, v22, v66
  v_mul_f32 v67, v22, v67
  v_mul_f32 v68, v22, v68
  v_mul_f32 v69, v22, v69
  v_mul_f32 v70, v22, v70
  v_mul_f32 v71, v22, v71
  s_cmp_lg_u32 s40, 1
  s_cbranch_scc1 L_hk3
  v_subrev_u32 v253, s55, v253
  v_cmp_ge_u32 vcc, s82, v253
  v_min_u32 v253, s82, v253
  s_bcnt1_i32_b32 s49, vcc_lo
  v_mov_b32 v250, v253
  s_nop 1
  v_add_u32_dpp v253, v253, v253 row_shr:1 row_mask:0xf bank_mask:0xf bound_ctrl:0
  v_max_u32_dpp v250, v250, v250 row_shr:1 row_mask:0xf bank_mask:0xf bound_ctrl:0
  s_nop 0
  v_add_u32_dpp v253, v253, v253 row_shr:2 row_mask:0xf bank_mask:0xf bound_ctrl:0
  v_max_u32_dpp v250, v250, v250 row_shr:2 row_mask:0xf bank_mask:0xf bound_ctrl:0
  s_nop 0
  v_add_u32_dpp v253, v253, v253 row_shr:4 row_mask:0xf bank_mask:0xf bound_ctrl:0
  v_max_u32_dpp v250, v250, v250 row_shr:4 row_mask:0xf bank_mask:0xf bound_ctrl:0
  s_nop 0
  v_add_u32_dpp v253, v253, v253 row_shr:8 row_mask:0xf bank_mask:0xf bound_ctrl:0
  v_max_u32_dpp v250, v250, v250 row_shr:8 row_mask:0xf bank_mask:0xf bound_ctrl:0
  s_cmp_ge_u32 s49, 8
  s_cselect_b32 s9, s9, 0
  s_cbranch_scc0 L_hk3
  v_readlane_b32 s48, v253, 15
  v_readlane_b32 s49, v253, 31
  s_add_u32 s48, s48, s49
  s_lshr_b32 s48, s48, 5
  v_readlane_b32 s87, v250, 15
  v_readlane_b32 s49, v250, 31
  s_max_u32 s87, s87, s49
  s_sub_u32 s87, s87, s48
  s_sub_i32 s87, s87, 110
  s_max_i32 s87, s87, 0
  s_lshr_b32 s87, s87, 0
  s_min_u32 s87, s87, 60
  s_cmp_ge_u32 s46, 14
  s_cselect_b32 s87, s87, 0
  s_sub_u32 s49, s48, s9
  s_min_u32 s49, s49, 280
  s_max_u32 s49, s49, 200
  s_sub_i32 s49, s49, s81
  s_ashr_i32 s49, s49, 2
  s_cmp_eq_u32 s9, 0
  s_cselect_b32 s49, 0, s49
  s_add_u32 s49, s49, s81
  s_cmp_eq_u32 s81, 0
  s_cselect_b32 s49, 226, s49
  s_mov_b32 s9, s48
  v_mov_b32 v251, s49
  s_sub_u32 s80, s46, 2
  s_mul_i32 s49, s49, s80
  s_sub_u32 s48, s48, s49
  s_add_u32 s48, s48, s87
  v_mov_b32 v250, s48
  s_mov_b64 exec, 1
  ds_write_b64 v248, v[250:251] offset:24
  s_mov_b64 exec, -1
L_hk3:
  s_waitcnt vmcnt(3)
  buffer_load_dwordx4 v[96:99], v246, s[24:27], s45 offen offset:2048 nt
  s_waitcnt vmcnt(3)
  buffer_load_dwordx4 v[100:103], v246, s[24:27], s45 offen offset:3072 nt
  v_perm_b32 v72, v124, v120, s50
  v_perm_b32 v73, v132, v128, s50
  v_perm_b32 v74, v140, v136, s50
  v_perm_b32 v75, v148, v144, s50
  v_perm_b32 v76, v124, v120, s51
  v_perm_b32 v77, v132, v128, s51
  v_perm_b32 v78, v140, v136, s51
  v_perm_b32 v79, v148, v144, s51
  s_nop 1
  v_mfma_f32_16x16x32_bf16 v[40:43], v[72:75], v[8:11], v[40:43]
  v_mfma_f32_16x16x32_bf16 v[44:47], v[76:79], v[8:11], v[44:47]
  s_waitcnt vmcnt(3)
  s_add_u32 s77, s45, 0x1000
  buffer_load_dwordx4 v[104:107], v246, s[24:27], s77 offen offset:0 nt
  v_perm_b32 v72, v125, v121, s50
  v_perm_b32 v73, v133, v129, s50
  v_perm_b32 v74, v141, v137, s50
  v_perm_b32 v75, v149, v145, s50
  v_perm_b32 v76, v125, v121, s51
  v_perm_b32 v77, v133, v129, s51
  v_perm_b32 v78, v141, v137, s51
  v_perm_b32 v79, v149, v145, s51
  s_nop 1
  v_mfma_f32_16x16x32_bf16 v[48:51], v[72:75], v[8:11], v[48:51]
  v_mfma_f32_16x16x32_bf16 v[52:55], v[76:79], v[8:11], v[52:55]
  s_waitcnt vmcnt(3)
  s_add_u32 s77, s45, 0x1000
  buffer_load_dwordx4 v[108:111], v246, s[24:27], s77 offen offset:1024 nt
  v_perm_b32 v72, v126, v122, s50
  v_perm_b32 v73, v134, v130, s50
  v_perm_b32 v74, v142, v138, s50
  v_perm_b32 v75, v150, v146, s50
  v_perm_b32 v76, v126, v122, s51
  v_perm_b32 v77, v134, v130, s51
  v_perm_b32 v78, v142, v138, s51
  v_perm_b32 v79, v150, v146, s51
  s_nop 1
  v_mfma_f32_16x16x32_bf16 v[56:59], v[72:75], v[8:11], v[56:59]
  v_mfma_f32_16x16x32_bf16 v[60:63], v[76:79], v[8:11], v[60:63]
  s_waitcnt vmcnt(3)
  s_add_u32 s77, s45, 0x1000
  buffer_load_dwordx4 v[112:115], v246, s[24:27], s77 offen offset:2048 nt
  v_perm_b32 v72, v127, v123, s50
  v_perm_b32 v73, v135, v131, s50
  v_perm_b32 v74, v143, v139, s50
  v_perm_b32 v75, v151, v147, s50
  v_perm_b32 v76, v127, v123, s51
  v_perm_b32 v77, v135, v131, s51
  v_perm_b32 v78, v143, v139, s51
  v_perm_b32 v79, v151, v147, s51
  s_nop 1
  v_mfma_f32_16x16x32_bf16 v[64:67], v[72:75], v[8:11], v[64:67]
  v_mfma_f32_16x16x32_bf16 v[68:71], v[76:79], v[8:11], v[68:71]
  s_waitcnt vmcnt(3)
  s_add_u32 s77, s45, 0x1000
  buffer_load_dwordx4 v[116:119], v246, s[24:27], s77 offen offset:3072 nt
  s_or_b32 s44, s45, 0x4000
  s_mov_b64 s[28:29], s[24:25]
  s_and_b32 s48, s46, 7
  s_cmp_eq_u32 s48, 7
  s_cselect_b32 s48, -7, 1
  s_mulk_i32 s48, 1280
  v_add_u32 v244, s48, v244
  v_add_u32 v245, s48, v245
  s_add_u32 s10, s10, s11
  s_mov_b32 s11, 0
  s_add_u32 s46, s46, 1
  s_cmp_lt_u32 s46, 31
  s_cbranch_scc1 L_loop
  s_branch L_last
L_b4:
  s_waitcnt vmcnt(7)
  buffer_load_dwordx4 v[120:123], v3, s[28:31], s44 offen offset:0 nt
  s_sub_u32 s48, s100, s10
  v_mov_b32 v226, s48
  s_add_u32 s48, s8, s7
  s_mov_b32 exec_hi, 0
  buffer_load_dword v253, v227, s[32:35], s8 offen sc1
  s_mov_b32 exec_lo, 1
  buffer_store_dword v226, off, s[12:15], s48 sc1
  s_mov_b64 exec, -1
  s_add_u32 s8, s8, 0x1100
  s_mov_b32 s47, 4
  s_branch L_snip
L_ret4:
  s_or_b32 s45, s44, 0x17f00
  s_add_u32 s45, s45, 0x100
  s_and_b32 s45, s45, 0x68000
  s_or_b32 s45, s45, s78
  ds_read_b32 v21, v245
  ds_read_b128 v[16:19], v244
  ds_read_b32 v22, v245 offset:640
  ds_read_b128 v[8:11], v244 offset:640
  s_waitcnt vmcnt(11)
  buffer_load_dwordx4 v[124:127], v3, s[28:31], s44 offen offset:1024 nt
  s_waitcnt lgkmcnt(0)
  s_nop 7
  v_mul_f32 v40, v21, v40
  v_mul_f32 v41, v21, v41
  v_mul_f32 v42, v21, v42
  v_mul_f32 v43, v21, v43
  v_mul_f32 v44, v21, v44
  v_mul_f32 v45, v21, v45
  v_mul_f32 v46, v21, v46
  v_mul_f32 v47, v21, v47
  v_mul_f32 v48, v21, v48
  v_mul_f32 v49, v21, v49
  v_mul_f32 v50, v21, v50
  v_mul_f32 v51, v21, v51
  v_mul_f32 v52, v21, v52
  v_mul_f32 v53, v21, v53
  v_mul_f32 v54, v21, v54
  v_mul_f32 v55, v21, v55
  v_mul_f32 v56, v21, v56
  v_mul_f32 v57, v21, v57
  v_mul_f32 v58, v21, v58
  v_mul_f32 v59, v21, v59
  v_mul_f32 v60, v21, v60
  v_mul_f32 v61, v21, v61
  v_mul_f32 v62, v21, v62
  v_mul_f32 v63, v21, v63
  v_mul_f32 v64, v21, v64
  v_mul_f32 v65, v21, v65
  v_mul_f32 v66, v21, v66
  v_mul_f32 v67, v21, v67
  v_mul_f32 v68, v21, v68
  v_mul_f32 v69, v21, v69
  v_mul_f32 v70, v21, v70
  v_mul_f32 v71, v21, v71
  s_waitcnt vmcnt(11)
  buffer_load_dwordx4 v[128:131], v3, s[28:31], s44 offen offset:2048 nt
  s_waitcnt vmcnt(11)
  buffer_load_dwordx4 v[132:135], v3, s[28:31], s44 offen offset:3072 nt
  s_waitcnt vmcnt(11)
  s_add_u32 s77, s44, 0x1000
  buffer_load_dwordx4 v[136:139], v3, s[28:31], s77 offen offset:0 nt
  s_waitcnt vmcnt(11)
  s_add_u32 s77, s44, 0x1000
  buffer_load_dwordx4 v[140:143], v3, s[28:31], s77 offen offset:1024 nt
  s_waitcnt vmcnt(11)
  s_add_u32 s77, s44, 0x1000
  buffer_load_dwordx4 v[144:147], v3, s[28:31], s77 offen offset:2048 nt
  s_waitcnt vmcnt(11)
  s_add_u32 s77, s44, 0x1000
  buffer_load_dwordx4 v[148:151], v3, s[28:31], s77 offen offset:3072 nt
  v_perm_b32 v72, v92, v88, s50
  v_perm_b32 v73, v100, v96, s50
  v_perm_b32 v74, v108, v104, s50
  v_perm_b32 v75, v116, v112, s50
  v_perm_b32 v76, v92, v88, s51
  v_perm_b32 v77, v100, v96, s51
  v_perm_b32 v78, v108, v104, s51
  v_perm_b32 v79, v116, v112, s51
  s_nop 1
  v_mfma_f32_16x16x32_bf16 v[40:43], v[72:75], v[16:19], v[40:43]
  v_mfma_f32_16x16x32_bf16 v[44:47], v[76:79], v[16:19], v[44:47]
  v_perm_b32 v72, v93, v89, s50
  v_perm_b32 v73, v101, v97, s50
  v_perm_b32 v74, v109, v105, s50
  v_perm_b32 v75, v117, v113, s50
  v_perm_b32 v76, v93, v89, s51
  v_perm_b32 v77, v101, v97, s51
  v_perm_b32 v78, v109, v105, s51
  v_perm_b32 v79, v117, v113, s51
  s_nop 1
  v_mfma_f32_16x16x32_bf16 v[48:51], v[72:75], v[16:19], v[48:51]
  v_mfma_f32_16x16x32_bf16 v[52:55], v[76:79], v[16:19], v[52:55]
  v_perm_b32 v72, v94, v90, s50
  v_perm_b32 v73, v102, v98, s50
  v_perm_b32 v74, v110, v106, s50
  v_perm_b32 v75, v118, v114, s50
  v_perm_b32 v76, v94, v90, s51
  v_perm_b32 v77, v102, v98, s51
  v_perm_b32 v78, v110, v106, s51
  v_perm_b32 v79, v118, v114, s51
  s_nop 1
  v_mfma_f32_16x16x32_bf16 v[56:59], v[72:75], v[16:19], v[56:59]
  v_mfma_f32_16x16x32_bf16 v[60:63], v[76:79], v[16:19], v[60:63]
  v_perm_b32 v72, v95, v91, s50
  v_perm_b32 v73, v103, v99, s50
  v_perm_b32 v74, v111, v107, s50
  v_perm_b32 v75, v119, v115, s50
  v_perm_b32 v76, v95, v91, s51
  v_perm_b32 v77, v103, v99, s51
  v_perm_b32 v78, v111, v107, s51
  v_perm_b32 v79, v119, v115, s51
  s_nop 1
  v_mfma_f32_16x16x32_bf16 v[64:67], v[72:75], v[16:19], v[64:67]
  v_mfma_f32_16x16x32_bf16 v[68:71], v[76:79], v[16:19], v[68:71]
  s_waitcnt vmcnt(11)
  buffer_load_dwordx4 v[88:91], v246, s[24:27], s45 offen offset:0 nt
  s_waitcnt vmcnt(7)
  buffer_load_dwordx4 v[92:95], v246, s[24:27], s45 offen offset:1024 nt
  s_nop 7
  v_mul_f32 v40, v22, v40
  v_mul_f32 v41, v22, v41
  v_mul_f32 v42, v22, v42
  v_mul_f32 v43, v22, v43
  v_mul_f32 v44, v22, v44
  v_mul_f32 v45, v22, v45
  v_mul_f32 v46, v22, v46
  v_mul_f32 v47, v22, v47
  v_mul_f32 v48, v22, v48
  v_mul_f32 v49, v22, v49
  v_mul_f32 v50, v22, v50
  v_mul_f32 v51, v22, v51
  v_mul_f32 v52, v22, v52
  v_mul_f32 v53, v22, v53
  v_mul_f32 v54, v22, v54
  v_mul_f32 v55, v22, v55
  v_mul_f32 v56, v22, v56
  v_mul_f32 v57, v22, v57
  v_mul_f32 v58, v22, v58
  v_mul_f32 v59, v22, v59
  v_mul_f32 v60, v22, v60
  v_mul_f32 v61, v22, v61
  v_mul_f32 v62, v22, v62
  v_mul_f32 v63, v22, v63
  v_mul_f32 v64, v22, v64
  v_mul_f32 v65, v22, v65
  v_mul_f32 v66, v22, v66
  v_mul_f32 v67, v22, v67
  v_mul_f32 v68, v22, v68
  v_mul_f32 v69, v22, v69
  v_mul_f32 v70, v22, v70
  v_mul_f32 v71, v22, v71
  s_cmp_lg_u32 s40, 1
  s_cbranch_scc1 L_hk4
  v_subrev_u32 v253, s55, v253
  v_cmp_ge_u32 vcc, s82, v253
  v_min_u32 v253, s82, v253
  s_bcnt1_i32_b32 s49, vcc_lo
  v_mov_b32 v250, v253
  s_nop 1
  v_add_u32_dpp v253, v253, v253 row_shr:1 row_mask:0xf bank_mask:0xf bound_ctrl:0
  v_max_u32_dpp v250, v250, v250 row_shr:1 row_mask:0xf bank_mask:0xf bound_ctrl:0
  s_nop 0
  v_add_u32_dpp v253, v253, v253 row_shr:2 row_mask:0xf bank_mask:0xf bound_ctrl:0
  v_max_u32_dpp v250, v250, v250 row_shr:2 row_mask:0xf bank_mask:0xf bound_ctrl:0
  s_nop 0
  v_add_u32_dpp v253, v253, v253 row_shr:4 row_mask:0xf bank_mask:0xf bound_ctrl:0
  v_max_u32_dpp v250, v250, v250 row_shr:4 row_mask:0xf bank_mask:0xf bound_ctrl:0
  s_nop 0
  v_add_u32_dpp v253, v253, v253 row_shr:8 row_mask:0xf bank_mask:0xf bound_ctrl:0
  v_max_u32_dpp v250, v250, v250 row_shr:8 row_mask:0xf bank_mask:0xf bound_ctrl:0
  s_cmp_ge_u32 s49, 8
  s_cselect_b32 s9, s9, 0
  s_cbranch_scc0 L_hk4
  v_readlane_b32 s48, v253, 15
  v_readlane_b32 s49, v253, 31
  s_add_u32 s48, s48, s49
  s_lshr_b32 s48, s48, 5
  v_readlane_b32 s87, v250, 15
  v_readlane_b32 s49, v250, 31
  s_max_u32 s87, s87, s49
  s_sub_u32 s87, s87, s48
  s_sub_i32 s87, s87, 110
  s_max_i32 s87, s87, 0
  s_lshr_b32 s87, s87, 0
  s_min_u32 s87, s87, 60
  s_cmp_ge_u32 s46, 14
  s_cselect_b32 s87, s87, 0
  s_sub_u32 s49, s48, s9
  s_min_u32 s49, s49, 280
  s_max_u32 s49, s49, 200
  s_sub_i32 s49, s49, s81
  s_ashr_i32 s49, s49, 2
  s_cmp_eq_u32 s9, 0
  s_cselect_b32 s49, 0, s49
  s_add_u32 s49, s49, s81
  s_cmp_eq_u32 s81, 0
  s_cselect_b32 s49, 226, s49
  s_mov_b32 s9, s48
  v_mov_b32 v251, s49
  s_sub_u32 s80, s46, 2
  s_mul_i32 s49, s49, s80
  s_sub_u32 s48, s48, s49
  s_add_u32 s48, s48, s87
  v_mov_b32 v250, s48
  s_mov_b64 exec, 1
  ds_write_b64 v248, v[250:251] offset:24
  s_mov_b64 exec, -1
L_hk4:
  s_waitcnt vmcnt(7)
  buffer_load_dwordx4 v[96:99], v246, s[24:27], s45 offen offset:2048 nt
  s_waitcnt vmcnt(7)
  buffer_load_dwordx4 v[100:103], v246, s[24:27], s45 offen offset:3072 nt
  s_waitcnt vmcnt(7)
  s_add_u32 s77, s45, 0x1000
  buffer_load_dwordx4 v[104:107], v246, s[24:27], s77 offen offset:0 nt
  s_waitcnt vmcnt(7)
  s_add_u32 s77, s45, 0x1000
  buffer_load_dwordx4 v[108:111], v246, s[24:27], s77 offen offset:1024 nt
  s_waitcnt vmcnt(7)
  s_add_u32 s77, s45, 0x1000
  buffer_load_dwordx4 v[112:115], v246, s[24:27], s77 offen offset:2048 nt
  s_waitcnt vmcnt(7)
  s_add_u32 s77, s45, 0x1000
  buffer_load_dwordx4 v[116:119], v246, s[24:27], s77 offen offset:3072 nt
  v_perm_b32 v72, v124, v120, s50
  v_perm_b32 v73, v132, v128, s50
  v_perm_b32 v74, v140, v136, s50
  v_perm_b32 v75, v148, v144, s50
  v_perm_b32 v76, v124, v120, s51
  v_perm_b32 v77, v132, v128, s51
  v_perm_b32 v78, v140, v136, s51
  v_perm_b32 v79, v148, v144, s51
  s_nop 1
  v_mfma_f32_16x16x32_bf16 v[40:43], v[72:75], v[8:11], v[40:43]
  v_mfma_f32_16x16x32_bf16 v[44:47], v[76:79], v[8:11], v[44:47]
  v_perm_b32 v72, v125, v121, s50
  v_perm_b32 v73, v133, v129, s50
  v_perm_b32 v74, v141, v137, s50
  v_perm_b32 v75, v149, v145, s50
  v_perm_b32 v76, v125, v121, s51
  v_perm_b32 v77, v133, v129, s51
  v_perm_b32 v78, v141, v137, s51
  v_perm_b32 v79, v149, v145, s51
  s_nop 1
  v_mfma_f32_16x16x32_bf16 v[48:51], v[72:75], v[8:11], v[48:51]
  v_mfma_f32_16x16x32_bf16 v[52:55], v[76:79], v[8:11], v[52:55]
  v_perm_b32 v72, v126, v122, s50
  v_perm_b32 v73, v134, v130, s50
  v_perm_b32 v74, v142, v138, s50
  v_perm_b32 v75, v150, v146, s50
  v_perm_b32 v76, v126, v122, s51
  v_perm_b32 v77, v134, v130, s51
  v_perm_b32 v78, v142, v138, s51
  v_perm_b32 v79, v150, v146, s51
  s_nop 1
  v_mfma_f32_16x16x32_bf16 v[56:59], v[72:75], v[8:11], v[56:59]
  v_mfma_f32_16x16x32_bf16 v[60:63], v[76:79], v[8:11], v[60:63]
  v_perm_b32 v72, v127, v123, s50
  v_perm_b32 v73, v135, v131, s50
  v_perm_b32 v74, v143, v139, s50
  v_perm_b32 v75, v151, v147, s50
  v_perm_b32 v76, v127, v123, s51
  v_perm_b32 v77, v135, v131, s51
  v_perm_b32 v78, v143, v139, s51
  v_perm_b32 v79, v151, v147, s51
  s_nop 1
  v_mfma_f32_16x16x32_bf16 v[64:67], v[72:75], v[8:11], v[64:67]
  v_mfma_f32_16x16x32_bf16 v[68:71], v[76:79], v[8:11], v[68:71]
  s_or_b32 s44, s45, 0x4000
  s_mov_b64 s[28:29], s[24:25]
  s_and_b32 s48, s46, 7
  s_cmp_eq_u32 s48, 7
  s_cselect_b32 s48, -7, 1
  s_mulk_i32 s48, 1280
  v_add_u32 v244, s48, v244
  v_add_u32 v245, s48, v245
  s_add_u32 s10, s10, s11
  s_mov_b32 s11, 0
  s_add_u32 s46, s46, 1
  s_cmp_lt_u32 s46, 31
  s_cbranch_scc1 L_loop
  s_branch L_last
L_b2:
  s_waitcnt vmcnt(6)
  buffer_load_dwordx4 v[120:123], v3, s[28:31], s44 offen offset:0 nt
  s_sub_u32 s48, s100, s10
  v_mov_b32 v226, s48
  s_add_u32 s48, s8, s7
  s_mov_b32 exec_hi, 0
  buffer_load_dword v253, v227, s[32:35], s8 offen sc1
  s_mov_b32 exec_lo, 1
  buffer_store_dword v226, off, s[12:15], s48 sc1
  s_mov_b64 exec, -1
  s_add_u32 s8, s8, 0x1100
  s_mov_b32 s47, 2
  s_branch L_snip
L_ret2:
  s_or_b32 s45, s44, 0x17f00
  s_add_u32 s45, s45, 0x100
  s_and_b32 s45, s45, 0x68000
  s_or_b32 s45, s45, s78
  ds_read_b32 v21, v245
  ds_read_b128 v[16:19], v244
  ds_read_b32 v22, v245 offset:640
  ds_read_b128 v[8:11], v244 offset:640
  s_waitcnt vmcnt(10)
  buffer_load_dwordx4 v[124:127], v3, s[28:31], s44 offen offset:1024 nt
  s_waitcnt lgkmcnt(0)
  s_nop 7
  v_mul_f32 v40, v21, v40
  v_mul_f32 v41, v21, v41
  v_mul_f32 v42, v21, v42
  v_mul_f32 v43, v21, v43
  v_mul_f32 v44, v21, v44
  v_mul_f32 v45, v21, v45
  v_mul_f32 v46, v21, v46
  v_mul_f32 v47, v21, v47
  v_mul_f32 v48, v21, v48
  v_mul_f32 v49, v21, v49
  v_mul_f32 v50, v21, v50
  v_mul_f32 v51, v21, v51
  v_mul_f32 v52, v21, v52
  v_mul_f32 v53, v21, v53
  v_mul_f32 v54, v21, v54
  v_mul_f32 v55, v21, v55
  v_mul_f32 v56, v21, v56
  v_mul_f32 v57, v21, v57
  v_mul_f32 v58, v21, v58
  v_mul_f32 v59, v21, v59
  v_mul_f32 v60, v21, v60
  v_mul_f32 v61, v21, v61
  v_mul_f32 v62, v21, v62
  v_mul_f32 v63, v21, v63
  v_mul_f32 v64, v21, v64
  v_mul_f32 v65, v21, v65
  v_mul_f32 v66, v21, v66
  v_mul_f32 v67, v21, v67
  v_mul_f32 v68, v21, v68
  v_mul_f32 v69, v21, v69
  v_mul_f32 v70, v21, v70
  v_mul_f32 v71, v21, v71
  s_waitcnt vmcnt(10)
  buffer_load_dwordx4 v[128:131], v3, s[28:31], s44 offen offset:2048 nt
  s_waitcnt vmcnt(10)
  buffer_load_dwordx4 v[132:135], v3, s[28:31], s44 offen offset:3072 nt
  s_waitcnt vmcnt(10)
  s_add_u32 s77, s44, 0x1000
  buffer_load_dwordx4 v[136:139], v3, s[28:31], s77 offen offset:0 nt
  s_waitcnt vmcnt(10)
  s_add_u32 s77, s44, 0x1000
  buffer_load_dwordx4 v[140:143], v3, s[28:31], s77 offen offset:1024 nt
  s_waitcnt vmcnt(10)
  s_add_u32 s77, s44, 0x1000
  buffer_load_dwordx4 v[144:147], v3, s[28:31], s77 offen offset:2048 nt
  v_perm_b32 v72, v92, v88, s50
  v_perm_b32 v73, v100, v96, s50
  v_perm_b32 v74, v108, v104, s50
  v_perm_b32 v75, v116, v112, s50
  v_perm_b32 v76, v92, v88, s51
  v_perm_b32 v77, v100, v96, s51
  v_perm_b32 v78, v108, v104, s51
  v_perm_b32 v79, v116, v112, s51
  s_nop 1
  v_mfma_f32_16x16x32_bf16 v[40:43], v[72:75], v[16:19], v[40:43]
  v_mfma_f32_16x16x32_bf16 v[44:47], v[76:79], v[16:19], v[44:47]
  s_waitcnt vmcnt(10)
  s_add_u32 s77, s44, 0x1000
  buffer_load_dwordx4 v[148:151], v3, s[28:31], s77 offen offset:3072 nt
  v_perm_b32 v72, v93, v89, s50
  v_perm_b32 v73, v101, v97, s50
  v_perm_b32 v74, v109, v105, s50
  v_perm_b32 v75, v117, v113, s50
  v_perm_b32 v76, v93, v89, s51
  v_perm_b32 v77, v101, v97, s51
  v_perm_b32 v78, v109, v105, s51
  v_perm_b32 v79, v117, v113, s51
  s_nop 1
  v_mfma_f32_16x16x32_bf16 v[48:51], v[72:75], v[16:19], v[48:51]
  v_mfma_f32_16x16x32_bf16 v[52:55], v[76:79], v[16:19], v[52:55]
  v_perm_b32 v72, v94, v90, s50
  v_perm_b32 v73, v102, v98, s50
  v_perm_b32 v74, v110, v106, s50
  v_perm_b32 v75, v118, v114, s50
  v_perm_b32 v76, v94, v90, s51
  v_perm_b32 v77, v102, v98, s51
  v_perm_b32 v78, v110, v106, s51
  v_perm_b32 v79, v118, v114, s51
  s_nop 1
  v_mfma_f32_16x16x32_bf16 v[56:59], v[72:75], v[16:19], v[56:59]
  v_mfma_f32_16x16x32_bf16 v[60:63], v[76:79], v[16:19], v[60:63]
  v_perm_b32 v72, v95, v91, s50
  v_perm_b32 v73, v103, v99, s50
  v_perm_b32 v74, v111, v107, s50
  v_perm_b32 v75, v119, v115, s50
  v_perm_b32 v76, v95, v91, s51
  v_perm_b32 v77, v103, v99, s51
  v_perm_b32 v78, v111, v107, s51
  v_perm_b32 v79, v119, v115, s51
  s_nop 1
  v_mfma_f32_16x16x32_bf16 v[64:67], v[72:75], v[16:19], v[64:67]
  v_mfma_f32_16x16x32_bf16 v[68:71], v[76:79], v[16:19], v[68:71]
  s_waitcnt vmcnt(6)
  buffer_load_dwordx4 v[88:91], v246, s[24:27], s45 offen offset:0 nt
  s_waitcnt vmcnt(6)
  buffer_load_dwordx4 v[92:95], v246, s[24:27], s45 offen offset:1024 nt
  s_nop 7
  v_mul_f32 v40, v22, v40
  v_mul_f32 v41, v22, v41
  v_mul_f32 v42, v22, v42
  v_mul_f32 v43, v22, v43
  v_mul_f32 v44, v22, v44
  v_mul_f32 v45, v22, v45
  v_mul_f32 v46, v22, v46
  v_mul_f32 v47, v22, v47
  v_mul_f32 v48, v22, v48
  v_mul_f32 v49, v22, v49
  v_mul_f32 v50, v22, v50
  v_mul_f32 v51, v22, v51
  v_mul_f32 v52, v22, v52
  v_mul_f32 v53, v22, v53
  v_mul_f32 v54, v22, v54
  v_mul_f32 v55, v22, v55
  v_mul_f32 v56, v22, v56
  v_mul_f32 v57, v22, v57
  v_mul_f32 v58, v22, v58
  v_mul_f32 v59, v22, v59
  v_mul_f32 v60, v22, v60
  v_mul_f32 v61, v22, v61
  v_mul_f32 v62, v22, v62
  v_mul_f32 v63, v22, v63
  v_mul_f32 v64, v22, v64
  v_mul_f32 v65, v22, v65
  v_mul_f32 v66, v22, v66
  v_mul_f32 v67, v22, v67
  v_mul_f32 v68, v22, v68
  v_mul_f32 v69, v22, v69
  v_mul_f32 v70, v22, v70
  v_mul_f32 v71, v22, v71
  s_cmp_lg_u32 s40, 1
  s_cbranch_scc1 L_hk2
  v_subrev_u32 v253, s55, v253
  v_cmp_ge_u32 vcc, s82, v253
  v_min_u32 v253, s82, v253
  s_bcnt1_i32_b32 s49, vcc_lo
  v_mov_b32 v250, v253
  s_nop 1
  v_add_u32_dpp v253, v253, v253 row_shr:1 row_mask:0xf bank_mask:0xf bound_ctrl:0
  v_max_u32_dpp v250, v250, v250 row_shr:1 row_mask:0xf bank_mask:0xf bound_ctrl:0
  s_nop 0
  v_add_u32_dpp v253, v253, v253 row_shr:2 row_mask:0xf bank_mask:0xf bound_ctrl:0
  v_max_u32_dpp v250, v250, v250 row_shr:2 row_mask:0xf bank_mask:0xf bound_ctrl:0
  s_nop 0
  v_add_u32_dpp v253, v253, v253 row_shr:4 row_mask:0xf bank_mask:0xf bound_ctrl:0
  v_max_u32_dpp v250, v250, v250 row_shr:4 row_mask:0xf bank_mask:0xf bound_ctrl:0
  s_nop 0
  v_add_u32_dpp v253, v253, v253 row_shr:8 row_mask:0xf bank_mask:0xf bound_ctrl:0
  v_max_u32_dpp v250, v250, v250 row_shr:8 row_mask:0xf bank_mask:0xf bound_ctrl:0
  s_cmp_ge_u32 s49, 8
  s_cselect_b32 s9, s9, 0
  s_cbranch_scc0 L_hk2
  v_readlane_b32 s48, v253, 15
  v_readlane_b32 s49, v253, 31
  s_add_u32 s48, s48, s49
  s_lshr_b32 s48, s48, 5
  v_readlane_b32 s87, v250, 15
  v_readlane_b32 s49, v250, 31
  s_max_u32 s87, s87, s49
  s_sub_u32 s87, s87, s48
  s_sub_i32 s87, s87, 110
  s_max_i32 s87, s87, 0
  s_lshr_b32 s87, s87, 0
  s_min_u32 s87, s87, 60
  s_cmp_ge_u32 s46, 14
  s_cselect_b32 s87, s87, 0
  s_sub_u32 s49, s48, s9
  s_min_u32 s49, s49, 280
  s_max_u32 s49, s49, 200
  s_sub_i32 s49, s49, s81
  s_ashr_i32 s49, s49, 2
  s_cmp_eq_u32 s9, 0
  s_cselect_b32 s49, 0, s49
  s_add_u32 s49, s49, s81
  s_cmp_eq_u32 s81, 0
  s_cselect_b32 s49, 226, s49
  s_mov_b32 s9, s48
  v_mov_b32 v251, s49
  s_sub_u32 s80, s46, 2
  s_mul_i32 s49, s49, s80
  s_sub_u32 s48, s48, s49
  s_add_u32 s48, s48, s87
  v_mov_b32 v250, s48
  s_mov_b64 exec, 1
  ds_write_b64 v248, v[250:251] offset:24
  s_mov_b64 exec, -1
L_hk2:
  s_waitcnt vmcnt(6)
  buffer_load_dwordx4 v[96:99], v246, s[24:27], s45 offen offset:2048 nt
  s_waitcnt vmcnt(6)
  buffer_load_dwordx4 v[100:103], v246, s[24:27], s45 offen offset:3072 nt
  s_waitcnt vmcnt(6)
  s_add_u32 s77, s45, 0x1000
  buffer_load_dwordx4 v[104:107], v246, s[24:27], s77 offen offset:0 nt
  s_waitcnt vmcnt(6)
  s_add_u32 s77, s45, 0x1000
  buffer_load_dwordx4 v[108:111], v246, s[24:27], s77 offen offset:1024 nt
  s_waitcnt vmcnt(6)
  s_add_u32 s77, s45, 0x1000
  buffer_load_dwordx4 v[112:115], v246, s[24:27], s77 offen offset:2048 nt
  v_perm_b32 v72, v124, v120, s50
  v_perm_b32 v73, v132, v128, s50
  v_perm_b32 v74, v140, v136, s50
  v_perm_b32 v75, v148, v144, s50
  v_perm_b32 v76, v124, v120, s51
  v_perm_b32 v77, v132, v128, s51
  v_perm_b32 v78, v140, v136, s51
  v_perm_b32 v79, v148, v144, s51
  s_nop 1
  v_mfma_f32_16x16x32_bf16 v[40:43], v[72:75], v[8:11], v[40:43]
  v_mfma_f32_16x16x32_bf16 v[44:47], v[76:79], v[8:11], v[44:47]
  s_waitcnt vmcnt(6)
  s_add_u32 s77, s45, 0x1000
  buffer_load_dwordx4 v[116:119], v246, s[24:27], s77 offen offset:3072 nt
  v_perm_b32 v72, v125, v121, s50
  v_perm_b32 v73, v133, v129, s50
  v_perm_b32 v74, v141, v137, s50
  v_perm_b32 v75, v149, v145, s50
  v_perm_b32 v76, v125, v121, s51
  v_perm_b32 v77, v133, v129, s51
  v_perm_b32 v78, v141, v137, s51
  v_perm_b32 v79, v149, v145, s51
  s_nop 1
  v_mfma_f32_16x16x32_bf16 v[48:51], v[72:75], v[8:11], v[48:51]
  v_mfma_f32_16x16x32_bf16 v[52:55], v[76:79], v[8:11], v[52:55]
  v_perm_b32 v72, v126, v122, s50
  v_perm_b32 v73, v134, v130, s50
  v_perm_b32 v74, v142, v138, s50
  v_perm_b32 v75, v150, v146, s50
  v_perm_b32 v76, v126, v122, s51
  v_perm_b32 v77, v134, v130, s51
  v_perm_b32 v78, v142, v138, s51
  v_perm_b32 v79, v150, v146, s51
  s_nop 1
  v_mfma_f32_16x16x32_bf16 v[56:59], v[72:75], v[8:11], v[56:59]
  v_mfma_f32_16x16x32_bf16 v[60:63], v[76:79], v[8:11], v[60:63]
  v_perm_b32 v72, v127, v123, s50
  v_perm_b32 v73, v135, v131, s50
  v_perm_b32 v74, v143, v139, s50
  v_perm_b32 v75, v151, v147, s50
  v_perm_b32 v76, v127, v123, s51
  v_perm_b32 v77, v135, v131, s51
  v_perm_b32 v78, v143, v139, s51
  v_perm_b32 v79, v151, v147, s51
  s_nop 1
  v_mfma_f32_16x16x32_bf16 v[64:67], v[72:75], v[8:11], v[64:67]
  v_mfma_f32_16x16x32_bf16 v[68:71], v[76:79], v[8:11], v[68:71]
  s_or_b32 s44, s45, 0x4000
  s_mov_b64 s[28:29], s[24:25]
  s_and_b32 s48, s46, 7
  s_cmp_eq_u32 s48, 7
  s_cselect_b32 s48, -7, 1
  s_mulk_i32 s48, 1280
  v_add_u32 v244, s48, v244
  v_add_u32 v245, s48, v245
  s_add_u32 s10, s10, s11
  s_mov_b32 s11, 0
  s_add_u32 s46, s46, 1
  s_cmp_lt_u32 s46, 31
  s_cbranch_scc1 L_loop
L_last:
L_lw0:
  s_waitcnt vmcnt(7)
  buffer_load_dwordx4 v[120:123], v3, s[28:31], s44 offen offset:0 nt
  v_and_b32 v220, 15, v0
  v_lshlrev_b32 v220, 4, v220
  v_bfe_u32 v221, v0, 4, 2
  v_lshl_add_u32 v220, v221, 10, v220
  s_and_b32 s49, s40, 1
  s_lshl_b32 s49, s49, 8
  s_add_u32 s49, s49, 0xc000
  v_add_u32 v220, s49, v220
  v_and_b32 v221, 7, v0
  v_lshlrev_b32 v221, 2, v221
  v_add_u32 v221, 0x18400, v221
  ds_read_b32 v152, v221 offset:0
  ds_read_b32 v153, v221 offset:256
  ds_read_b32 v154, v221 offset:512
  ds_read_b32 v155, v221 offset:768
  ds_read_b32 v156, v221 offset:2048
  ds_read_b32 v157, v221 offset:2304
  ds_read_b32 v158, v221 offset:2560
  ds_read_b32 v159, v221 offset:2816
  s_and_b32 s48, s40, 1
  s_lshl_b32 s49, s48, 12
  s_add_u32 s49, s49, 0x1a040
  v_add_u32 v224, s49, v2
  s_lshl_b32 s48, s48, 2
  v_add_u32 v226, s48, v248
  s_mov_b32 s88, 0x7060500
  s_mov_b32 s89, 0x7060501
  s_mov_b32 s90, 0x7060502
  s_mov_b32 s91, 0x7060503
  ds_read_b32 v21, v245
  ds_read_b128 v[16:19], v244
  ds_read_b32 v22, v245 offset:640
  ds_read_b128 v[8:11], v244 offset:640
  s_waitcnt vmcnt(7)
  buffer_load_dwordx4 v[124:127], v3, s[28:31], s44 offen offset:1024 nt
  s_waitcnt lgkmcnt(0)
  s_nop 7
  v_mul_f32 v40, v21, v40
  v_mul_f32 v41, v21, v41
  v_mul_f32 v42, v21, v42
  v_mul_f32 v43, v21, v43
  v_mul_f32 v44, v21, v44
  v_mul_f32 v45, v21, v45
  v_mul_f32 v46, v21, v46
  v_mul_f32 v47, v21, v47
  v_mul_f32 v48, v21, v48
  v_mul_f32 v49, v21, v49
  v_mul_f32 v50, v21, v50
  v_mul_f32 v51, v21, v51
  v_mul_f32 v52, v21, v52
  v_mul_f32 v53, v21, v53
  v_mul_f32 v54, v21, v54
  v_mul_f32 v55, v21, v55
  v_mul_f32 v56, v21, v56
  v_mul_f32 v57, v21, v57
  v_mul_f32 v58, v21, v58
  v_mul_f32 v59, v21, v59
  v_mul_f32 v60, v21, v60
  v_mul_f32 v61, v21, v61
  v_mul_f32 v62, v21, v62
  v_mul_f32 v63, v21, v63
  v_mul_f32 v64, v21, v64
  v_mul_f32 v65, v21, v65
  v_mul_f32 v66, v21, v66
  v_mul_f32 v67, v21, v67
  v_mul_f32 v68, v21, v68
  v_mul_f32 v69, v21, v69
  v_mul_f32 v70, v21, v70
  v_mul_f32 v71, v21, v71
  s_waitcnt vmcnt(7)
  buffer_load_dwordx4 v[128:131], v3, s[28:31], s44 offen offset:2048 nt
  v_max3_f32 v160, v152, v153, v154
  v_max_f32 v160, v160, v155
  v_sub_f32 v152, v152, v160
  v_sub_f32 v153, v153, v160
  v_sub_f32 v154, v154, v160
  v_sub_f32 v155, v155, v160
  v_exp_f32 v152, v152
  v_exp_f32 v153, v153
  v_exp_f32 v154, v154
  v_exp_f32 v155, v155
  s_nop 0
  v_mul_f32 v161, v152, v156
  v_fma_f32 v161, v153, v157, v161
  v_fma_f32 v161, v154, v158, v161
  v_fma_f32 v161, v155, v159, v161
  v_rcp_f32 v161, v161
  s_nop 0
  v_mul_f32 v216, v161, v152
  v_mul_f32 v217, v161, v153
  v_mul_f32 v218, v161, v154
  v_mul_f32 v219, v161, v155
  s_waitcnt vmcnt(7)
  buffer_load_dwordx4 v[132:135], v3, s[28:31], s44 offen offset:3072 nt
  s_waitcnt vmcnt(7)
  s_add_u32 s77, s44, 0x1000
  buffer_load_dwordx4 v[136:139], v3, s[28:31], s77 offen offset:0 nt
  s_waitcnt vmcnt(7)
  s_add_u32 s77, s44, 0x1000
  buffer_load_dwordx4 v[140:143], v3, s[28:31], s77 offen offset:1024 nt
  s_waitcnt vmcnt(7)
  s_add_u32 s77, s44, 0x1000
  buffer_load_dwordx4 v[144:147], v3, s[28:31], s77 offen offset:2048 nt
  s_waitcnt vmcnt(7)
  s_add_u32 s77, s44, 0x1000
  buffer_load_dwordx4 v[148:151], v3, s[28:31], s77 offen offset:3072 nt
  v_perm_b32 v72, v92, v88, s50
  v_perm_b32 v73, v100, v96, s50
  v_perm_b32 v74, v108, v104, s50
  v_perm_b32 v75, v116, v112, s50
  v_perm_b32 v76, v92, v88, s51
  v_perm_b32 v77, v100, v96, s51
  v_perm_b32 v78, v108, v104, s51
  v_perm_b32 v79, v116, v112, s51
  s_nop 1
  v_mfma_f32_16x16x32_bf16 v[40:43], v[72:75], v[16:19], v[40:43]
  v_mfma_f32_16x16x32_bf16 v[44:47], v[76:79], v[16:19], v[44:47]
  v_perm_b32 v72, v93, v89, s50
  v_perm_b32 v73, v101, v97, s50
  v_perm_b32 v74, v109, v105, s50
  v_perm_b32 v75, v117, v113, s50
  v_perm_b32 v76, v93, v89, s51
  v_perm_b32 v77, v101, v97, s51
  v_perm_b32 v78, v109, v105, s51
  v_perm_b32 v79, v117, v113, s51
  s_nop 1
  v_mfma_f32_16x16x32_bf16 v[48:51], v[72:75], v[16:19], v[48:51]
  v_mfma_f32_16x16x32_bf16 v[52:55], v[76:79], v[16:19], v[52:55]
  v_perm_b32 v72, v94, v90, s50
  v_perm_b32 v73, v102, v98, s50
  v_perm_b32 v74, v110, v106, s50
  v_perm_b32 v75, v118, v114, s50
  v_perm_b32 v76, v94, v90, s51
  v_perm_b32 v77, v102, v98, s51
  v_perm_b32 v78, v110, v106, s51
  v_perm_b32 v79, v118, v114, s51
  s_nop 1
  v_mfma_f32_16x16x32_bf16 v[56:59], v[72:75], v[16:19], v[56:59]
  v_mfma_f32_16x16x32_bf16 v[60:63], v[76:79], v[16:19], v[60:63]
  v_perm_b32 v72, v95, v91, s50
  v_perm_b32 v73, v103, v99, s50
  v_perm_b32 v74, v111, v107, s50
  v_perm_b32 v75, v119, v115, s50
  v_perm_b32 v76, v95, v91, s51
  v_perm_b32 v77, v103, v99, s51
  v_perm_b32 v78, v111, v107, s51
  v_perm_b32 v79, v119, v115, s51
  s_nop 1
  v_mfma_f32_16x16x32_bf16 v[64:67], v[72:75], v[16:19], v[64:67]
  v_mfma_f32_16x16x32_bf16 v[68:71], v[76:79], v[16:19], v[68:71]
  s_nop 7
  v_mul_f32 v40, v22, v40
  v_mul_f32 v41, v22, v41
  v_mul_f32 v42, v22, v42
  v_mul_f32 v43, v22, v43
  v_mul_f32 v44, v22, v44
  v_mul_f32 v45, v22, v45
  v_mul_f32 v46, v22, v46
  v_mul_f32 v47, v22, v47
  v_mul_f32 v48, v22, v48
  v_mul_f32 v49, v22, v49
  v_mul_f32 v50, v22, v50
  v_mul_f32 v51, v22, v51
  v_mul_f32 v52, v22, v52
  v_mul_f32 v53, v22, v53
  v_mul_f32 v54, v22, v54
  v_mul_f32 v55, v22, v55
  v_mul_f32 v56, v22, v56
  v_mul_f32 v57, v22, v57
  v_mul_f32 v58, v22, v58
  v_mul_f32 v59, v22, v59
  v_mul_f32 v60, v22, v60
  v_mul_f32 v61, v22, v61
  v_mul_f32 v62, v22, v62
  v_mul_f32 v63, v22, v63
  v_mul_f32 v64, v22, v64
  v_mul_f32 v65, v22, v65
  v_mul_f32 v66, v22, v66
  v_mul_f32 v67, v22, v67
  v_mul_f32 v68, v22, v68
  v_mul_f32 v69, v22, v69
  v_mul_f32 v70, v22, v70
  v_mul_f32 v71, v22, v71
  s_waitcnt vmcnt(7)
  buffer_load_dwordx4 v[88:91], v86, s[36:39], s93 offen offset:0 sc1
  s_waitcnt vmcnt(7)
  buffer_load_dwordx4 v[92:95], v86, s[36:39], s93 offen offset:128 sc1
  v_perm_b32 v152, v124, v120, s50
  v_perm_b32 v156, v124, v120, s51
  v_perm_b32 v160, v125, v121, s50
  v_perm_b32 v164, v125, v121, s51
  v_perm_b32 v168, v126, v122, s50
  v_perm_b32 v172, v126, v122, s51
  v_perm_b32 v176, v127, v123, s50
  v_perm_b32 v180, v127, v123, s51
  s_waitcnt vmcnt(7)
  buffer_load_dwordx4 v[96:99], v86, s[36:39], s93 offen offset:1024 sc1
  s_waitcnt vmcnt(7)
  buffer_load_dwordx4 v[100:103], v86, s[36:39], s93 offen offset:1152 sc1
  v_perm_b32 v153, v132, v128, s50
  v_perm_b32 v157, v132, v128, s51
  v_perm_b32 v161, v133, v129, s50
  v_perm_b32 v165, v133, v129, s51
  v_perm_b32 v169, v134, v130, s50
  v_perm_b32 v173, v134, v130, s51
  v_perm_b32 v177, v135, v131, s50
  v_perm_b32 v181, v135, v131, s51
  s_waitcnt vmcnt(7)
  buffer_load_dwordx4 v[104:107], v86, s[36:39], s58 offen offset:0 sc1
  s_waitcnt vmcnt(7)
  buffer_load_dwordx4 v[108:111], v86, s[36:39], s58 offen offset:128 sc1
  v_perm_b32 v154, v140, v136, s50
  v_perm_b32 v158, v140, v136, s51
  v_perm_b32 v162, v141, v137, s50
  v_perm_b32 v166, v141, v137, s51
  v_perm_b32 v170, v142, v138, s50
  v_perm_b32 v174, v142, v138, s51
  v_perm_b32 v178, v143, v139, s50
  v_perm_b32 v182, v143, v139, s51
  s_waitcnt vmcnt(7)
  buffer_load_dwordx4 v[112:115], v86, s[36:39], s58 offen offset:1024 sc1
  s_waitcnt vmcnt(7)
  v_perm_b32 v155, v148, v144, s50
  v_perm_b32 v159, v148, v144, s51
  v_perm_b32 v163, v149, v145, s50
  v_perm_b32 v167, v149, v145, s51
  v_mfma_f32_16x16x32_bf16 v[40:43], v[152:155], v[8:11], v[40:43]
  v_mfma_f32_16x16x32_bf16 v[44:47], v[156:159], v[8:11], v[44:47]
  v_perm_b32 v171, v150, v146, s50
  v_perm_b32 v175, v150, v146, s51
  v_mfma_f32_16x16x32_bf16 v[48:51], v[160:163], v[8:11], v[48:51]
  v_mfma_f32_16x16x32_bf16 v[52:55], v[164:167], v[8:11], v[52:55]
  v_perm_b32 v179, v151, v147, s50
  v_perm_b32 v183, v151, v147, s51
  v_mfma_f32_16x16x32_bf16 v[56:59], v[168:171], v[8:11], v[56:59]
  v_mfma_f32_16x16x32_bf16 v[60:63], v[172:175], v[8:11], v[60:63]
  v_mfma_f32_16x16x32_bf16 v[64:67], v[176:179], v[8:11], v[64:67]
  v_mfma_f32_16x16x32_bf16 v[68:71], v[180:183], v[8:11], v[68:71]
  buffer_load_dwordx4 v[116:119], v86, s[36:39], s58 offen offset:1152 sc1
L_tail:
  s_mov_b64 exec, s[56:57]
  ds_write_b128 v80, v[40:43] offset:0
  ds_write_b128 v80, v[44:47] offset:512
  ds_write_b128 v80, v[48:51] offset:1024
  ds_write_b128 v80, v[52:55] offset:1536
  ds_write_b128 v80, v[56:59] offset:2048
  ds_write_b128 v80, v[60:63] offset:2560
  ds_write_b128 v80, v[64:67] offset:3072
  ds_write_b128 v80, v[68:71] offset:3584
  s_mov_b64 exec, -1
  s_waitcnt lgkmcnt(0)
  s_barrier
  s_cmp_ge_u32 s40, 2
  s_cbranch_scc1 L_t1b
  ds_read_b128 v[18:21], v220 offset:0
  ds_read_b128 v[22:25], v220 offset:512
  ds_read_b128 v[26:29], v220 offset:4096
  ds_read_b128 v[30:33], v220 offset:4608
  ds_read_b128 v[34:37], v220 offset:8192
  ds_read_b128 v[38:41], v220 offset:8704
  ds_read_b128 v[42:45], v220 offset:12288
  ds_read_b128 v[46:49], v220 offset:12800
  s_add_u32 s49, s94, 0x800
  s_cmp_eq_u32 s6, 0
  s_waitcnt lgkmcnt(7)
  v_mul_f32 v54, v216, v18
  v_mul_f32 v55, v216, v19
  v_mul_f32 v56, v216, v20
  v_mul_f32 v57, v216, v21
  s_waitcnt lgkmcnt(6)
  v_mul_f32 v58, v216, v22
  v_mul_f32 v59, v216, v23
  v_mul_f32 v60, v216, v24
  v_mul_f32 v61, v216, v25
  s_waitcnt lgkmcnt(5)
  v_fma_f32 v54, v217, v26, v54
  v_fma_f32 v55, v217, v27, v55
  v_fma_f32 v56, v217, v28, v56
  v_fma_f32 v57, v217, v29, v57
  s_waitcnt lgkmcnt(4)
  v_fma_f32 v58, v217, v30, v58
  v_fma_f32 v59, v217, v31, v59
  v_fma_f32 v60, v217, v32, v60
  v_fma_f32 v61, v217, v33, v61
  s_waitcnt lgkmcnt(3)
  v_fma_f32 v54, v218, v34, v54
  v_fma_f32 v55, v218, v35, v55
  v_fma_f32 v56, v218, v36, v56
  v_fma_f32 v57, v218, v37, v57
  s_waitcnt lgkmcnt(2)
  v_fma_f32 v58, v218, v38, v58
  v_fma_f32 v59, v218, v39, v59
  v_fma_f32 v60, v218, v40, v60
  v_fma_f32 v61, v218, v41, v61
  s_waitcnt lgkmcnt(1)
  v_fma_f32 v54, v219, v42, v54
  v_fma_f32 v55, v219, v43, v55
  v_fma_f32 v56, v219, v44, v56
  v_fma_f32 v57, v219, v45, v57
  s_waitcnt lgkmcnt(0)
  v_fma_f32 v58, v219, v46, v58
  v_fma_f32 v59, v219, v47, v59
  v_fma_f32 v60, v219, v48, v60
  v_fma_f32 v61, v219, v49, v61
  v_cvt_pk_bf16_f32 v62, v54, v55
  v_cvt_pk_bf16_f32 v63, v60, v61
  v_cvt_pk_bf16_f32 v64, v58, v59
  v_cvt_pk_bf16_f32 v65, v56, v57
  v_min_u32 v62, -2, v62
  v_min_u32 v63, -2, v63
  v_min_u32 v64, -2, v64
  v_min_u32 v65, -2, v65
  s_cbranch_scc0 L_ol1
  buffer_store_dwordx4 v[62:65], v2, s[20:23], s49 offen
L_ol2:
  s_waitcnt vmcnt(1)
  s_branch L_t1
L_t1b:
  s_waitcnt vmcnt(0)
L_t1:
  buffer_load_dwordx4 v[168:171], v86, s[36:39], s93 offen offset:2048 sc1
  buffer_load_dwordx4 v[172:175], v86, s[36:39], s93 offen offset:2176 sc1
  buffer_load_dwordx4 v[176:179], v86, s[36:39], s93 offen offset:3072 sc1
  buffer_load_dwordx4 v[180:183], v86, s[36:39], s93 offen offset:3200 sc1
  buffer_load_dwordx4 v[184:187], v86, s[36:39], s58 offen offset:2048 sc1
  buffer_load_dwordx4 v[188:191], v86, s[36:39], s58 offen offset:2176 sc1
  buffer_load_dwordx4 v[192:195], v86, s[36:39], s58 offen offset:3072 sc1
  buffer_load_dwordx4 v[196:199], v86, s[36:39], s58 offen offset:3200 sc1
  v_mfma_f32_16x16x32_bf16 v[232:235], a[0:3], v[88:91], 0
  v_mfma_f32_16x16x32_bf16 v[236:239], a[4:7], v[88:91], 0
  v_mfma_f32_16x16x32_bf16 v[240:243], a[8:11], v[88:91], 0
  v_mfma_f32_16x16x32_bf16 v[244:247], a[12:15], v[88:91], 0
  v_mov_b32 v200, 0
  v_mov_b32 v201, 0
  v_mfma_f32_16x16x32_bf16 v[232:235], a[16:19], v[92:95], v[232:235]
  v_mfma_f32_16x16x32_bf16 v[236:239], a[20:23], v[92:95], v[236:239]
  v_mfma_f32_16x16x32_bf16 v[240:243], a[24:27], v[92:95], v[240:243]
  v_mfma_f32_16x16x32_bf16 v[244:247], a[28:31], v[92:95], v[244:247]
  v_mov_b32 v202, 0
  v_mov_b32 v203, 0
  v_mfma_f32_16x16x32_bf16 v[232:235], a[32:35], v[96:99], v[232:235]
  v_mfma_f32_16x16x32_bf16 v[236:239], a[36:39], v[96:99], v[236:239]
  v_mfma_f32_16x16x32_bf16 v[240:243], a[40:43], v[96:99], v[240:243]
  v_mfma_f32_16x16x32_bf16 v[244:247], a[44:47], v[96:99], v[244:247]
  v_mov_b32 v204, 0
  v_mov_b32 v205, 0
  v_mfma_f32_16x16x32_bf16 v[232:235], a[48:51], v[100:103], v[232:235]
  v_mfma_f32_16x16x32_bf16 v[236:239], a[52:55], v[100:103], v[236:239]
  v_mfma_f32_16x16x32_bf16 v[240:243], a[56:59], v[100:103], v[240:243]
  v_mfma_f32_16x16x32_bf16 v[244:247], a[60:63], v[100:103], v[244:247]
  v_mov_b32 v206, 0
  v_mov_b32 v207, 0
  v_mfma_f32_16x16x32_bf16 v[232:235], a[64:67], v[104:107], v[232:235]
  v_mfma_f32_16x16x32_bf16 v[236:239], a[68:71], v[104:107], v[236:239]
  v_mfma_f32_16x16x32_bf16 v[240:243], a[72:75], v[104:107], v[240:243]
  v_mfma_f32_16x16x32_bf16 v[244:247], a[76:79], v[104:107], v[244:247]
  v_mov_b32 v208, 0
  v_mov_b32 v209, 0
  v_mfma_f32_16x16x32_bf16 v[232:235], a[80:83], v[108:111], v[232:235]
  v_mfma_f32_16x16x32_bf16 v[236:239], a[84:87], v[108:111], v[236:239]
  v_mfma_f32_16x16x32_bf16 v[240:243], a[88:91], v[108:111], v[240:243]
  v_mfma_f32_16x16x32_bf16 v[244:247], a[92:95], v[108:111], v[244:247]
  v_mov_b32 v210, 0
  v_mov_b32 v211, 0
  v_mfma_f32_16x16x32_bf16 v[232:235], a[96:99], v[112:115], v[232:235]
  v_mfma_f32_16x16x32_bf16 v[236:239], a[100:103], v[112:115], v[236:239]
  v_mfma_f32_16x16x32_bf16 v[240:243], a[104:107], v[112:115], v[240:243]
  v_mfma_f32_16x16x32_bf16 v[244:247], a[108:111], v[112:115], v[244:247]
  v_mov_b32 v212, 0
  v_mov_b32 v213, 0
  v_mfma_f32_16x16x32_bf16 v[232:235], a[112:115], v[116:119], v[232:235]
  v_mfma_f32_16x16x32_bf16 v[236:239], a[116:119], v[116:119], v[236:239]
  v_mfma_f32_16x16x32_bf16 v[240:243], a[120:123], v[116:119], v[240:243]
  v_mfma_f32_16x16x32_bf16 v[244:247], a[124:127], v[116:119], v[244:247]
  v_mov_b32 v214, 0
  v_mov_b32 v215, 0
  s_cmp_lt_u32 s40, 2
  s_cbranch_scc1 L_t2
  s_nop 4
  ds_write_b128 v224, v[232:235] offset:0
  ds_write_b128 v224, v[236:239] offset:1024
  ds_write_b128 v224, v[240:243] offset:2048
  ds_write_b128 v224, v[244:247] offset:3072
  ds_write_b32 v226, v83 offset:32
  s_waitcnt vmcnt(0)
  s_branch L_t3
L_t2:
  s_mov_b32 s54, 0x400000
L_xp_1:
  ds_read_b32 v249, v226 offset:32
  ds_read_b128 v[120:123], v224 offset:0
  ds_read_b128 v[124:127], v224 offset:1024
  ds_read_b128 v[128:131], v224 offset:2048
  ds_read_b128 v[132:135], v224 offset:3072
  s_sub_u32 s54, s54, 1
  s_waitcnt lgkmcnt(4)
  v_readfirstlane_b32 s48, v249
  s_cmp_eq_u32 s54, 0
  s_cbranch_scc1 L_xd_2
  s_cmp_eq_u32 s48, 0
  s_cbranch_scc1 L_xp_1
L_xd_2:
  s_add_u32 s48, s84, 0
  s_add_u32 s49, s48, 0x40000
  s_waitcnt lgkmcnt(3)
  v_add_f32 v232, v232, v120
  v_add_f32 v233, v233, v121
  v_add_f32 v234, v234, v122
  v_add_f32 v235, v235, v123
  v_perm_b32 v232, v232, v254, s88
  v_perm_b32 v233, v233, v254, s89
  v_perm_b32 v234, v234, v254, s90
  v_perm_b32 v235, v235, v254, s91
  buffer_store_dwordx4 v[232:235], v87, s[36:39], s48 offen offset:0 sc1
  s_waitcnt lgkmcnt(2)
  v_add_f32 v236, v236, v124
  v_add_f32 v237, v237, v125
  v_add_f32 v238, v238, v126
  v_add_f32 v239, v239, v127
  v_perm_b32 v236, v236, v254, s88
  v_perm_b32 v237, v237, v254, s89
  v_perm_b32 v238, v238, v254, s90
  v_perm_b32 v239, v239, v254, s91
  buffer_store_dwordx4 v[236:239], v87, s[36:39], s48 offen offset:512 sc1
  s_waitcnt lgkmcnt(1)
  v_add_f32 v240, v240, v128
  v_add_f32 v241, v241, v129
  v_add_f32 v242, v242, v130
  v_add_f32 v243, v243, v131
  v_perm_b32 v240, v240, v254, s88
  v_perm_b32 v241, v241, v254, s89
  v_perm_b32 v242, v242, v254, s90
  v_perm_b32 v243, v243, v254, s91
  buffer_store_dwordx4 v[240:243], v87, s[36:39], s49 offen offset:0 sc1
  s_waitcnt lgkmcnt(0)
  v_add_f32 v244, v244, v132
  v_add_f32 v245, v245, v133
  v_add_f32 v246, v246, v134
  v_add_f32 v247, v247, v135
  v_perm_b32 v244, v244, v254, s88
  v_perm_b32 v245, v245, v254, s89
  v_perm_b32 v246, v246, v254, s90
  v_perm_b32 v247, v247, v254, s91
  buffer_store_dwordx4 v[244:247], v87, s[36:39], s49 offen offset:512 sc1
  s_waitcnt vmcnt(4)
L_t3:
  s_mov_b32 s54, 0x20000
  s_mov_b32 s53, 15
L_retry:
  v_max3_u32 v8, v168, v169, v170
  v_max3_u32 v9, v171, v172, v173
  v_max3_u32 v8, v8, v174, v175
  v_max_u32 v8, v8, v9
  v_cmp_eq_u32 s[8:9], -1, v8
  v_max3_u32 v8, v176, v177, v178
  v_max3_u32 v9, v179, v180, v181
  v_max3_u32 v8, v8, v182, v183
  v_max_u32 v8, v8, v9
  v_cmp_eq_u32 s[10:11], -1, v8
  v_max3_u32 v8, v184, v185, v186
  v_max3_u32 v9, v187, v188, v189
  v_max3_u32 v8, v8, v190, v191
  v_max_u32 v8, v8, v9
  v_cmp_eq_u32 s[48:49], -1, v8
  v_max3_u32 v8, v192, v193, v194
  v_max3_u32 v9, v195, v196, v197
  v_max3_u32 v8, v8, v198, v199
  v_max_u32 v8, v8, v9
  v_cmp_eq_u32 vcc, -1, v8
  s_mov_b32 s7, 0
  s_or_b64 s[12:13], s[8:9], s[10:11]
  s_or_b64 s[14:15], s[48:49], vcc
  s_or_b64 s[12:13], s[12:13], s[14:15]
  s_cbranch_scc0 L_fpg
  s_mov_b64 exec, s[8:9]
  buffer_load_dwordx4 v[168:171], v86, s[36:39], s93 offen offset:2048 sc1
  buffer_load_dwordx4 v[172:175], v86, s[36:39], s93 offen offset:2176 sc1
  s_cmp_lg_u64 s[8:9], 0
  s_addc_u32 s7, s7, s7
  s_mov_b64 exec, s[10:11]
  buffer_load_dwordx4 v[176:179], v86, s[36:39], s93 offen offset:3072 sc1
  buffer_load_dwordx4 v[180:183], v86, s[36:39], s93 offen offset:3200 sc1
  s_cmp_lg_u64 s[10:11], 0
  s_addc_u32 s7, s7, s7
  s_mov_b64 exec, s[48:49]
  buffer_load_dwordx4 v[184:187], v86, s[36:39], s58 offen offset:2048 sc1
  buffer_load_dwordx4 v[188:191], v86, s[36:39], s58 offen offset:2176 sc1
  s_cmp_lg_u64 s[48:49], 0
  s_addc_u32 s7, s7, s7
  s_mov_b64 exec, vcc
  buffer_load_dwordx4 v[192:195], v86, s[36:39], s58 offen offset:3072 sc1
  buffer_load_dwordx4 v[196:199], v86, s[36:39], s58 offen offset:3200 sc1
  s_cmp_lg_u64 vcc, 0
  s_addc_u32 s7, s7, s7
  s_mov_b64 exec, -1
L_fpg:
  s_andn2_b32 s8, s53, s7
  s_mov_b32 s53, s7
  s_cbranch_scc0 L_rc3
  s_bitcmp1_b32 s8, 3
  s_cbranch_scc0 L_rc0
  v_mfma_f32_16x16x32_bf16 v[200:203], a[0:3], v[168:171], v[200:203]
  v_mfma_f32_16x16x32_bf16 v[204:207], a[4:7], v[168:171], v[204:207]
  v_mfma_f32_16x16x32_bf16 v[208:211], a[8:11], v[168:171], v[208:211]
  v_mfma_f32_16x16x32_bf16 v[212:215], a[12:15], v[168:171], v[212:215]
  v_mfma_f32_16x16x32_bf16 v[200:203], a[16:19], v[172:175], v[200:203]
  v_mfma_f32_16x16x32_bf16 v[204:207], a[20:23], v[172:175], v[204:207]
  v_mfma_f32_16x16x32_bf16 v[208:211], a[24:27], v[172:175], v[208:211]
  v_mfma_f32_16x16x32_bf16 v[212:215], a[28:31], v[172:175], v[212:215]
L_rc0:
  s_bitcmp1_b32 s8, 2
  s_cbranch_scc0 L_rc1
  v_mfma_f32_16x16x32_bf16 v[200:203], a[32:35], v[176:179], v[200:203]
  v_mfma_f32_16x16x32_bf16 v[204:207], a[36:39], v[176:179], v[204:207]
  v_mfma_f32_16x16x32_bf16 v[208:211], a[40:43], v[176:179], v[208:211]
  v_mfma_f32_16x16x32_bf16 v[212:215], a[44:47], v[176:179], v[212:215]
  v_mfma_f32_16x16x32_bf16 v[200:203], a[48:51], v[180:183], v[200:203]
  v_mfma_f32_16x16x32_bf16 v[204:207], a[52:55], v[180:183], v[204:207]
  v_mfma_f32_16x16x32_bf16 v[208:211], a[56:59], v[180:183], v[208:211]
  v_mfma_f32_16x16x32_bf16 v[212:215], a[60:63], v[180:183], v[212:215]
L_rc1:
  s_bitcmp1_b32 s8, 1
  s_cbranch_scc0 L_rc2
  v_mfma_f32_16x16x32_bf16 v[200:203], a[64:67], v[184:187], v[200:203]
  v_mfma_f32_16x16x32_bf16 v[204:207], a[68:71], v[184:187], v[204:207]
  v_mfma_f32_16x16x32_bf16 v[208:211], a[72:75], v[184:187], v[208:211]
  v_mfma_f32_16x16x32_bf16 v[212:215], a[76:79], v[184:187], v[212:215]
  v_mfma_f32_16x16x32_bf16 v[200:203], a[80:83], v[188:191], v[200:203]
  v_mfma_f32_16x16x32_bf16 v[204:207], a[84:87], v[188:191], v[204:207]
  v_mfma_f32_16x16x32_bf16 v[208:211], a[88:91], v[188:191], v[208:211]
  v_mfma_f32_16x16x32_bf16 v[212:215], a[92:95], v[188:191], v[212:215]
L_rc2:
  s_bitcmp1_b32 s8, 0
  s_cbranch_scc0 L_rc3
  v_mfma_f32_16x16x32_bf16 v[200:203], a[96:99], v[192:195], v[200:203]
  v_mfma_f32_16x16x32_bf16 v[204:207], a[100:103], v[192:195], v[204:207]
  v_mfma_f32_16x16x32_bf16 v[208:211], a[104:107], v[192:195], v[208:211]
  v_mfma_f32_16x16x32_bf16 v[212:215], a[108:111], v[192:195], v[212:215]
  v_mfma_f32_16x16x32_bf16 v[200:203], a[112:115], v[196:199], v[200:203]
  v_mfma_f32_16x16x32_bf16 v[204:207], a[116:119], v[196:199], v[204:207]
  v_mfma_f32_16x16x32_bf16 v[208:211], a[120:123], v[196:199], v[208:211]
  v_mfma_f32_16x16x32_bf16 v[212:215], a[124:127], v[196:199], v[212:215]
L_rc3:
  s_cmp_eq_u32 s53, 0
  s_cbranch_scc1 L_alldone
  s_sub_u32 s54, s54, 1
  s_waitcnt vmcnt(0)
  s_cmp_lg_u32 s54, 0
  s_cbranch_scc1 L_retry
L_alldone:
  s_cmp_ge_u32 s40, 2
  s_cbranch_scc1 L_t4
  s_mov_b32 s54, 0x400000
L_xp_3:
  ds_read_b32 v249, v226 offset:48
  ds_read_b128 v[120:123], v224 offset:8192
  ds_read_b128 v[124:127], v224 offset:9216
  ds_read_b128 v[128:131], v224 offset:10240
  ds_read_b128 v[132:135], v224 offset:11264
  s_sub_u32 s54, s54, 1
  s_waitcnt lgkmcnt(4)
  v_readfirstlane_b32 s48, v249
  s_cmp_eq_u32 s54, 0
  s_cbranch_scc1 L_xd_4
  s_cmp_eq_u32 s48, 0
  s_cbranch_scc1 L_xp_3
L_xd_4:
  s_add_u32 s48, s84, s4
  s_add_u32 s49, s48, 0x40000
  s_waitcnt lgkmcnt(3)
  v_add_f32 v200, v200, v120
  v_add_f32 v201, v201, v121
  v_add_f32 v202, v202, v122
  v_add_f32 v203, v203, v123
  v_perm_b32 v200, v200, v254, s88
  v_perm_b32 v201, v201, v254, s89
  v_perm_b32 v202, v202, v254, s90
  v_perm_b32 v203, v203, v254, s91
  buffer_store_dwordx4 v[200:203], v87, s[36:39], s48 offen offset:0 sc1
  s_waitcnt lgkmcnt(2)
  v_add_f32 v204, v204, v124
  v_add_f32 v205, v205, v125
  v_add_f32 v206, v206, v126
  v_add_f32 v207, v207, v127
  v_perm_b32 v204, v204, v254, s88
  v_perm_b32 v205, v205, v254, s89
  v_perm_b32 v206, v206, v254, s90
  v_perm_b32 v207, v207, v254, s91
  buffer_store_dwordx4 v[204:207], v87, s[36:39], s48 offen offset:512 sc1
  s_waitcnt lgkmcnt(1)
  v_add_f32 v208, v208, v128
  v_add_f32 v209, v209, v129
  v_add_f32 v210, v210, v130
  v_add_f32 v211, v211, v131
  v_perm_b32 v208, v208, v254, s88
  v_perm_b32 v209, v209, v254, s89
  v_perm_b32 v210, v210, v254, s90
  v_perm_b32 v211, v211, v254, s91
  buffer_store_dwordx4 v[208:211], v87, s[36:39], s49 offen offset:0 sc1
  s_waitcnt lgkmcnt(0)
  v_add_f32 v212, v212, v132
  v_add_f32 v213, v213, v133
  v_add_f32 v214, v214, v134
  v_add_f32 v215, v215, v135
  v_perm_b32 v212, v212, v254, s88
  v_perm_b32 v213, v213, v254, s89
  v_perm_b32 v214, v214, v254, s90
  v_perm_b32 v215, v215, v254, s91
  buffer_store_dwordx4 v[212:215], v87, s[36:39], s49 offen offset:512 sc1
  s_branch L_fin
L_t4:
  s_nop 4
  ds_write_b128 v224, v[200:203] offset:8192
  ds_write_b128 v224, v[204:207] offset:9216
  ds_write_b128 v224, v[208:211] offset:10240
  ds_write_b128 v224, v[212:215] offset:11264
  ds_write_b32 v226, v83 offset:48
  s_cmp_eq_u32 s40, 3
  s_cbranch_scc1 L_fin
  s_mov_b32 s46, 0
L_r1d:
  buffer_load_dwordx4 v[88:91], v2, s[36:39], s85 offen offset:0 sc1
  buffer_load_dwordx4 v[92:95], v2, s[36:39], s85 offen offset:1024 sc1
  buffer_load_dwordx4 v[96:99], v2, s[36:39], s85 offen offset:2048 sc1
  buffer_load_dwordx4 v[100:103], v2, s[36:39], s85 offen offset:3072 sc1
  buffer_load_dwordx4 v[104:107], v4, s[36:39], s85 offen offset:0 sc1
  buffer_load_dwordx4 v[108:111], v4, s[36:39], s85 offen offset:1024 sc1
  buffer_load_dwordx4 v[112:115], v4, s[36:39], s85 offen offset:2048 sc1
  buffer_load_dwordx4 v[116:119], v4, s[36:39], s85 offen offset:3072 sc1
L_red:
  s_mov_b32 s50, 0x0c0c0400
  s_mov_b32 s51, 0x04000c0c
  s_mov_b32 s52, 0xffffff00
  s_mov_b32 s54, 0x20000
  s_mov_b32 s53, 0xff
  s_mov_b32 s54, 0x20000
  s_waitcnt vmcnt(0)
L_c_5:
  s_bitcmp1_b32 s53, 0
  s_cbranch_scc0 L_n_7
  v_perm_b32 v8, v89, v88, s50
  v_perm_b32 v9, v91, v90, s51
  v_or_b32 v8, v8, v9
  v_cmp_ne_u32 vcc, s3, v8
  s_cbranch_vccnz L_n_7x
  s_bitset0_b32 s53, 0
  v_and_b32 v88, s52, v88
  v_and_b32 v89, s52, v89
  v_and_b32 v90, s52, v90
  v_and_b32 v91, s52, v91
L_n_7:
  s_bitcmp1_b32 s53, 1
  s_cbranch_scc0 L_n_8
  v_perm_b32 v8, v93, v92, s50
  v_perm_b32 v9, v95, v94, s51
  v_or_b32 v8, v8, v9
  v_cmp_ne_u32 vcc, s3, v8
  s_cbranch_vccnz L_n_8x
  s_bitset0_b32 s53, 1
  v_and_b32 v92, s52, v92
  v_and_b32 v93, s52, v93
  v_and_b32 v94, s52, v94
  v_and_b32 v95, s52, v95
L_n_8:
  s_bitcmp1_b32 s53, 2
  s_cbranch_scc0 L_n_9
  v_perm_b32 v8, v97, v96, s50
  v_perm_b32 v9, v99, v98, s51
  v_or_b32 v8, v8, v9
  v_cmp_ne_u32 vcc, s3, v8
  s_cbranch_vccnz L_n_9x
  s_bitset0_b32 s53, 2
  v_and_b32 v96, s52, v96
  v_and_b32 v97, s52, v97
  v_and_b32 v98, s52, v98
  v_and_b32 v99, s52, v99
L_n_9:
  s_bitcmp1_b32 s53, 3
  s_cbranch_scc0 L_n_10
  v_perm_b32 v8, v101, v100, s50
  v_perm_b32 v9, v103, v102, s51
  v_or_b32 v8, v8, v9
  v_cmp_ne_u32 vcc, s3, v8
  s_cbranch_vccnz L_n_10x
  s_bitset0_b32 s53, 3
  v_and_b32 v100, s52, v100
  v_and_b32 v101, s52, v101
  v_and_b32 v102, s52, v102
  v_and_b32 v103, s52, v103
L_n_10:
  s_bitcmp1_b32 s53, 4
  s_cbranch_scc0 L_n_11
  v_perm_b32 v8, v105, v104, s50
  v_perm_b32 v9, v107, v106, s51
  v_or_b32 v8, v8, v9
  v_cmp_ne_u32 vcc, s3, v8
  s_cbranch_vccnz L_n_11x
  s_bitset0_b32 s53, 4
  v_and_b32 v104, s52, v104
  v_and_b32 v105, s52, v105
  v_and_b32 v106, s52, v106
  v_and_b32 v107, s52, v107
L_n_11:
  s_bitcmp1_b32 s53, 5
  s_cbranch_scc0 L_n_12
  v_perm_b32 v8, v109, v108, s50
  v_perm_b32 v9, v111, v110, s51
  v_or_b32 v8, v8, v9
  v_cmp_ne_u32 vcc, s3, v8
  s_cbranch_vccnz L_n_12x
  s_bitset0_b32 s53, 5
  v_and_b32 v108, s52, v108
  v_and_b32 v109, s52, v109
  v_and_b32 v110, s52, v110
  v_and_b32 v111, s52, v111
L_n_12:
  s_bitcmp1_b32 s53, 6
  s_cbranch_scc0 L_n_13
  v_perm_b32 v8, v113, v112, s50
  v_perm_b32 v9, v115, v114, s51
  v_or_b32 v8, v8, v9
  v_cmp_ne_u32 vcc, s3, v8
  s_cbranch_vccnz L_n_13x
  s_bitset0_b32 s53, 6
  v_and_b32 v112, s52, v112
  v_and_b32 v113, s52, v113
  v_and_b32 v114, s52, v114
  v_and_b32 v115, s52, v115
L_n_13:
  s_bitcmp1_b32 s53, 7
  s_cbranch_scc0 L_n_14
  v_perm_b32 v8, v117, v116, s50
  v_perm_b32 v9, v119, v118, s51
  v_or_b32 v8, v8, v9
  v_cmp_ne_u32 vcc, s3, v8
  s_cbranch_vccnz L_n_14x
  s_bitset0_b32 s53, 7
  v_and_b32 v116, s52, v116
  v_and_b32 v117, s52, v117
  v_and_b32 v118, s52, v118
  v_and_b32 v119, s52, v119
L_n_14:
  s_cmp_eq_u32 s53, 0
  s_cbranch_scc1 L_o_6
  s_sub_u32 s54, s54, 1
  s_waitcnt vmcnt(0)
  s_cmp_lg_u32 s54, 0
  s_cbranch_scc1 L_c_5
L_o_6:
  v_add_f32 v88, v88, v92
  v_add_f32 v89, v89, v93
  v_add_f32 v90, v90, v94
  v_add_f32 v91, v91, v95
  v_add_f32 v96, v96, v100
  v_add_f32 v97, v97, v101
  v_add_f32 v98, v98, v102
  v_add_f32 v99, v99, v103
  v_add_f32 v104, v104, v108
  v_add_f32 v105, v105, v109
  v_add_f32 v106, v106, v110
  v_add_f32 v107, v107, v111
  v_add_f32 v112, v112, v116
  v_add_f32 v113, v113, v117
  v_add_f32 v114, v114, v118
  v_add_f32 v115, v115, v119
  v_add_f32 v88, v88, v96
  v_add_f32 v89, v89, v97
  v_add_f32 v90, v90, v98
  v_add_f32 v91, v91, v99
  v_add_f32 v104, v104, v112
  v_add_f32 v105, v105, v113
  v_add_f32 v106, v106, v114
  v_add_f32 v107, v107, v115
  v_add_f32 v88, v88, v104
  v_add_f32 v89, v89, v105
  v_add_f32 v90, v90, v106
  v_add_f32 v91, v91, v107
  v_cvt_pk_bf16_f32 v92, v88, v89
  v_cvt_pk_bf16_f32 v93, v90, v91
  buffer_store_dwordx2 v[92:93], v82, s[64:67], s86 offen
  s_add_u32 s85, s85, s4
  s_add_u32 s86, s86, 0x20000
  s_add_u32 s46, s46, 1
  s_cmp_eq_u32 s46, 1
  s_nop 1
  s_cbranch_scc1 L_r1d
L_fin:
L_end:
  s_endpgm
L_ol1:
  buffer_store_dwordx4 v[62:65], v2, s[20:23], s49 offen sc1
  s_branch L_ol2
L_n_7x:
  buffer_load_dwordx4 v[88:91], v2, s[36:39], s85 offen offset:0 sc1
  s_branch L_n_7
L_n_8x:
  buffer_load_dwordx4 v[92:95], v2, s[36:39], s85 offen offset:1024 sc1
  s_branch L_n_8
L_n_9x:
  buffer_load_dwordx4 v[96:99], v2, s[36:39], s85 offen offset:2048 sc1
  s_branch L_n_9
L_n_10x:
  buffer_load_dwordx4 v[100:103], v2, s[36:39], s85 offen offset:3072 sc1
  s_branch L_n_10
L_n_11x:
  buffer_load_dwordx4 v[104:107], v4, s[36:39], s85 offen offset:0 sc1
  s_branch L_n_11
L_n_12x:
  buffer_load_dwordx4 v[108:111], v4, s[36:39], s85 offen offset:1024 sc1
  s_branch L_n_12
L_n_13x:
  buffer_load_dwordx4 v[112:115], v4, s[36:39], s85 offen offset:2048 sc1
  s_branch L_n_13
L_n_14x:
  buffer_load_dwordx4 v[116:119], v4, s[36:39], s85 offen offset:3072 sc1
  s_branch L_n_14
L_snip:
L_snipA:
  s_cmp_lg_u32 s46, 8
  s_cbranch_scc1 L_snA8x
  buffer_load_dword v252, v2, s[96:99], 0 offen
  s_add_u32 m0, s59, 0
  s_add_u32 s48, s58, 0x0
  buffer_load_dwordx4 v85, s[60:63], s48 offen lds
  s_branch L_snret
L_snA8x:
  s_cmp_lg_u32 s46, 9
  s_cbranch_scc1 L_snA9x
  buffer_load_dword v252, v2, s[96:99], 0 offen
  v_mov_b32 v20, v6
  s_nop 1
  v_permlane16_swap_b32 v6, v20
  s_nop 1
  v_add_f32 v6, v6, v20
  v_mov_b32 v20, v6
  s_nop 1
  v_permlane32_swap_b32 v6, v20
  s_nop 1
  v_add_f32 v6, v6, v20
  ds_write_b32 v81, v5
  ds_write_b32 v81, v6 offset:2048
  v_mov_b32 v24, v32
  v_mov_b32 v25, v33
  v_mov_b32 v26, v34
  v_mov_b32 v27, v35
  v_mov_b32 v28, v36
  v_mov_b32 v29, v37
  v_mov_b32 v30, v38
  v_mov_b32 v31, v39
  v_add_u32 v81, 0x400, v81
  v_mov_b32 v5, 0xff800000
  v_mov_b32 v6, 0
  s_add_u32 m0, s59, 1024
  s_add_u32 s48, s58, 0x4000
  v_xor_b32 v249, 64, v85
  buffer_load_dwordx4 v249, s[60:63], s48 offen lds
  s_branch L_snret
L_snA9x:
  s_cmp_lg_u32 s46, 10
  s_cbranch_scc1 L_snA10x
  buffer_load_dword v252, v2, s[96:99], 0 offen
  s_add_u32 m0, s59, 2048
  s_add_u32 s48, s58, 0x8000
  buffer_load_dwordx4 v85, s[60:63], s48 offen lds
  s_branch L_snret
L_snA10x:
  s_cmp_lg_u32 s46, 11
  s_cbranch_scc1 L_snA11x
  buffer_load_dword v252, v2, s[96:99], 0 offen
  s_add_u32 m0, s59, 3072
  s_add_u32 s48, s58, 0xc000
  v_xor_b32 v249, 64, v85
  buffer_load_dwordx4 v249, s[60:63], s48 offen lds
  s_branch L_snret
L_snA11x:
  s_cmp_lg_u32 s46, 12
  s_cbranch_scc1 L_snA12x
  buffer_load_dword v252, v2, s[96:99], 0 offen
  s_add_u32 m0, s59, 4096
  s_add_u32 s48, s58, 0x10000
  buffer_load_dwordx4 v85, s[60:63], s48 offen lds
  s_branch L_snret
L_snA12x:
  s_cmp_lg_u32 s46, 13
  s_cbranch_scc1 L_snA13x
  buffer_load_dword v252, v2, s[96:99], 0 offen
  s_add_u32 m0, s59, 5120
  s_add_u32 s48, s58, 0x14000
  v_xor_b32 v249, 64, v85
  buffer_load_dwordx4 v249, s[60:63], s48 offen lds
  s_branch L_snret
L_snA13x:
  s_cmp_lg_u32 s46, 14
  s_cbranch_scc1 L_snA14x
  buffer_load_dword v252, v2, s[96:99], 0 offen
  s_add_u32 m0, s59, 6144
  s_add_u32 s48, s58, 0x18000
  buffer_load_dwordx4 v85, s[60:63], s48 offen lds
  s_branch L_snret
L_snA14x:
  s_cmp_lg_u32 s46, 15
  s_cbranch_scc1 L_snA15x
  buffer_load_dword v252, v2, s[96:99], 0 offen
  s_mov_b64 s[24:25], s[0:1]
  v_mov_b32 v246, v1
  s_mov_b32 s78, s43
  s_add_u32 m0, s59, 7168
  s_add_u32 s48, s58, 0x1c000
  v_xor_b32 v249, 64, v85
  buffer_load_dwordx4 v249, s[60:63], s48 offen lds
  s_mov_b32 s11, 8
  s_branch L_snret
L_snA15x:
  s_cmp_lg_u32 s46, 16
  s_cbranch_scc1 L_snA16x
  buffer_load_dword v252, v2, s[96:99], 0 offen
  s_nop 7
  s_mov_b64 exec, s[56:57]
  ds_write_b128 v80, v[40:43] offset:0
  ds_write_b128 v80, v[44:47] offset:512
  ds_write_b128 v80, v[48:51] offset:1024
  ds_write_b128 v80, v[52:55] offset:1536
  ds_write_b128 v80, v[56:59] offset:2048
  ds_write_b128 v80, v[60:63] offset:2560
  ds_write_b128 v80, v[64:67] offset:3072
  ds_write_b128 v80, v[68:71] offset:3584
  s_mov_b64 exec, -1
  v_add_u32 v80, 0x4000, v80
  s_waitcnt lgkmcnt(0)
  s_mov_b64 exec, 1
  ds_add_u32 v248, v83
  s_mov_b64 exec, -1
  v_mov_b32 v40, 0
  v_mov_b32 v41, 0
  v_mov_b32 v42, 0
  v_mov_b32 v43, 0
  v_mov_b32 v44, 0
  v_mov_b32 v45, 0
  v_mov_b32 v46, 0
  v_mov_b32 v47, 0
  v_mov_b32 v48, 0
  v_mov_b32 v49, 0
  v_mov_b32 v50, 0
  v_mov_b32 v51, 0
  v_mov_b32 v52, 0
  v_mov_b32 v53, 0
  v_mov_b32 v54, 0
  v_mov_b32 v55, 0
  v_mov_b32 v56, 0
  v_mov_b32 v57, 0
  v_mov_b32 v58, 0
  v_mov_b32 v59, 0
  v_mov_b32 v60, 0
  v_mov_b32 v61, 0
  v_mov_b32 v62, 0
  v_mov_b32 v63, 0
  v_mov_b32 v64, 0
  v_mov_b32 v65, 0
  v_mov_b32 v66, 0
  v_mov_b32 v67, 0
  v_mov_b32 v68, 0
  v_mov_b32 v69, 0
  v_mov_b32 v70, 0
  v_mov_b32 v71, 0
  s_add_u32 m0, s59, 8192
  s_add_u32 s48, s58, 0x20000
  buffer_load_dwordx4 v85, s[60:63], s48 offen lds
  s_mov_b32 s11, 20
  s_branch L_snret
L_snA16x:
  s_cmp_lg_u32 s46, 17
  s_cbranch_scc1 L_snA17x
  buffer_load_dword v252, v2, s[96:99], 0 offen
  s_add_u32 m0, s59, 9216
  s_add_u32 s48, s58, 0x24000
  v_xor_b32 v249, 64, v85
  buffer_load_dwordx4 v249, s[60:63], s48 offen lds
  s_branch L_snret
L_snA17x:
  s_cmp_lg_u32 s46, 18
  s_cbranch_scc1 L_snA18x
  s_cmp_ge_u32 s40, 2
  s_cbranch_scc1 L_cf_15
  v_and_b32 v228, 15, v0
  v_lshlrev_b32 v228, 4, v228
  v_bfe_u32 v229, v0, 4, 2
  v_lshl_add_u32 v228, v229, 10, v228
  s_and_b32 s49, s40, 1
  s_lshl_b32 s49, s49, 8
  s_add_u32 s49, s49, 0x8000
  v_add_u32 v228, s49, v228
  v_and_b32 v229, 7, v0
  v_lshlrev_b32 v229, 2, v229
  v_add_u32 v229, 0x18000, v229
  s_mov_b32 s54, 0x100000
L_lp_17:
  ds_read_b32 v230, v248 offset:0
  s_waitcnt lgkmcnt(0)
  v_readfirstlane_b32 s48, v230
  s_cmp_ge_u32 s48, 4
  s_cbranch_scc1 L_ld_18
  s_sub_u32 s54, s54, 1
  s_cmp_eq_u32 s54, 0
  s_cbranch_scc1 L_ld_18
  s_sleep 2
  s_branch L_lp_17
L_ld_18:
  ds_read_b32 v168, v229 offset:0
  ds_read_b32 v169, v229 offset:256
  ds_read_b32 v170, v229 offset:512
  ds_read_b32 v171, v229 offset:768
  ds_read_b32 v172, v229 offset:2048
  ds_read_b32 v173, v229 offset:2304
  ds_read_b32 v174, v229 offset:2560
  ds_read_b32 v175, v229 offset:2816
  ds_read_b128 v[176:179], v228 offset:0
  ds_read_b128 v[180:183], v228 offset:512
  ds_read_b128 v[184:187], v228 offset:4096
  ds_read_b128 v[188:191], v228 offset:4608
  ds_read_b128 v[192:195], v228 offset:8192
  ds_read_b128 v[196:199], v228 offset:8704
  s_waitcnt lgkmcnt(10)
  v_max3_f32 v208, v168, v169, v170
  v_max_f32 v208, v208, v171
  ds_read_b128 v[200:203], v228 offset:12288
  ds_read_b128 v[204:207], v228 offset:12800
  v_sub_f32 v168, v168, v208
  v_sub_f32 v169, v169, v208
  v_sub_f32 v170, v170, v208
  v_sub_f32 v171, v171, v208
  v_exp_f32 v168, v168
  v_exp_f32 v169, v169
  v_exp_f32 v170, v170
  v_exp_f32 v171, v171
  s_waitcnt lgkmcnt(8)
  v_mul_f32 v209, v168, v172
  v_fma_f32 v209, v169, v173, v209
  v_fma_f32 v209, v170, v174, v209
  v_fma_f32 v209, v171, v175, v209
  v_rcp_f32 v209, v209
  s_nop 0
  v_mul_f32 v168, v209, v168
  v_mul_f32 v169, v209, v169
  v_mul_f32 v170, v209, v170
  v_mul_f32 v171, v209, v171
  s_waitcnt lgkmcnt(0)
  v_mul_f32 v212, v168, v176
  v_mul_f32 v213, v168, v177
  v_mul_f32 v214, v168, v178
  v_mul_f32 v215, v168, v179
  v_mul_f32 v216, v168, v180
  v_mul_f32 v217, v168, v181
  v_mul_f32 v218, v168, v182
  v_mul_f32 v219, v168, v183
  v_fma_f32 v212, v169, v184, v212
  v_fma_f32 v213, v169, v185, v213
  v_fma_f32 v214, v169, v186, v214
  v_fma_f32 v215, v169, v187, v215
  v_fma_f32 v216, v169, v188, v216
  v_fma_f32 v217, v169, v189, v217
  v_fma_f32 v218, v169, v190, v218
  v_fma_f32 v219, v169, v191, v219
  v_fma_f32 v212, v170, v192, v212
  v_fma_f32 v213, v170, v193, v213
  v_fma_f32 v214, v170, v194, v214
  v_fma_f32 v215, v170, v195, v215
  v_fma_f32 v216, v170, v196, v216
  v_fma_f32 v217, v170, v197, v217
  v_fma_f32 v218, v170, v198, v218
  v_fma_f32 v219, v170, v199, v219
  v_fma_f32 v212, v171, v200, v212
  v_fma_f32 v213, v171, v201, v213
  v_fma_f32 v214, v171, v202, v214
  v_fma_f32 v215, v171, v203, v215
  v_fma_f32 v216, v171, v204, v216
  v_fma_f32 v217, v171, v205, v217
  v_fma_f32 v218, v171, v206, v218
  v_fma_f32 v219, v171, v207, v219
  v_cvt_pk_bf16_f32 v220, v212, v213
  v_cvt_pk_bf16_f32 v221, v218, v219
  v_cvt_pk_bf16_f32 v222, v216, v217
  v_cvt_pk_bf16_f32 v223, v214, v215
  v_min_u32 v220, -2, v220
  v_min_u32 v221, -2, v221
  v_min_u32 v222, -2, v222
  v_min_u32 v223, -2, v223
  s_mov_b32 s49, s94
  buffer_store_dwordx4 v[220:223], v2, s[20:23], s49 offen sc1
  s_branch L_ce_16
L_cf_15:
  v_mov_b32 v228, -1
  v_mov_b32 v229, -1
  v_mov_b32 v230, -1
  v_mov_b32 v231, -1
  s_add_u32 s48, s94, 0x800
  buffer_store_dwordx4 v[228:231], v2, s[36:39], s48 offen sc1
L_ce_16:
  s_add_u32 m0, s59, 10240
  s_add_u32 s48, s58, 0x28000
  buffer_load_dwordx4 v85, s[60:63], s48 offen lds
  s_mov_b32 s11, 28
  s_branch L_snret
L_snA18x:
  s_cmp_lg_u32 s46, 19
  s_cbranch_scc1 L_snA19x
  buffer_load_dword v252, v2, s[96:99], 0 offen
  s_add_u32 m0, s59, 11264
  s_add_u32 s48, s58, 0x2c000
  v_xor_b32 v249, 64, v85
  buffer_load_dwordx4 v249, s[60:63], s48 offen lds
  s_mov_b32 s11, 8
  s_branch L_snret
L_snA19x:
  s_cmp_lg_u32 s46, 20
  s_cbranch_scc1 L_snA20x
  s_waitcnt lgkmcnt(0)
  s_mov_b64 exec, 1
  ds_add_rtn_u32 v249, v248, v83 offset:4
  s_xor_b32 s49, s55, s5
  v_mov_b32 v168, s49
  s_waitcnt lgkmcnt(0)
  v_readfirstlane_b32 s49, v249
  v_mov_b32 v249, 0
  s_cmp_eq_u32 s49, 3
  s_cselect_b32 s98, 0x1c00000, 0
  s_nop 0
  buffer_store_dword v168, v249, s[96:99], s95 offen sc1
  s_mov_b64 exec, -1
  s_nop 0
  s_mov_b32 s98, 0
  s_add_u32 m0, s59, 12288
  s_add_u32 s48, s58, 0x30000
  buffer_load_dwordx4 v85, s[60:63], s48 offen lds
  s_branch L_snret
L_snA20x:
  s_cmp_lg_u32 s46, 21
  s_cbranch_scc1 L_snA21x
  buffer_load_dword v252, v2, s[96:99], 0 offen
  s_add_u32 m0, s59, 13312
  s_add_u32 s48, s58, 0x34000
  v_xor_b32 v249, 64, v85
  buffer_load_dwordx4 v249, s[60:63], s48 offen lds
  s_branch L_snret
L_snA21x:
  s_cmp_lg_u32 s46, 22
  s_cbranch_scc1 L_snA22x
  buffer_load_dword v252, v2, s[96:99], 0 offen
  s_add_u32 m0, s59, 14336
  s_add_u32 s48, s58, 0x38000
  buffer_load_dwordx4 v85, s[60:63], s48 offen lds
  s_branch L_snret
L_snA22x:
  s_cmp_lg_u32 s46, 23
  s_cbranch_scc1 L_snA23x
  buffer_load_dword v252, v2, s[96:99], 0 offen
  s_mov_b64 s[24:25], s[16:17]
  v_mov_b32 v246, v3
  s_add_u32 m0, s59, 15360
  s_add_u32 s48, s58, 0x3c000
  v_xor_b32 v249, 64, v85
  buffer_load_dwordx4 v249, s[60:63], s48 offen lds
  s_branch L_snret
L_snA23x:
  s_cmp_lg_u32 s46, 24
  s_cbranch_scc1 L_snA24x
  buffer_load_dword v252, v2, s[96:99], 0 offen
  buffer_load_dword v252, v2, s[96:99], 0 offen
  v_mov_b32 v20, v6
  s_nop 1
  v_permlane16_swap_b32 v6, v20
  s_nop 1
  v_add_f32 v6, v6, v20
  v_mov_b32 v20, v6
  s_nop 1
  v_permlane32_swap_b32 v6, v20
  s_nop 1
  v_add_f32 v6, v6, v20
  ds_write_b32 v81, v5
  ds_write_b32 v81, v6 offset:2048
  s_mov_b32 s11, -14
  s_branch L_snret
L_snA24x:
  s_cmp_lg_u32 s46, 25
  s_cbranch_scc1 L_snA25x
  buffer_load_dword v252, v2, s[96:99], 0 offen
  buffer_load_dword v252, v2, s[96:99], 0 offen
  s_mov_b64 exec, 1
  ds_add_u32 v248, v83 offset:16
  s_mov_b64 exec, -1
  s_branch L_snret
L_snA25x:
  s_cmp_lg_u32 s46, 27
  s_cbranch_scc1 L_snA27x
  buffer_load_dword v252, v2, s[96:99], 0 offen
  buffer_load_dword v252, v2, s[96:99], 0 offen
  s_mov_b32 s54, 0x100000
L_lp_19:
  ds_read_b32 v249, v248 offset:16
  s_waitcnt lgkmcnt(0)
  v_readfirstlane_b32 s48, v249
  s_cmp_ge_u32 s48, 4
  s_cbranch_scc1 L_ld_20
  s_sub_u32 s54, s54, 1
  s_cmp_eq_u32 s54, 0
  s_cbranch_scc1 L_ld_20
  s_sleep 2
  s_branch L_lp_19
L_ld_20:
  v_mov_b32 v232, v84
  v_xor_b32 v233, 32, v84
  v_xor_b32 v234, 64, v84
  v_xor_b32 v235, 96, v84
  v_xor_b32 v236, 0x80, v84
  v_xor_b32 v237, 0xa0, v84
  v_xor_b32 v238, 0xc0, v84
  v_xor_b32 v239, 0xe0, v84
  ds_read_b64_tr_b16 a[0:1], v232 offset:0
  ds_read_b64_tr_b16 a[2:3], v236 offset:0
  ds_read_b64_tr_b16 a[4:5], v233 offset:0
  ds_read_b64_tr_b16 a[6:7], v237 offset:0
  ds_read_b64_tr_b16 a[8:9], v234 offset:0
  ds_read_b64_tr_b16 a[10:11], v238 offset:0
  ds_read_b64_tr_b16 a[12:13], v235 offset:0
  ds_read_b64_tr_b16 a[14:15], v239 offset:0
  s_waitcnt lgkmcnt(6)
  ds_read_b64_tr_b16 a[16:17], v232 offset:4096
  ds_read_b64_tr_b16 a[18:19], v236 offset:4096
  ds_read_b64_tr_b16 a[20:21], v233 offset:4096
  ds_read_b64_tr_b16 a[22:23], v237 offset:4096
  ds_read_b64_tr_b16 a[24:25], v234 offset:4096
  ds_read_b64_tr_b16 a[26:27], v238 offset:4096
  ds_read_b64_tr_b16 a[28:29], v235 offset:4096
  ds_read_b64_tr_b16 a[30:31], v239 offset:4096
  s_waitcnt lgkmcnt(6)
  ds_read_b64_tr_b16 a[32:33], v232 offset:8192
  ds_read_b64_tr_b16 a[34:35], v236 offset:8192
  ds_read_b64_tr_b16 a[36:37], v233 offset:8192
  ds_read_b64_tr_b16 a[38:39], v237 offset:8192
  ds_read_b64_tr_b16 a[40:41], v234 offset:8192
  ds_read_b64_tr_b16 a[42:43], v238 offset:8192
  ds_read_b64_tr_b16 a[44:45], v235 offset:8192
  ds_read_b64_tr_b16 a[46:47], v239 offset:8192
  s_waitcnt lgkmcnt(6)
  ds_read_b64_tr_b16 a[48:49], v232 offset:12288
  ds_read_b64_tr_b16 a[50:51], v236 offset:12288
  ds_read_b64_tr_b16 a[52:53], v233 offset:12288
  ds_read_b64_tr_b16 a[54:55], v237 offset:12288
  ds_read_b64_tr_b16 a[56:57], v234 offset:12288
  ds_read_b64_tr_b16 a[58:59], v238 offset:12288
  ds_read_b64_tr_b16 a[60:61], v235 offset:12288
  ds_read_b64_tr_b16 a[62:63], v239 offset:12288
  s_waitcnt lgkmcnt(6)
  s_branch L_snret
L_snA27x:
  s_cmp_lg_u32 s46, 28
  s_cbranch_scc1 L_snA28x
  buffer_load_dword v252, v2, s[96:99], 0 offen
  s_andn2_b32 s48, s95, 127
  v_bfe_u32 v225, v0, 0, 5
  v_lshlrev_b32 v225, 2, v225
  buffer_load_dword v224, v225, s[36:39], s48 offen sc1
  v_mov_b32 v232, v84
  v_xor_b32 v233, 32, v84
  v_xor_b32 v234, 64, v84
  v_xor_b32 v235, 96, v84
  v_xor_b32 v236, 0x80, v84
  v_xor_b32 v237, 0xa0, v84
  v_xor_b32 v238, 0xc0, v84
  v_xor_b32 v239, 0xe0, v84
  ds_read_b64_tr_b16 a[64:65], v232 offset:16384
  ds_read_b64_tr_b16 a[66:67], v236 offset:16384
  ds_read_b64_tr_b16 a[68:69], v233 offset:16384
  ds_read_b64_tr_b16 a[70:71], v237 offset:16384
  ds_read_b64_tr_b16 a[72:73], v234 offset:16384
  ds_read_b64_tr_b16 a[74:75], v238 offset:16384
  ds_read_b64_tr_b16 a[76:77], v235 offset:16384
  ds_read_b64_tr_b16 a[78:79], v239 offset:16384
  s_waitcnt lgkmcnt(6)
  ds_read_b64_tr_b16 a[80:81], v232 offset:20480
  ds_read_b64_tr_b16 a[82:83], v236 offset:20480
  ds_read_b64_tr_b16 a[84:85], v233 offset:20480
  ds_read_b64_tr_b16 a[86:87], v237 offset:20480
  ds_read_b64_tr_b16 a[88:89], v234 offset:20480
  ds_read_b64_tr_b16 a[90:91], v238 offset:20480
  ds_read_b64_tr_b16 a[92:93], v235 offset:20480
  ds_read_b64_tr_b16 a[94:95], v239 offset:20480
  s_waitcnt lgkmcnt(6)
  ds_read_b64_tr_b16 a[96:97], v232 offset:24576
  ds_read_b64_tr_b16 a[98:99], v236 offset:24576
  ds_read_b64_tr_b16 a[100:101], v233 offset:24576
  ds_read_b64_tr_b16 a[102:103], v237 offset:24576
  ds_read_b64_tr_b16 a[104:105], v234 offset:24576
  ds_read_b64_tr_b16 a[106:107], v238 offset:24576
  ds_read_b64_tr_b16 a[108:109], v235 offset:24576
  ds_read_b64_tr_b16 a[110:111], v239 offset:24576
  s_waitcnt lgkmcnt(6)
  ds_read_b64_tr_b16 a[112:113], v232 offset:28672
  ds_read_b64_tr_b16 a[114:115], v236 offset:28672
  ds_read_b64_tr_b16 a[116:117], v233 offset:28672
  ds_read_b64_tr_b16 a[118:119], v237 offset:28672
  ds_read_b64_tr_b16 a[120:121], v234 offset:28672
  ds_read_b64_tr_b16 a[122:123], v238 offset:28672
  ds_read_b64_tr_b16 a[124:125], v235 offset:28672
  ds_read_b64_tr_b16 a[126:127], v239 offset:28672
  s_waitcnt lgkmcnt(6)
  s_branch L_snret
L_snA28x:
  s_cmp_lg_u32 s46, 30
  s_cbranch_scc1 L_snA30x
  buffer_load_dword v252, v2, s[96:99], 0 offen
  buffer_load_dword v252, v2, s[96:99], 0 offen
  s_mov_b32 s54, 0x20000
L_cp_21:
  v_xor_b32 v224, s55, v224
  v_and_b32 v225, 0xffffffe1, v224
  v_cmp_ne_u32 vcc, 0, v225
  s_cbranch_vccz L_cd_22
  s_sub_u32 s54, s54, 1
  s_cmp_eq_u32 s54, 0
  s_cbranch_scc1 L_cd_22
  s_sleep 8
  s_andn2_b32 s48, s95, 127
  v_bfe_u32 v225, v0, 0, 5
  v_lshlrev_b32 v225, 2, v225
  buffer_load_dword v224, v225, s[36:39], s48 offen sc1
  s_waitcnt vmcnt(0)
  s_branch L_cp_21
L_cd_22:
  v_cmp_ne_u32 vcc, s5, v224
  s_add_u32 s58, s93, 0x40000
  s_or_b32 s6, vcc_lo, vcc_hi
  s_branch L_snret
L_snA30x:
  buffer_load_dword v252, v2, s[96:99], 0 offen
  buffer_load_dword v252, v2, s[96:99], 0 offen
L_snret:
  s_cmp_ge_u32 s47, 5
  s_cbranch_scc1 L_snretk
  s_cmp_eq_u32 s47, 1
  s_cbranch_scc1 L_ret1
  s_cmp_eq_u32 s47, 0
  s_cbranch_scc1 L_ret0
  s_cmp_eq_u32 s47, 3
  s_cbranch_scc1 L_ret3
  s_cmp_eq_u32 s47, 4
  s_cbranch_scc1 L_ret4
  s_branch L_ret2
L_snretk:
  s_cmp_eq_u32 s47, 6
  s_cbranch_scc1 L_ret6
  s_cmp_eq_u32 s47, 5
  s_cbranch_scc1 L_ret5
  s_cmp_eq_u32 s47, 8
  s_cbranch_scc1 L_ret8
  s_cmp_eq_u32 s47, 9
  s_cbranch_scc1 L_ret9
  s_branch L_ret7
L_cend:
.section .rodata,"a"
.p2align 6
.amdhsa_kernel standalone__mha_block_cached__sampling_kernel
  .amdhsa_next_free_vgpr 512
  .amdhsa_next_free_sgpr 102
  .amdhsa_accum_offset 256
  .amdhsa_group_segment_fixed_size 0
  .amdhsa_kernarg_size 64
  .amdhsa_user_sgpr_count 2
  .amdhsa_user_sgpr_kernarg_segment_ptr 1
  .amdhsa_system_sgpr_workgroup_id_x 1
.end_amdhsa_kernel
```
